```python
import torch

def _softmax(x, axis=-1):
    return torch.softmax(x, dim=axis)
def _gelu(x):
    return torch.nn.functional.gelu(x, approximate="tanh")
def _silu(x):
    return torch.nn.functional.silu(x)
def _sigmoid(x):
    return torch.sigmoid(x)
def _layernorm(x, axis=-1, eps=1e-5):
    m = x.mean(dim=axis, keepdim=True)
    v = x.var(dim=axis, keepdim=True, unbiased=False)
    return (x - m) / torch.sqrt(v + eps)
def _scatter_add(tgt, idx, src, axis=0):
    return tgt.clone().index_add_(axis, idx, src)
def _segment_sum(src, seg, n):
    out = torch.zeros((n,) + src.shape[1:], dtype=src.dtype)
    return out.index_add_(0, seg, src)
def _pad(x, pw):
    flat = tuple(v for pair in reversed(pw) for v in pair)
    return torch.nn.functional.pad(x, flat)

kernel_name = 'concat_heads__gqa_block_cached__gqa_block_cached__near_ridge'

def setup_inputs():

    _w = (lambda a: (lambda t: t.to(torch.bfloat16) if t.is_floating_point() else t)(torch.as_tensor(a)))
    def _A_setup():
        B, Sq, D = 8, 112, 512
        Hq, Hkv, Sk, Dh = 32, 32, 512, 128
        assert Hq % Hkv == 0, (Hq, Hkv)
        return {
            "x": _w((lambda *s: torch.randn(*s, dtype=torch.bfloat16) * 0.8)(B, Sq, D)),
            "k_cache": _w((lambda *s: torch.randn(*s, dtype=torch.bfloat16) * 0.8)(B, Hkv, Sk, Dh)),
            "v_cache": _w((lambda *s: torch.randn(*s, dtype=torch.bfloat16) * 0.05)(B, Hkv, Sk, Dh)),
            "wq": _w((lambda *s: torch.randn(*s, dtype=torch.bfloat16) * 0.8)(D, Hq * Dh) * (D ** -0.5)),
            "wo": _w((lambda *s: torch.randn(*s, dtype=torch.bfloat16) * 0.05)(Hq * Dh, D) * ((Hq * Dh) ** -0.5)),
        }
    _A_in = _A_setup()

    def _B_setup():
        B, Sq, D = 8, 112, 512
        Hq, Hkv, Sk, Dh = 32, 32, 512, 128
        assert Hq % Hkv == 0, (Hq, Hkv)
        return {
            "x": _w((lambda *s: torch.randn(*s, dtype=torch.bfloat16) * 0.8)(B, Sq, D)),
            "k_cache": _w((lambda *s: torch.randn(*s, dtype=torch.bfloat16) * 0.8)(B, Hkv, Sk, Dh)),
            "v_cache": _w((lambda *s: torch.randn(*s, dtype=torch.bfloat16) * 0.05)(B, Hkv, Sk, Dh)),
            "wq": _w((lambda *s: torch.randn(*s, dtype=torch.bfloat16) * 0.8)(D, Hq * Dh) * (D ** -0.5)),
            "wo": _w((lambda *s: torch.randn(*s, dtype=torch.bfloat16) * 0.05)(Hq * Dh, D) * ((Hq * Dh) ** -0.5)),
        }
    _B_in = _B_setup()

    return {
        "A_x": _A_in["x"],
        "A_k_cache": _A_in["k_cache"],
        "A_v_cache": _A_in["v_cache"],
        "A_wq": _A_in["wq"],
        "A_wo": _A_in["wo"],
        "B_x": _B_in["x"],
        "B_k_cache": _B_in["k_cache"],
        "B_v_cache": _B_in["v_cache"],
        "B_wq": _B_in["wq"],
        "B_wo": _B_in["wo"],
    }

def reference(A_x, A_k_cache, A_v_cache, A_wq, A_wo, B_x, B_k_cache, B_v_cache, B_wq, B_wo):
    def _A_ref(x, k_cache, v_cache, wq, wo):
        B, Sq, D = x.shape
        Hq, Dh = 32, 128
        Hkv = k_cache.shape[1]
        rep = Hq // Hkv
        q = (lambda x, *d: x.permute(*d))((x @ wq).reshape(B, Sq, Hq, Dh), 0, 2, 1, 3)
        k = (lambda x, n, axis: torch.repeat_interleave(x, n, dim=axis))(k_cache, rep, axis=1)
        v = (lambda x, n, axis: torch.repeat_interleave(x, n, dim=axis))(v_cache, rep, axis=1)
        scores = torch.einsum("bhqd,bhkd->bhqk", q, k) * (Dh ** -0.5)
        p = _softmax(scores, axis=-1)
        o = torch.einsum("bhqk,bhkd->bhqd", p, v)
        return (lambda x, *d: x.permute(*d))(o, 0, 2, 1, 3).reshape(B, Sq, Hq * Dh) @ wo

    def _B_ref(x, k_cache, v_cache, wq, wo):
        B, Sq, D = x.shape
        Hq, Dh = 32, 128
        Hkv = k_cache.shape[1]
        rep = Hq // Hkv
        q = (lambda x, *d: x.permute(*d))((x @ wq).reshape(B, Sq, Hq, Dh), 0, 2, 1, 3)
        k = (lambda x, n, axis: torch.repeat_interleave(x, n, dim=axis))(k_cache, rep, axis=1)
        v = (lambda x, n, axis: torch.repeat_interleave(x, n, dim=axis))(v_cache, rep, axis=1)
        scores = torch.einsum("bhqd,bhkd->bhqk", q, k) * (Dh ** -0.5)
        p = _softmax(scores, axis=-1)
        o = torch.einsum("bhqk,bhkd->bhqd", p, v)
        return (lambda x, *d: x.permute(*d))(o, 0, 2, 1, 3).reshape(B, Sq, Hq * Dh) @ wo

    a = _A_ref(A_x, A_k_cache, A_v_cache, A_wq, A_wo)
    b = _B_ref(B_x, B_k_cache, B_v_cache, B_wq, B_wo)
    return torch.concatenate([a, b], axis=-1)
```

```asm
; @launch grid=(256,1,1) block=(512,1,1) lds=163840
.amdgcn_target "amdgcn-amd-amdhsa--gfx950"
.text
.globl concat_heads__gqa_block_cached__gqa_block_cached__near_ridge_kernel
.p2align 8
.type concat_heads__gqa_block_cached__gqa_block_cached__near_ridge_kernel,@function
concat_heads__gqa_block_cached__gqa_block_cached__near_ridge_kernel:
    s_cmp_ge_u32 s2, 256
    s_cbranch_scc1 K_END
    s_load_dwordx8 s[36:43], s[0:1], 0
    s_load_dwordx2 s[44:45], s[0:1], 32
    s_load_dwordx8 s[64:71], s[0:1], 40
    s_load_dwordx4 s[72:75], s[0:1], 72
    s_load_dwordx4 s[52:55], s[0:1], 88
    v_lshrrev_b32 v1, 6, v0
    v_and_b32 v0, 63, v0
    v_readfirstlane_b32 s30, v1
    s_and_b32 s56, s2, 7
    s_lshr_b32 s57, s2, 3
    s_lshr_b32 s47, s56, 2
    s_and_b32 s46, s56, 3
    s_lshr_b32 s34, s57, 2
    s_and_b32 s35, s57, 3
    s_lshl_b32 s48, s46, 3
    s_lshl_b32 s3, s35, 1
    s_add_u32 s48, s48, s3
    s_lshl_b32 s50, s56, 3
    s_add_u32 s50, s50, s34
    s_lshl_b32 s49, s57, 14
    s_lshl_b32 s3, s35, 1
    s_add_u32 s3, s3, s34
    s_and_b32 s3, s3, 7
    s_and_b32 s28, s30, 3
    s_lshl_b32 s29, s28, 12
    s_cmp_ge_u32 s30, 4
    s_cbranch_scc1 G2_START
    v_lshrrev_b32 v226, 3, v0
    v_and_b32 v227, 7, v0
    v_lshrrev_b32 v228, 1, v226
    v_xor_b32 v228, v228, v227
    v_lshlrev_b32 v228, 4, v228
    v_lshl_add_u32 v228, v226, 10, v228
    s_lshl_b32 s30, s28, 15
    v_add_u32 v236, s30, v228
    v_xor_b32 v237, 64, v236
    v_lshrrev_b32 v226, 4, v0
    v_and_b32 v227, 15, v0
    v_lshlrev_b32 v228, 2, v226
    v_xor_b32 v228, v227, v228
    v_lshlrev_b32 v228, 4, v228
    v_lshl_add_u32 v229, v226, 13, v228
    s_lshl_b32 s30, s28, 17
    v_add_u32 v238, s30, v229
    s_waitcnt lgkmcnt(0)
    s_cmp_eq_u32 s47, 0
    s_cselect_b32 s36, s36, s64
    s_cselect_b32 s37, s37, s65
    s_cselect_b32 s38, s38, s66
    s_cselect_b32 s39, s39, s67
    s_cselect_b32 s40, s40, s68
    s_cselect_b32 s41, s41, s69
    s_cselect_b32 s42, s42, s70
    s_cselect_b32 s43, s43, s71
    s_cselect_b32 s44, s44, s72
    s_cselect_b32 s45, s45, s73
    s_mov_b32 s56, s52
    s_mov_b32 s57, s53
    s_mov_b32 s52, s54
    s_mov_b32 s53, s55
    s_mov_b32 s54, s56
    s_mov_b32 s55, s57
    s_mul_i32 s58, s34, 114688
    s_add_u32 s4, s36, s58
    s_addc_u32 s5, s37, 0
    s_mov_b32 s6, 114688
    s_mov_b32 s7, 0x00020000
    s_lshl_b32 s51, s48, 8
    s_add_u32 s8, s42, s51
    s_addc_u32 s9, s43, 0
    s_mov_b32 s10, 4187392
    s_mov_b32 s11, 0x00020000
    s_add_u32 m0, s29, 32768
    s_add_u32 s31, s3, 0
    s_and_b32 s31, s31, 7
    s_lshl_b32 s31, s31, 7
    s_add_u32 s30, s31, 0
    buffer_load_dwordx4 v236, s[4:7], s30 offen offset:0 lds
    s_add_u32 s30, s31, 7168
    buffer_load_dwordx4 v237, s[4:7], s30 offen offset:1024 lds
    s_add_u32 s30, s31, 14336
    buffer_load_dwordx4 v236, s[4:7], s30 offen offset:2048 lds
    s_add_u32 s30, s31, 21504
    buffer_load_dwordx4 v237, s[4:7], s30 offen offset:3072 lds
    s_add_u32 m0, s29, 49152
    s_add_u32 s31, s3, 0
    s_and_b32 s31, s31, 7
    s_lshl_b32 s31, s31, 19
    s_add_u32 s30, s31, 256
    buffer_load_dwordx4 v238, s[8:11], s30 offen offset:0 lds
    s_add_u32 s30, s31, 32000
    buffer_load_dwordx4 v238, s[8:11], s30 offen offset:1024 lds
    s_add_u32 s30, s31, 63744
    buffer_load_dwordx4 v238, s[8:11], s30 offen offset:2048 lds
    s_add_u32 s30, s31, 95488
    buffer_load_dwordx4 v238, s[8:11], s30 offen offset:3072 lds
    s_add_u32 m0, s29, 98304
    s_add_u32 s31, s3, 1
    s_and_b32 s31, s31, 7
    s_lshl_b32 s31, s31, 7
    s_add_u32 s30, s31, 0
    buffer_load_dwordx4 v236, s[4:7], s30 offen offset:0 lds
    s_add_u32 s30, s31, 7168
    buffer_load_dwordx4 v237, s[4:7], s30 offen offset:1024 lds
    s_add_u32 s30, s31, 14336
    buffer_load_dwordx4 v236, s[4:7], s30 offen offset:2048 lds
    s_add_u32 s30, s31, 21504
    buffer_load_dwordx4 v237, s[4:7], s30 offen offset:3072 lds
    s_add_u32 m0, s29, 65536
    s_add_u32 s31, s3, 1
    s_and_b32 s31, s31, 7
    s_lshl_b32 s31, s31, 19
    s_add_u32 s30, s31, 256
    buffer_load_dwordx4 v238, s[8:11], s30 offen offset:0 lds
    s_add_u32 s30, s31, 32000
    buffer_load_dwordx4 v238, s[8:11], s30 offen offset:1024 lds
    s_add_u32 s30, s31, 63744
    buffer_load_dwordx4 v238, s[8:11], s30 offen offset:2048 lds
    s_add_u32 s30, s31, 95488
    buffer_load_dwordx4 v238, s[8:11], s30 offen offset:3072 lds
    v_lshl_add_u32 v229, v226, 8, v228
    v_add_u32 v30, s29, v229
    v_xor_b32 v228, v227, v226
    v_lshlrev_b32 v228, 4, v228
    v_lshl_add_u32 v228, v226, 8, v228
    v_add_u32 v26, s29, v228
    v_xor_b32 v27, 64, v26
    v_xor_b32 v28, 128, v26
    v_xor_b32 v29, 192, v26
    s_lshl_b32 s58, s34, 5
    s_add_u32 s58, s58, s48
    s_lshl_b32 s51, s58, 17
    s_add_u32 s12, s38, s51
    s_addc_u32 s13, s39, 0
    s_mov_b32 s14, 655360
    s_mov_b32 s15, 0x00020000
    s_add_u32 s16, s40, s51
    s_addc_u32 s17, s41, 0
    s_mov_b32 s18, 655360
    s_mov_b32 s19, 0x00020000
    s_lshl_b32 s58, s47, 3
    s_add_u32 s58, s58, s34
    s_lshl_b32 s58, s58, 5
    s_add_u32 s58, s58, s48
    s_lshl_b32 s58, s58, 15
    s_add_u32 s20, s52, s58
    s_addc_u32 s21, s53, 0
    s_mov_b32 s22, 163840
    s_mov_b32 s23, 0x00020000
    s_lshl_b32 s58, s50, 10
    s_add_u32 s58, s58, 100663296
    s_add_u32 s24, s52, s58
    s_addc_u32 s25, s53, 0
    s_mov_b32 s26, 1024
    s_mov_b32 s27, 0x00020000
    v_and_b32 v226, 31, v0
    v_lshrrev_b32 v227, 5, v0
    v_and_b32 v228, 15, v0
    v_xor_b32 v228, v228, v227
    v_lshlrev_b32 v228, 4, v228
    v_lshl_add_u32 v2, v226, 8, v228
    v_xor_b32 v3, 32, v2
    v_xor_b32 v4, 64, v2
    v_xor_b32 v5, 96, v2
    v_xor_b32 v6, 128, v2
    v_xor_b32 v7, 160, v2
    v_xor_b32 v8, 192, v2
    v_xor_b32 v9, 224, v2
    v_add_u32 v10, 65536, v2
    v_add_u32 v11, 65536, v3
    v_add_u32 v12, 65536, v4
    v_add_u32 v13, 65536, v5
    v_add_u32 v14, 65536, v6
    v_add_u32 v15, 65536, v7
    v_add_u32 v16, 65536, v8
    v_add_u32 v17, 65536, v9
    v_lshrrev_b32 v226, 2, v0
    v_and_b32 v226, 3, v226
    v_lshrrev_b32 v228, 4, v0
    v_and_b32 v228, 1, v228
    v_lshlrev_b32 v228, 5, v228
    v_lshl_add_u32 v228, v226, 8, v228
    v_lshl_add_u32 v228, v226, 6, v228
    v_and_b32 v229, 3, v0
    v_lshl_add_u32 v18, v229, 3, v228
    v_lshl_add_u32 v18, v227, 10, v18
    v_xor_b32 v19, 64, v18
    v_xor_b32 v20, 128, v18
    v_xor_b32 v21, 192, v18
    v_add_u32 v22, 65536, v18
    v_add_u32 v23, 65536, v19
    v_add_u32 v24, 65536, v20
    v_add_u32 v25, 65536, v21
    s_mov_b32 s32, 0x41000000
    v_lshlrev_b32 v231, 4, v0
    v_add_u32 v231, s29, v231
    v_add_u32 v232, 114688, v231
    s_waitcnt vmcnt(8)
    s_barrier
    s_add_u32 m0, s29, 114688
    s_add_u32 s31, s3, 2
    s_and_b32 s31, s31, 7
    s_lshl_b32 s31, s31, 7
    s_add_u32 s30, s31, 0
    buffer_load_dwordx4 v236, s[4:7], s30 offen offset:0 lds
    s_add_u32 s30, s31, 7168
    buffer_load_dwordx4 v237, s[4:7], s30 offen offset:1024 lds
    s_add_u32 s30, s31, 14336
    buffer_load_dwordx4 v236, s[4:7], s30 offen offset:2048 lds
    s_add_u32 s30, s31, 21504
    buffer_load_dwordx4 v237, s[4:7], s30 offen offset:3072 lds
    s_add_u32 m0, s29, 131072
    s_add_u32 s31, s3, 2
    s_and_b32 s31, s31, 7
    s_lshl_b32 s31, s31, 19
    s_add_u32 s30, s31, 256
    buffer_load_dwordx4 v238, s[8:11], s30 offen offset:0 lds
    s_add_u32 s30, s31, 32000
    buffer_load_dwordx4 v238, s[8:11], s30 offen offset:1024 lds
    s_add_u32 s30, s31, 63744
    buffer_load_dwordx4 v238, s[8:11], s30 offen offset:2048 lds
    s_add_u32 s30, s31, 95488
    buffer_load_dwordx4 v238, s[8:11], s30 offen offset:3072 lds
    s_waitcnt vmcnt(8)
    s_barrier
    s_add_u32 m0, s29, 147456
    s_add_u32 s31, s3, 3
    s_and_b32 s31, s31, 7
    s_lshl_b32 s31, s31, 7
    s_add_u32 s30, s31, 0
    buffer_load_dwordx4 v236, s[4:7], s30 offen offset:0 lds
    s_add_u32 s30, s31, 7168
    buffer_load_dwordx4 v237, s[4:7], s30 offen offset:1024 lds
    s_add_u32 s30, s31, 14336
    buffer_load_dwordx4 v236, s[4:7], s30 offen offset:2048 lds
    s_add_u32 s30, s31, 21504
    buffer_load_dwordx4 v237, s[4:7], s30 offen offset:3072 lds
    s_add_u32 m0, s29, 81920
    s_add_u32 s31, s3, 3
    s_and_b32 s31, s31, 7
    s_lshl_b32 s31, s31, 19
    s_add_u32 s30, s31, 256
    buffer_load_dwordx4 v238, s[8:11], s30 offen offset:0 lds
    s_add_u32 s30, s31, 32000
    buffer_load_dwordx4 v238, s[8:11], s30 offen offset:1024 lds
    s_add_u32 s30, s31, 63744
    buffer_load_dwordx4 v238, s[8:11], s30 offen offset:2048 lds
    s_add_u32 s30, s31, 95488
    buffer_load_dwordx4 v238, s[8:11], s30 offen offset:3072 lds
    s_add_u32 m0, s29, 0
    s_add_u32 s30, s49, 0
    s_and_b32 s30, s30, 114688
    s_add_u32 s30, s30, 131072
    buffer_load_dwordx4 v26, s[12:15], s30 offen offset:0 nt lds
    buffer_load_dwordx4 v27, s[12:15], s30 offen offset:1024 nt lds
    buffer_load_dwordx4 v28, s[12:15], s30 offen offset:2048 nt lds
    buffer_load_dwordx4 v29, s[12:15], s30 offen offset:3072 nt lds
    s_waitcnt vmcnt(12)
    s_barrier
    s_add_u32 m0, s29, 32768
    s_add_u32 s31, s3, 4
    s_and_b32 s31, s31, 7
    s_lshl_b32 s31, s31, 7
    s_add_u32 s30, s31, 0
    buffer_load_dwordx4 v236, s[4:7], s30 offen offset:0 lds
    s_add_u32 s30, s31, 7168
    buffer_load_dwordx4 v237, s[4:7], s30 offen offset:1024 lds
    s_add_u32 s30, s31, 14336
    buffer_load_dwordx4 v236, s[4:7], s30 offen offset:2048 lds
    s_add_u32 s30, s31, 21504
    buffer_load_dwordx4 v237, s[4:7], s30 offen offset:3072 lds
    s_add_u32 m0, s29, 49152
    s_add_u32 s31, s3, 4
    s_and_b32 s31, s31, 7
    s_lshl_b32 s31, s31, 19
    s_add_u32 s30, s31, 256
    buffer_load_dwordx4 v238, s[8:11], s30 offen offset:0 lds
    s_add_u32 s30, s31, 32000
    buffer_load_dwordx4 v238, s[8:11], s30 offen offset:1024 lds
    s_add_u32 s30, s31, 63744
    buffer_load_dwordx4 v238, s[8:11], s30 offen offset:2048 lds
    s_add_u32 s30, s31, 95488
    buffer_load_dwordx4 v238, s[8:11], s30 offen offset:3072 lds
    s_waitcnt vmcnt(12)
    s_barrier
    s_add_u32 m0, s29, 98304
    s_add_u32 s31, s3, 5
    s_and_b32 s31, s31, 7
    s_lshl_b32 s31, s31, 7
    s_add_u32 s30, s31, 0
    buffer_load_dwordx4 v236, s[4:7], s30 offen offset:0 lds
    s_add_u32 s30, s31, 7168
    buffer_load_dwordx4 v237, s[4:7], s30 offen offset:1024 lds
    s_add_u32 s30, s31, 14336
    buffer_load_dwordx4 v236, s[4:7], s30 offen offset:2048 lds
    s_add_u32 s30, s31, 21504
    buffer_load_dwordx4 v237, s[4:7], s30 offen offset:3072 lds
    s_add_u32 m0, s29, 65536
    s_add_u32 s31, s3, 5
    s_and_b32 s31, s31, 7
    s_lshl_b32 s31, s31, 19
    s_add_u32 s30, s31, 256
    buffer_load_dwordx4 v238, s[8:11], s30 offen offset:0 lds
    s_add_u32 s30, s31, 32000
    buffer_load_dwordx4 v238, s[8:11], s30 offen offset:1024 lds
    s_add_u32 s30, s31, 63744
    buffer_load_dwordx4 v238, s[8:11], s30 offen offset:2048 lds
    s_add_u32 s30, s31, 95488
    buffer_load_dwordx4 v238, s[8:11], s30 offen offset:3072 lds
    s_add_u32 m0, s29, 16384
    s_add_u32 s30, s49, 16384
    s_and_b32 s30, s30, 114688
    s_add_u32 s30, s30, 131072
    buffer_load_dwordx4 v26, s[12:15], s30 offen offset:0 nt lds
    buffer_load_dwordx4 v27, s[12:15], s30 offen offset:1024 nt lds
    buffer_load_dwordx4 v28, s[12:15], s30 offen offset:2048 nt lds
    buffer_load_dwordx4 v29, s[12:15], s30 offen offset:3072 nt lds
    s_waitcnt vmcnt(12)
    s_barrier
    s_add_u32 m0, s29, 114688
    s_add_u32 s31, s3, 6
    s_and_b32 s31, s31, 7
    s_lshl_b32 s31, s31, 7
    s_add_u32 s30, s31, 0
    buffer_load_dwordx4 v236, s[4:7], s30 offen offset:0 lds
    s_add_u32 s30, s31, 7168
    buffer_load_dwordx4 v237, s[4:7], s30 offen offset:1024 lds
    s_add_u32 s30, s31, 14336
    buffer_load_dwordx4 v236, s[4:7], s30 offen offset:2048 lds
    s_add_u32 s30, s31, 21504
    buffer_load_dwordx4 v237, s[4:7], s30 offen offset:3072 lds
    s_add_u32 m0, s29, 131072
    s_add_u32 s31, s3, 6
    s_and_b32 s31, s31, 7
    s_lshl_b32 s31, s31, 19
    s_add_u32 s30, s31, 256
    buffer_load_dwordx4 v238, s[8:11], s30 offen offset:0 lds
    s_add_u32 s30, s31, 32000
    buffer_load_dwordx4 v238, s[8:11], s30 offen offset:1024 lds
    s_add_u32 s30, s31, 63744
    buffer_load_dwordx4 v238, s[8:11], s30 offen offset:2048 lds
    s_add_u32 s30, s31, 95488
    buffer_load_dwordx4 v238, s[8:11], s30 offen offset:3072 lds
    s_waitcnt vmcnt(12)
    s_barrier
    s_add_u32 m0, s29, 147456
    s_add_u32 s31, s3, 7
    s_and_b32 s31, s31, 7
    s_lshl_b32 s31, s31, 7
    s_add_u32 s30, s31, 0
    buffer_load_dwordx4 v236, s[4:7], s30 offen offset:0 lds
    s_add_u32 s30, s31, 7168
    buffer_load_dwordx4 v237, s[4:7], s30 offen offset:1024 lds
    s_add_u32 s30, s31, 14336
    buffer_load_dwordx4 v236, s[4:7], s30 offen offset:2048 lds
    s_add_u32 s30, s31, 21504
    buffer_load_dwordx4 v237, s[4:7], s30 offen offset:3072 lds
    s_add_u32 m0, s29, 81920
    s_add_u32 s31, s3, 7
    s_and_b32 s31, s31, 7
    s_lshl_b32 s31, s31, 19
    s_add_u32 s30, s31, 256
    buffer_load_dwordx4 v238, s[8:11], s30 offen offset:0 lds
    s_add_u32 s30, s31, 32000
    buffer_load_dwordx4 v238, s[8:11], s30 offen offset:1024 lds
    s_add_u32 s30, s31, 63744
    buffer_load_dwordx4 v238, s[8:11], s30 offen offset:2048 lds
    s_add_u32 s30, s31, 95488
    buffer_load_dwordx4 v238, s[8:11], s30 offen offset:3072 lds
    s_waitcnt vmcnt(8)
    s_barrier
    s_add_u32 m0, s29, 32768
    s_add_u32 s30, s49, 0
    s_and_b32 s30, s30, 114688
    s_add_u32 s30, s30, 131072
    buffer_load_dwordx4 v30, s[16:19], s30 offen offset:0 nt lds
    buffer_load_dwordx4 v30, s[16:19], s30 offen offset:1024 nt lds
    buffer_load_dwordx4 v30, s[16:19], s30 offen offset:2048 nt lds
    buffer_load_dwordx4 v30, s[16:19], s30 offen offset:3072 nt lds
    s_add_u32 m0, s29, 49152
    s_add_u32 s30, s49, 32768
    s_and_b32 s30, s30, 114688
    s_add_u32 s30, s30, 131072
    buffer_load_dwordx4 v26, s[12:15], s30 offen offset:0 nt lds
    buffer_load_dwordx4 v27, s[12:15], s30 offen offset:1024 nt lds
    buffer_load_dwordx4 v28, s[12:15], s30 offen offset:2048 nt lds
    buffer_load_dwordx4 v29, s[12:15], s30 offen offset:3072 nt lds
    s_waitcnt vmcnt(8)
    s_barrier
    s_add_u32 m0, s29, 98304
    s_add_u32 s30, s49, 16384
    s_and_b32 s30, s30, 114688
    s_add_u32 s30, s30, 131072
    buffer_load_dwordx4 v30, s[16:19], s30 offen offset:0 nt lds
    buffer_load_dwordx4 v30, s[16:19], s30 offen offset:1024 nt lds
    buffer_load_dwordx4 v30, s[16:19], s30 offen offset:2048 nt lds
    buffer_load_dwordx4 v30, s[16:19], s30 offen offset:3072 nt lds
    s_add_u32 m0, s29, 65536
    s_add_u32 s30, s49, 49152
    s_and_b32 s30, s30, 114688
    s_add_u32 s30, s30, 131072
    buffer_load_dwordx4 v26, s[12:15], s30 offen offset:0 nt lds
    buffer_load_dwordx4 v27, s[12:15], s30 offen offset:1024 nt lds
    buffer_load_dwordx4 v28, s[12:15], s30 offen offset:2048 nt lds
    buffer_load_dwordx4 v29, s[12:15], s30 offen offset:3072 nt lds
    s_lshl_b32 s58, s47, 3
    s_add_u32 s58, s58, s34
    s_lshl_b32 s58, s58, 7
    s_add_u32 s58, s58, 101711872
    s_add_u32 s92, s52, s58
    s_addc_u32 s93, s53, 0
    s_load_dword s90, s[92:93], 0
    s_waitcnt lgkmcnt(0)
    s_xor_b32 s89, s90, 0x9e3779b9
    s_barrier
    ds_read_b128 v[112:115], v232 offset:0
    ds_read_b128 v[116:119], v232 offset:1024
    ds_read_b128 v[120:123], v232 offset:2048
    ds_read_b128 v[124:127], v232 offset:3072
    ds_read_b128 v[128:131], v232 offset:16384
    ds_read_b128 v[132:135], v232 offset:17408
    ds_read_b128 v[136:139], v232 offset:18432
    ds_read_b128 v[140:143], v232 offset:19456
    ds_read_b128 v[192:195], v2 offset:0
    ds_read_b128 v[196:199], v3 offset:0
    ds_read_b128 v[200:203], v4 offset:0
    ds_read_b128 v[204:207], v5 offset:0
    ds_read_b128 v[208:211], v6 offset:0
    s_waitcnt lgkmcnt(5)
    s_waitcnt lgkmcnt(3)
    v_mfma_f32_32x32x16_bf16 v[144:159], v[192:195], v[112:115], 0
    ds_read_b128 v[212:215], v7 offset:0
    v_mfma_f32_32x32x16_bf16 v[144:159], v[196:199], v[116:119], v[144:159]
    ds_read_b128 v[216:219], v8 offset:0
    s_waitcnt lgkmcnt(3)
    v_mfma_f32_32x32x16_bf16 v[144:159], v[200:203], v[120:123], v[144:159]
    ds_read_b128 v[220:223], v9 offset:0
    v_mfma_f32_32x32x16_bf16 v[144:159], v[204:207], v[124:127], v[144:159]
    ds_read_b128 v[192:195], v2 offset:8192
    s_waitcnt lgkmcnt(3)
    v_mfma_f32_32x32x16_bf16 v[144:159], v[208:211], v[128:131], v[144:159]
    ds_read_b128 v[196:199], v3 offset:8192
    v_mfma_f32_32x32x16_bf16 v[144:159], v[212:215], v[132:135], v[144:159]
    ds_read_b128 v[200:203], v4 offset:8192
    s_waitcnt lgkmcnt(3)
    v_mfma_f32_32x32x16_bf16 v[144:159], v[216:219], v[136:139], v[144:159]
    ds_read_b128 v[204:207], v5 offset:8192
    v_mfma_f32_32x32x16_bf16 v[144:159], v[220:223], v[140:143], v[144:159]
    ds_read_b128 v[208:211], v6 offset:8192
    s_nop 10
    v_max3_f32 v224, v144, v145, v146
    v_max3_f32 v226, v147, v148, v149
    v_max3_f32 v224, v224, v150, v151
    v_max3_f32 v226, v226, v152, v153
    v_max3_f32 v224, v224, v154, v155
    v_max3_f32 v226, v226, v156, v157
    v_max3_f32 v224, v224, v158, v159
    v_max_f32 v224, v224, v226
    v_mov_b32 v226, v224
    s_nop 1
    v_permlane32_swap_b32 v224, v226
    v_max_f32 v226, v226, v224
    v_mov_b32 v31, 0
    v_mov_b32 v225, 0
    v_sub_f32 v144, v144, v226
    v_sub_f32 v145, v145, v226
    v_sub_f32 v146, v146, v226
    v_sub_f32 v147, v147, v226
    v_sub_f32 v148, v148, v226
    v_sub_f32 v149, v149, v226
    v_sub_f32 v150, v150, v226
    v_sub_f32 v151, v151, v226
    v_sub_f32 v152, v152, v226
    v_sub_f32 v153, v153, v226
    v_sub_f32 v154, v154, v226
    v_sub_f32 v155, v155, v226
    v_sub_f32 v156, v156, v226
    v_sub_f32 v157, v157, v226
    v_sub_f32 v158, v158, v226
    v_sub_f32 v159, v159, v226
    v_sub_f32 v32, 0, v226
    v_sub_f32 v33, 0, v226
    v_sub_f32 v34, 0, v226
    v_sub_f32 v35, 0, v226
    v_sub_f32 v36, 0, v226
    v_sub_f32 v37, 0, v226
    v_sub_f32 v38, 0, v226
    v_sub_f32 v39, 0, v226
    v_sub_f32 v40, 0, v226
    v_sub_f32 v41, 0, v226
    v_sub_f32 v42, 0, v226
    v_sub_f32 v43, 0, v226
    v_sub_f32 v44, 0, v226
    v_sub_f32 v45, 0, v226
    v_sub_f32 v46, 0, v226
    v_sub_f32 v47, 0, v226
    s_waitcnt lgkmcnt(3)
    s_nop 0
    v_mfma_f32_32x32x16_bf16 v[160:175], v[192:195], v[112:115], v[32:47]
    ds_read_b128 v[212:215], v7 offset:8192
    v_exp_f32 v144, v144
    v_exp_f32 v145, v145
    v_exp_f32 v146, v146
    v_add_f32 v31, v31, v144
    v_exp_f32 v147, v147
    v_mfma_f32_32x32x16_bf16 v[160:175], v[196:199], v[116:119], v[160:175]
    ds_read_b128 v[216:219], v8 offset:8192
    v_add_f32 v225, v225, v145
    v_cvt_pk_bf16_f32 v176, v144, v145
    v_exp_f32 v148, v148
    v_add_f32 v31, v31, v146
    v_exp_f32 v149, v149
    s_waitcnt lgkmcnt(3)
    v_mfma_f32_32x32x16_bf16 v[160:175], v[200:203], v[120:123], v[160:175]
    ds_read_b128 v[220:223], v9 offset:8192
    v_add_f32 v225, v225, v147
    v_cvt_pk_bf16_f32 v177, v146, v147
    v_exp_f32 v150, v150
    v_add_f32 v31, v31, v148
    v_exp_f32 v151, v151
    v_mfma_f32_32x32x16_bf16 v[160:175], v[204:207], v[124:127], v[160:175]
    ds_read_b128 v[192:195], v2 offset:16384
    v_add_f32 v225, v225, v149
    v_cvt_pk_bf16_f32 v178, v148, v149
    v_exp_f32 v152, v152
    v_add_f32 v31, v31, v150
    v_exp_f32 v153, v153
    s_waitcnt lgkmcnt(3)
    v_mfma_f32_32x32x16_bf16 v[160:175], v[208:211], v[128:131], v[160:175]
    ds_read_b128 v[196:199], v3 offset:16384
    v_add_f32 v225, v225, v151
    v_cvt_pk_bf16_f32 v179, v150, v151
    v_exp_f32 v154, v154
    v_add_f32 v31, v31, v152
    v_exp_f32 v155, v155
    v_mfma_f32_32x32x16_bf16 v[160:175], v[212:215], v[132:135], v[160:175]
    ds_read_b128 v[200:203], v4 offset:16384
    v_add_f32 v225, v225, v153
    v_cvt_pk_bf16_f32 v180, v152, v153
    v_exp_f32 v156, v156
    v_add_f32 v31, v31, v154
    v_exp_f32 v157, v157
    s_waitcnt lgkmcnt(3)
    v_mfma_f32_32x32x16_bf16 v[160:175], v[216:219], v[136:139], v[160:175]
    ds_read_b128 v[204:207], v5 offset:16384
    v_add_f32 v225, v225, v155
    v_cvt_pk_bf16_f32 v181, v154, v155
    v_exp_f32 v158, v158
    v_add_f32 v31, v31, v156
    v_exp_f32 v159, v159
    v_mfma_f32_32x32x16_bf16 v[160:175], v[220:223], v[140:143], v[160:175]
    ds_read_b128 v[208:211], v6 offset:16384
    v_add_f32 v225, v225, v157
    v_cvt_pk_bf16_f32 v182, v156, v157
    v_add_f32 v31, v31, v158
    v_add_f32 v225, v225, v159
    v_cvt_pk_bf16_f32 v183, v158, v159
    s_waitcnt vmcnt(8)
    s_barrier
    s_nop 3
    v_max3_f32 v224, v160, v161, v162
    v_max3_f32 v226, v163, v164, v165
    v_max3_f32 v224, v224, v166, v167
    v_max3_f32 v226, v226, v168, v169
    v_max3_f32 v224, v224, v170, v171
    v_max3_f32 v226, v226, v172, v173
    v_max3_f32 v224, v224, v174, v175
    v_max_f32 v224, v224, v226
    v_cmp_lt_f32 vcc, s32, v224
    s_cbranch_vccnz SLOW_0_1
BACK_0_1:
    s_waitcnt lgkmcnt(3)
    v_mfma_f32_32x32x16_bf16 v[144:159], v[192:195], v[112:115], v[32:47]
    ds_read_b128 v[212:215], v7 offset:16384
    v_exp_f32 v160, v160
    v_exp_f32 v161, v161
    v_exp_f32 v162, v162
    v_add_f32 v31, v31, v160
    v_mfma_f32_32x32x16_bf16 v[144:159], v[196:199], v[116:119], v[144:159]
    ds_read_b128 v[216:219], v8 offset:16384
    v_exp_f32 v163, v163
    v_add_f32 v225, v225, v161
    v_cvt_pk_bf16_f32 v184, v160, v161
    s_waitcnt lgkmcnt(3)
    v_mfma_f32_32x32x16_bf16 v[144:159], v[200:203], v[120:123], v[144:159]
    ds_read_b128 v[220:223], v9 offset:16384
    v_exp_f32 v164, v164
    v_add_f32 v31, v31, v162
    v_exp_f32 v165, v165
    v_mfma_f32_32x32x16_bf16 v[144:159], v[204:207], v[124:127], v[144:159]
    ds_read_b64_tr_b16 v[192:193], v18 offset:32768
    ds_read_b64_tr_b16 v[194:195], v18 offset:34816
    v_add_f32 v225, v225, v163
    v_cvt_pk_bf16_f32 v185, v162, v163
    v_exp_f32 v166, v166
    s_waitcnt lgkmcnt(4)
    v_mfma_f32_32x32x16_bf16 v[144:159], v[208:211], v[128:131], v[144:159]
    ds_read_b64_tr_b16 v[196:197], v19 offset:32768
    ds_read_b64_tr_b16 v[198:199], v19 offset:34816
    v_add_f32 v31, v31, v164
    v_exp_f32 v167, v167
    v_add_f32 v225, v225, v165
    v_mfma_f32_32x32x16_bf16 v[144:159], v[212:215], v[132:135], v[144:159]
    ds_read_b64_tr_b16 v[200:201], v20 offset:32768
    ds_read_b64_tr_b16 v[202:203], v20 offset:34816
    v_cvt_pk_bf16_f32 v186, v164, v165
    v_exp_f32 v168, v168
    v_add_f32 v31, v31, v166
    s_waitcnt lgkmcnt(6)
    v_mfma_f32_32x32x16_bf16 v[144:159], v[216:219], v[136:139], v[144:159]
    ds_read_b64_tr_b16 v[204:205], v21 offset:32768
    ds_read_b64_tr_b16 v[206:207], v21 offset:34816
    v_exp_f32 v169, v169
    v_add_f32 v225, v225, v167
    v_cvt_pk_bf16_f32 v187, v166, v167
    v_mfma_f32_32x32x16_bf16 v[144:159], v[220:223], v[140:143], v[144:159]
    ds_read_b64_tr_b16 v[208:209], v18 offset:36864
    ds_read_b64_tr_b16 v[210:211], v18 offset:38912
    v_exp_f32 v170, v170
    v_add_f32 v31, v31, v168
    v_exp_f32 v171, v171
    s_waitcnt lgkmcnt(6)
    v_mfma_f32_32x32x16_bf16 v[48:63], v[192:195], v[176:179], 0
    ds_read_b64_tr_b16 v[212:213], v19 offset:36864
    ds_read_b64_tr_b16 v[214:215], v19 offset:38912
    v_add_f32 v225, v225, v169
    v_cvt_pk_bf16_f32 v188, v168, v169
    v_exp_f32 v172, v172
    v_mfma_f32_32x32x16_bf16 v[64:79], v[196:199], v[176:179], 0
    ds_read_b64_tr_b16 v[216:217], v20 offset:36864
    ds_read_b64_tr_b16 v[218:219], v20 offset:38912
    v_add_f32 v31, v31, v170
    v_exp_f32 v173, v173
    v_add_f32 v225, v225, v171
    s_waitcnt lgkmcnt(6)
    v_mfma_f32_32x32x16_bf16 v[80:95], v[200:203], v[176:179], 0
    ds_read_b64_tr_b16 v[220:221], v21 offset:36864
    ds_read_b64_tr_b16 v[222:223], v21 offset:38912
    v_cvt_pk_bf16_f32 v189, v170, v171
    v_exp_f32 v174, v174
    v_add_f32 v31, v31, v172
    v_mfma_f32_32x32x16_bf16 v[96:111], v[204:207], v[176:179], 0
    ds_read_b128 v[192:195], v2 offset:24576
    v_exp_f32 v175, v175
    v_add_f32 v225, v225, v173
    v_cvt_pk_bf16_f32 v190, v172, v173
    s_waitcnt lgkmcnt(5)
    v_mfma_f32_32x32x16_bf16 v[48:63], v[208:211], v[180:183], v[48:63]
    ds_read_b128 v[196:199], v3 offset:24576
    v_add_f32 v31, v31, v174
    v_add_f32 v225, v225, v175
    v_cvt_pk_bf16_f32 v191, v174, v175
    v_mfma_f32_32x32x16_bf16 v[64:79], v[212:215], v[180:183], v[64:79]
    ds_read_b128 v[200:203], v4 offset:24576
    v_max3_f32 v224, v144, v145, v146
    v_max3_f32 v226, v147, v148, v149
    v_max3_f32 v224, v224, v150, v151
    s_waitcnt lgkmcnt(3)
    v_mfma_f32_32x32x16_bf16 v[80:95], v[216:219], v[180:183], v[80:95]
    ds_read_b128 v[204:207], v5 offset:24576
    v_max3_f32 v226, v226, v152, v153
    v_max3_f32 v224, v224, v154, v155
    v_max3_f32 v226, v226, v156, v157
    v_mfma_f32_32x32x16_bf16 v[96:111], v[220:223], v[180:183], v[96:111]
    ds_read_b128 v[208:211], v6 offset:24576
    v_max3_f32 v224, v224, v158, v159
    v_max_f32 v224, v224, v226
    v_cmp_lt_f32 vcc, s32, v224
    s_cbranch_vccnz SLOW_0_2
BACK_0_2:
    s_waitcnt lgkmcnt(3)
    v_mfma_f32_32x32x16_bf16 v[160:175], v[192:195], v[112:115], v[32:47]
    ds_read_b128 v[212:215], v7 offset:24576
    v_exp_f32 v144, v144
    v_exp_f32 v145, v145
    v_exp_f32 v146, v146
    v_add_f32 v31, v31, v144
    v_mfma_f32_32x32x16_bf16 v[160:175], v[196:199], v[116:119], v[160:175]
    ds_read_b128 v[216:219], v8 offset:24576
    v_exp_f32 v147, v147
    v_add_f32 v225, v225, v145
    v_cvt_pk_bf16_f32 v176, v144, v145
    s_waitcnt lgkmcnt(3)
    v_mfma_f32_32x32x16_bf16 v[160:175], v[200:203], v[120:123], v[160:175]
    ds_read_b128 v[220:223], v9 offset:24576
    v_exp_f32 v148, v148
    v_add_f32 v31, v31, v146
    v_exp_f32 v149, v149
    v_mfma_f32_32x32x16_bf16 v[160:175], v[204:207], v[124:127], v[160:175]
    ds_read_b64_tr_b16 v[192:193], v18 offset:40960
    ds_read_b64_tr_b16 v[194:195], v18 offset:43008
    v_add_f32 v225, v225, v147
    v_cvt_pk_bf16_f32 v177, v146, v147
    v_exp_f32 v150, v150
    s_waitcnt lgkmcnt(4)
    v_mfma_f32_32x32x16_bf16 v[160:175], v[208:211], v[128:131], v[160:175]
    ds_read_b64_tr_b16 v[196:197], v19 offset:40960
    ds_read_b64_tr_b16 v[198:199], v19 offset:43008
    v_add_f32 v31, v31, v148
    v_exp_f32 v151, v151
    v_add_f32 v225, v225, v149
    v_mfma_f32_32x32x16_bf16 v[160:175], v[212:215], v[132:135], v[160:175]
    ds_read_b64_tr_b16 v[200:201], v20 offset:40960
    ds_read_b64_tr_b16 v[202:203], v20 offset:43008
    v_cvt_pk_bf16_f32 v178, v148, v149
    v_exp_f32 v152, v152
    v_add_f32 v31, v31, v150
    s_waitcnt lgkmcnt(6)
    v_mfma_f32_32x32x16_bf16 v[160:175], v[216:219], v[136:139], v[160:175]
    ds_read_b64_tr_b16 v[204:205], v21 offset:40960
    ds_read_b64_tr_b16 v[206:207], v21 offset:43008
    v_exp_f32 v153, v153
    v_add_f32 v225, v225, v151
    v_cvt_pk_bf16_f32 v179, v150, v151
    v_mfma_f32_32x32x16_bf16 v[160:175], v[220:223], v[140:143], v[160:175]
    ds_read_b64_tr_b16 v[208:209], v18 offset:45056
    ds_read_b64_tr_b16 v[210:211], v18 offset:47104
    v_exp_f32 v154, v154
    v_add_f32 v31, v31, v152
    v_exp_f32 v155, v155
    s_waitcnt lgkmcnt(6)
    v_mfma_f32_32x32x16_bf16 v[48:63], v[192:195], v[184:187], v[48:63]
    ds_read_b64_tr_b16 v[212:213], v19 offset:45056
    ds_read_b64_tr_b16 v[214:215], v19 offset:47104
    v_add_f32 v225, v225, v153
    v_cvt_pk_bf16_f32 v180, v152, v153
    v_exp_f32 v156, v156
    v_mfma_f32_32x32x16_bf16 v[64:79], v[196:199], v[184:187], v[64:79]
    ds_read_b64_tr_b16 v[216:217], v20 offset:45056
    ds_read_b64_tr_b16 v[218:219], v20 offset:47104
    v_add_f32 v31, v31, v154
    v_exp_f32 v157, v157
    v_add_f32 v225, v225, v155
    s_waitcnt lgkmcnt(6)
    v_mfma_f32_32x32x16_bf16 v[80:95], v[200:203], v[184:187], v[80:95]
    ds_read_b64_tr_b16 v[220:221], v21 offset:45056
    ds_read_b64_tr_b16 v[222:223], v21 offset:47104
    v_cvt_pk_bf16_f32 v181, v154, v155
    v_exp_f32 v158, v158
    v_add_f32 v31, v31, v156
    v_mfma_f32_32x32x16_bf16 v[96:111], v[204:207], v[184:187], v[96:111]
    ds_read_b128 v[192:195], v2 offset:49152
    v_exp_f32 v159, v159
    v_add_f32 v225, v225, v157
    v_cvt_pk_bf16_f32 v182, v156, v157
    s_waitcnt lgkmcnt(5)
    v_mfma_f32_32x32x16_bf16 v[48:63], v[208:211], v[188:191], v[48:63]
    ds_read_b128 v[196:199], v3 offset:49152
    v_add_f32 v31, v31, v158
    v_add_f32 v225, v225, v159
    v_cvt_pk_bf16_f32 v183, v158, v159
    v_mfma_f32_32x32x16_bf16 v[64:79], v[212:215], v[188:191], v[64:79]
    ds_read_b128 v[200:203], v4 offset:49152
    v_max3_f32 v224, v160, v161, v162
    v_max3_f32 v226, v163, v164, v165
    v_max3_f32 v224, v224, v166, v167
    s_waitcnt lgkmcnt(3)
    v_mfma_f32_32x32x16_bf16 v[80:95], v[216:219], v[188:191], v[80:95]
    ds_read_b128 v[204:207], v5 offset:49152
    v_max3_f32 v226, v226, v168, v169
    v_max3_f32 v224, v224, v170, v171
    v_max3_f32 v226, v226, v172, v173
    v_mfma_f32_32x32x16_bf16 v[96:111], v[220:223], v[188:191], v[96:111]
    ds_read_b128 v[208:211], v6 offset:49152
    v_max3_f32 v224, v224, v174, v175
    v_max_f32 v224, v224, v226
    v_cmp_lt_f32 vcc, s32, v224
    s_waitcnt vmcnt(0)
    s_barrier
    s_cbranch_vccnz SLOW_0_3
BACK_0_3:
    s_waitcnt lgkmcnt(3)
    v_mfma_f32_32x32x16_bf16 v[144:159], v[192:195], v[112:115], v[32:47]
    ds_read_b128 v[212:215], v7 offset:49152
    v_exp_f32 v160, v160
    v_exp_f32 v161, v161
    v_exp_f32 v162, v162
    v_add_f32 v31, v31, v160
    v_mfma_f32_32x32x16_bf16 v[144:159], v[196:199], v[116:119], v[144:159]
    ds_read_b128 v[216:219], v8 offset:49152
    v_exp_f32 v163, v163
    v_add_f32 v225, v225, v161
    v_cvt_pk_bf16_f32 v184, v160, v161
    s_waitcnt lgkmcnt(3)
    v_mfma_f32_32x32x16_bf16 v[144:159], v[200:203], v[120:123], v[144:159]
    ds_read_b128 v[220:223], v9 offset:49152
    v_exp_f32 v164, v164
    v_add_f32 v31, v31, v162
    v_exp_f32 v165, v165
    v_mfma_f32_32x32x16_bf16 v[144:159], v[204:207], v[124:127], v[144:159]
    ds_read_b64_tr_b16 v[192:193], v22 offset:32768
    ds_read_b64_tr_b16 v[194:195], v22 offset:34816
    v_add_f32 v225, v225, v163
    v_cvt_pk_bf16_f32 v185, v162, v163
    v_exp_f32 v166, v166
    s_waitcnt lgkmcnt(4)
    v_mfma_f32_32x32x16_bf16 v[144:159], v[208:211], v[128:131], v[144:159]
    ds_read_b64_tr_b16 v[196:197], v23 offset:32768
    ds_read_b64_tr_b16 v[198:199], v23 offset:34816
    v_add_f32 v31, v31, v164
    v_exp_f32 v167, v167
    v_add_f32 v225, v225, v165
    v_mfma_f32_32x32x16_bf16 v[144:159], v[212:215], v[132:135], v[144:159]
    ds_read_b64_tr_b16 v[200:201], v24 offset:32768
    ds_read_b64_tr_b16 v[202:203], v24 offset:34816
    v_cvt_pk_bf16_f32 v186, v164, v165
    v_exp_f32 v168, v168
    v_add_f32 v31, v31, v166
    s_waitcnt lgkmcnt(6)
    v_mfma_f32_32x32x16_bf16 v[144:159], v[216:219], v[136:139], v[144:159]
    ds_read_b64_tr_b16 v[204:205], v25 offset:32768
    ds_read_b64_tr_b16 v[206:207], v25 offset:34816
    v_exp_f32 v169, v169
    v_add_f32 v225, v225, v167
    v_cvt_pk_bf16_f32 v187, v166, v167
    v_mfma_f32_32x32x16_bf16 v[144:159], v[220:223], v[140:143], v[144:159]
    ds_read_b64_tr_b16 v[208:209], v22 offset:36864
    ds_read_b64_tr_b16 v[210:211], v22 offset:38912
    v_exp_f32 v170, v170
    v_add_f32 v31, v31, v168
    v_exp_f32 v171, v171
    s_waitcnt lgkmcnt(6)
    v_mfma_f32_32x32x16_bf16 v[48:63], v[192:195], v[176:179], v[48:63]
    ds_read_b64_tr_b16 v[212:213], v23 offset:36864
    ds_read_b64_tr_b16 v[214:215], v23 offset:38912
    v_add_f32 v225, v225, v169
    v_cvt_pk_bf16_f32 v188, v168, v169
    v_exp_f32 v172, v172
    v_mfma_f32_32x32x16_bf16 v[64:79], v[196:199], v[176:179], v[64:79]
    ds_read_b64_tr_b16 v[216:217], v24 offset:36864
    ds_read_b64_tr_b16 v[218:219], v24 offset:38912
    v_add_f32 v31, v31, v170
    v_exp_f32 v173, v173
    v_add_f32 v225, v225, v171
    s_waitcnt lgkmcnt(6)
    v_mfma_f32_32x32x16_bf16 v[80:95], v[200:203], v[176:179], v[80:95]
    ds_read_b64_tr_b16 v[220:221], v25 offset:36864
    ds_read_b64_tr_b16 v[222:223], v25 offset:38912
    v_cvt_pk_bf16_f32 v189, v170, v171
    v_exp_f32 v174, v174
    v_add_f32 v31, v31, v172
    v_mfma_f32_32x32x16_bf16 v[96:111], v[204:207], v[176:179], v[96:111]
    ds_read_b128 v[192:195], v2 offset:57344
    v_exp_f32 v175, v175
    v_add_f32 v225, v225, v173
    v_cvt_pk_bf16_f32 v190, v172, v173
    s_waitcnt lgkmcnt(5)
    v_mfma_f32_32x32x16_bf16 v[48:63], v[208:211], v[180:183], v[48:63]
    ds_read_b128 v[196:199], v3 offset:57344
    v_add_f32 v31, v31, v174
    v_add_f32 v225, v225, v175
    v_cvt_pk_bf16_f32 v191, v174, v175
    v_mfma_f32_32x32x16_bf16 v[64:79], v[212:215], v[180:183], v[64:79]
    ds_read_b128 v[200:203], v4 offset:57344
    v_max3_f32 v224, v144, v145, v146
    v_max3_f32 v226, v147, v148, v149
    v_max3_f32 v224, v224, v150, v151
    s_waitcnt lgkmcnt(3)
    v_mfma_f32_32x32x16_bf16 v[80:95], v[216:219], v[180:183], v[80:95]
    ds_read_b128 v[204:207], v5 offset:57344
    v_max3_f32 v226, v226, v152, v153
    v_max3_f32 v224, v224, v154, v155
    v_max3_f32 v226, v226, v156, v157
    v_mfma_f32_32x32x16_bf16 v[96:111], v[220:223], v[180:183], v[96:111]
    ds_read_b128 v[208:211], v6 offset:57344
    v_max3_f32 v224, v224, v158, v159
    v_max_f32 v224, v224, v226
    v_cmp_lt_f32 vcc, s32, v224
    s_cbranch_vccnz SLOW_0_4
BACK_0_4:
    s_waitcnt lgkmcnt(3)
    v_mfma_f32_32x32x16_bf16 v[160:175], v[192:195], v[112:115], v[32:47]
    ds_read_b128 v[212:215], v7 offset:57344
    v_exp_f32 v144, v144
    v_exp_f32 v145, v145
    v_exp_f32 v146, v146
    v_add_f32 v31, v31, v144
    v_mfma_f32_32x32x16_bf16 v[160:175], v[196:199], v[116:119], v[160:175]
    ds_read_b128 v[216:219], v8 offset:57344
    v_exp_f32 v147, v147
    v_add_f32 v225, v225, v145
    v_cvt_pk_bf16_f32 v176, v144, v145
    s_waitcnt lgkmcnt(3)
    v_mfma_f32_32x32x16_bf16 v[160:175], v[200:203], v[120:123], v[160:175]
    ds_read_b128 v[220:223], v9 offset:57344
    v_exp_f32 v148, v148
    v_add_f32 v31, v31, v146
    v_exp_f32 v149, v149
    v_mfma_f32_32x32x16_bf16 v[160:175], v[204:207], v[124:127], v[160:175]
    ds_read_b64_tr_b16 v[192:193], v22 offset:40960
    ds_read_b64_tr_b16 v[194:195], v22 offset:43008
    v_add_f32 v225, v225, v147
    v_cvt_pk_bf16_f32 v177, v146, v147
    v_exp_f32 v150, v150
    s_waitcnt lgkmcnt(4)
    v_mfma_f32_32x32x16_bf16 v[160:175], v[208:211], v[128:131], v[160:175]
    ds_read_b64_tr_b16 v[196:197], v23 offset:40960
    ds_read_b64_tr_b16 v[198:199], v23 offset:43008
    v_add_f32 v31, v31, v148
    v_exp_f32 v151, v151
    v_add_f32 v225, v225, v149
    v_mfma_f32_32x32x16_bf16 v[160:175], v[212:215], v[132:135], v[160:175]
    ds_read_b64_tr_b16 v[200:201], v24 offset:40960
    ds_read_b64_tr_b16 v[202:203], v24 offset:43008
    v_cvt_pk_bf16_f32 v178, v148, v149
    v_exp_f32 v152, v152
    v_add_f32 v31, v31, v150
    s_waitcnt lgkmcnt(6)
    v_mfma_f32_32x32x16_bf16 v[160:175], v[216:219], v[136:139], v[160:175]
    ds_read_b64_tr_b16 v[204:205], v25 offset:40960
    ds_read_b64_tr_b16 v[206:207], v25 offset:43008
    v_exp_f32 v153, v153
    v_add_f32 v225, v225, v151
    v_cvt_pk_bf16_f32 v179, v150, v151
    v_mfma_f32_32x32x16_bf16 v[160:175], v[220:223], v[140:143], v[160:175]
    ds_read_b64_tr_b16 v[208:209], v22 offset:45056
    ds_read_b64_tr_b16 v[210:211], v22 offset:47104
    v_exp_f32 v154, v154
    v_add_f32 v31, v31, v152
    v_exp_f32 v155, v155
    s_waitcnt lgkmcnt(6)
    v_mfma_f32_32x32x16_bf16 v[48:63], v[192:195], v[184:187], v[48:63]
    ds_read_b64_tr_b16 v[212:213], v23 offset:45056
    ds_read_b64_tr_b16 v[214:215], v23 offset:47104
    v_add_f32 v225, v225, v153
    v_cvt_pk_bf16_f32 v180, v152, v153
    v_exp_f32 v156, v156
    v_mfma_f32_32x32x16_bf16 v[64:79], v[196:199], v[184:187], v[64:79]
    ds_read_b64_tr_b16 v[216:217], v24 offset:45056
    ds_read_b64_tr_b16 v[218:219], v24 offset:47104
    v_add_f32 v31, v31, v154
    v_exp_f32 v157, v157
    v_add_f32 v225, v225, v155
    s_waitcnt lgkmcnt(6)
    v_mfma_f32_32x32x16_bf16 v[80:95], v[200:203], v[184:187], v[80:95]
    ds_read_b64_tr_b16 v[220:221], v25 offset:45056
    ds_read_b64_tr_b16 v[222:223], v25 offset:47104
    v_cvt_pk_bf16_f32 v181, v154, v155
    v_exp_f32 v158, v158
    v_add_f32 v31, v31, v156
    v_mfma_f32_32x32x16_bf16 v[96:111], v[204:207], v[184:187], v[96:111]
    ds_read_b128 v[192:195], v10 offset:0
    v_exp_f32 v159, v159
    v_add_f32 v225, v225, v157
    v_cvt_pk_bf16_f32 v182, v156, v157
    s_waitcnt lgkmcnt(5)
    v_mfma_f32_32x32x16_bf16 v[48:63], v[208:211], v[188:191], v[48:63]
    ds_read_b128 v[196:199], v11 offset:0
    v_add_f32 v31, v31, v158
    v_add_f32 v225, v225, v159
    v_cvt_pk_bf16_f32 v183, v158, v159
    v_mfma_f32_32x32x16_bf16 v[64:79], v[212:215], v[188:191], v[64:79]
    ds_read_b128 v[200:203], v12 offset:0
    v_max3_f32 v224, v160, v161, v162
    v_max3_f32 v226, v163, v164, v165
    v_max3_f32 v224, v224, v166, v167
    s_waitcnt lgkmcnt(3)
    v_mfma_f32_32x32x16_bf16 v[80:95], v[216:219], v[188:191], v[80:95]
    ds_read_b128 v[204:207], v13 offset:0
    v_max3_f32 v226, v226, v168, v169
    v_max3_f32 v224, v224, v170, v171
    v_max3_f32 v226, v226, v172, v173
    v_mfma_f32_32x32x16_bf16 v[96:111], v[220:223], v[188:191], v[96:111]
    ds_read_b128 v[208:211], v14 offset:0
    v_max3_f32 v224, v224, v174, v175
    v_max_f32 v224, v224, v226
    v_cmp_lt_f32 vcc, s32, v224
    s_barrier
    s_cbranch_vccnz SLOW_0_5
BACK_0_5:
    s_waitcnt lgkmcnt(3)
    v_mfma_f32_32x32x16_bf16 v[144:159], v[192:195], v[112:115], v[32:47]
    ds_read_b128 v[212:215], v15 offset:0
    v_exp_f32 v160, v160
    v_exp_f32 v161, v161
    v_exp_f32 v162, v162
    v_add_f32 v31, v31, v160
    v_mfma_f32_32x32x16_bf16 v[144:159], v[196:199], v[116:119], v[144:159]
    ds_read_b128 v[216:219], v16 offset:0
    v_exp_f32 v163, v163
    v_add_f32 v225, v225, v161
    v_cvt_pk_bf16_f32 v184, v160, v161
    s_waitcnt lgkmcnt(3)
    v_mfma_f32_32x32x16_bf16 v[144:159], v[200:203], v[120:123], v[144:159]
    ds_read_b128 v[220:223], v17 offset:0
    v_exp_f32 v164, v164
    v_add_f32 v31, v31, v162
    v_exp_f32 v165, v165
    v_mfma_f32_32x32x16_bf16 v[144:159], v[204:207], v[124:127], v[144:159]
    ds_read_b64_tr_b16 v[192:193], v22 offset:16384
    ds_read_b64_tr_b16 v[194:195], v22 offset:18432
    v_add_f32 v225, v225, v163
    v_cvt_pk_bf16_f32 v185, v162, v163
    v_exp_f32 v166, v166
    s_waitcnt lgkmcnt(4)
    v_mfma_f32_32x32x16_bf16 v[144:159], v[208:211], v[128:131], v[144:159]
    ds_read_b64_tr_b16 v[196:197], v23 offset:16384
    ds_read_b64_tr_b16 v[198:199], v23 offset:18432
    v_add_f32 v31, v31, v164
    v_exp_f32 v167, v167
    v_add_f32 v225, v225, v165
    v_mfma_f32_32x32x16_bf16 v[144:159], v[212:215], v[132:135], v[144:159]
    ds_read_b64_tr_b16 v[200:201], v24 offset:16384
    ds_read_b64_tr_b16 v[202:203], v24 offset:18432
    v_cvt_pk_bf16_f32 v186, v164, v165
    v_exp_f32 v168, v168
    v_add_f32 v31, v31, v166
    s_waitcnt lgkmcnt(6)
    v_mfma_f32_32x32x16_bf16 v[144:159], v[216:219], v[136:139], v[144:159]
    ds_read_b64_tr_b16 v[204:205], v25 offset:16384
    ds_read_b64_tr_b16 v[206:207], v25 offset:18432
    v_exp_f32 v169, v169
    v_add_f32 v225, v225, v167
    v_cvt_pk_bf16_f32 v187, v166, v167
    v_mfma_f32_32x32x16_bf16 v[144:159], v[220:223], v[140:143], v[144:159]
    ds_read_b64_tr_b16 v[208:209], v22 offset:20480
    ds_read_b64_tr_b16 v[210:211], v22 offset:22528
    v_exp_f32 v170, v170
    v_add_f32 v31, v31, v168
    v_exp_f32 v171, v171
    s_waitcnt lgkmcnt(6)
    v_mfma_f32_32x32x16_bf16 v[48:63], v[192:195], v[176:179], v[48:63]
    ds_read_b64_tr_b16 v[212:213], v23 offset:20480
    ds_read_b64_tr_b16 v[214:215], v23 offset:22528
    v_add_f32 v225, v225, v169
    v_cvt_pk_bf16_f32 v188, v168, v169
    v_exp_f32 v172, v172
    v_mfma_f32_32x32x16_bf16 v[64:79], v[196:199], v[176:179], v[64:79]
    ds_read_b64_tr_b16 v[216:217], v24 offset:20480
    ds_read_b64_tr_b16 v[218:219], v24 offset:22528
    v_add_f32 v31, v31, v170
    v_exp_f32 v173, v173
    v_add_f32 v225, v225, v171
    s_waitcnt lgkmcnt(6)
    v_mfma_f32_32x32x16_bf16 v[80:95], v[200:203], v[176:179], v[80:95]
    ds_read_b64_tr_b16 v[220:221], v25 offset:20480
    ds_read_b64_tr_b16 v[222:223], v25 offset:22528
    v_cvt_pk_bf16_f32 v189, v170, v171
    v_exp_f32 v174, v174
    v_add_f32 v31, v31, v172
    v_mfma_f32_32x32x16_bf16 v[96:111], v[204:207], v[176:179], v[96:111]
    ds_read_b128 v[192:195], v10 offset:8192
    v_exp_f32 v175, v175
    v_add_f32 v225, v225, v173
    v_cvt_pk_bf16_f32 v190, v172, v173
    s_waitcnt lgkmcnt(5)
    v_mfma_f32_32x32x16_bf16 v[48:63], v[208:211], v[180:183], v[48:63]
    ds_read_b128 v[196:199], v11 offset:8192
    v_add_f32 v31, v31, v174
    v_add_f32 v225, v225, v175
    v_cvt_pk_bf16_f32 v191, v174, v175
    v_mfma_f32_32x32x16_bf16 v[64:79], v[212:215], v[180:183], v[64:79]
    ds_read_b128 v[200:203], v12 offset:8192
    v_max3_f32 v224, v144, v145, v146
    v_max3_f32 v226, v147, v148, v149
    v_max3_f32 v224, v224, v150, v151
    s_waitcnt lgkmcnt(3)
    v_mfma_f32_32x32x16_bf16 v[80:95], v[216:219], v[180:183], v[80:95]
    ds_read_b128 v[204:207], v13 offset:8192
    v_max3_f32 v226, v226, v152, v153
    v_max3_f32 v224, v224, v154, v155
    v_max3_f32 v226, v226, v156, v157
    v_mfma_f32_32x32x16_bf16 v[96:111], v[220:223], v[180:183], v[96:111]
    ds_read_b128 v[208:211], v14 offset:8192
    v_max3_f32 v224, v224, v158, v159
    v_max_f32 v224, v224, v226
    v_cmp_lt_f32 vcc, s32, v224
    s_cbranch_vccnz SLOW_0_6
BACK_0_6:
    s_waitcnt lgkmcnt(3)
    v_mfma_f32_32x32x16_bf16 v[160:175], v[192:195], v[112:115], v[32:47]
    ds_read_b128 v[212:215], v15 offset:8192
    v_exp_f32 v144, v144
    v_exp_f32 v145, v145
    v_exp_f32 v146, v146
    v_add_f32 v31, v31, v144
    v_mfma_f32_32x32x16_bf16 v[160:175], v[196:199], v[116:119], v[160:175]
    ds_read_b128 v[216:219], v16 offset:8192
    v_exp_f32 v147, v147
    v_add_f32 v225, v225, v145
    v_cvt_pk_bf16_f32 v176, v144, v145
    s_waitcnt lgkmcnt(3)
    v_mfma_f32_32x32x16_bf16 v[160:175], v[200:203], v[120:123], v[160:175]
    ds_read_b128 v[220:223], v17 offset:8192
    v_exp_f32 v148, v148
    v_add_f32 v31, v31, v146
    v_exp_f32 v149, v149
    v_mfma_f32_32x32x16_bf16 v[160:175], v[204:207], v[124:127], v[160:175]
    ds_read_b64_tr_b16 v[192:193], v22 offset:24576
    ds_read_b64_tr_b16 v[194:195], v22 offset:26624
    v_add_f32 v225, v225, v147
    v_cvt_pk_bf16_f32 v177, v146, v147
    v_exp_f32 v150, v150
    s_waitcnt lgkmcnt(4)
    v_mfma_f32_32x32x16_bf16 v[160:175], v[208:211], v[128:131], v[160:175]
    ds_read_b64_tr_b16 v[196:197], v23 offset:24576
    ds_read_b64_tr_b16 v[198:199], v23 offset:26624
    v_add_f32 v31, v31, v148
    v_exp_f32 v151, v151
    v_add_f32 v225, v225, v149
    v_mfma_f32_32x32x16_bf16 v[160:175], v[212:215], v[132:135], v[160:175]
    ds_read_b64_tr_b16 v[200:201], v24 offset:24576
    ds_read_b64_tr_b16 v[202:203], v24 offset:26624
    v_cvt_pk_bf16_f32 v178, v148, v149
    v_exp_f32 v152, v152
    v_add_f32 v31, v31, v150
    s_waitcnt lgkmcnt(6)
    v_mfma_f32_32x32x16_bf16 v[160:175], v[216:219], v[136:139], v[160:175]
    ds_read_b64_tr_b16 v[204:205], v25 offset:24576
    ds_read_b64_tr_b16 v[206:207], v25 offset:26624
    v_exp_f32 v153, v153
    v_add_f32 v225, v225, v151
    v_cvt_pk_bf16_f32 v179, v150, v151
    v_mfma_f32_32x32x16_bf16 v[160:175], v[220:223], v[140:143], v[160:175]
    ds_read_b64_tr_b16 v[208:209], v22 offset:28672
    ds_read_b64_tr_b16 v[210:211], v22 offset:30720
    v_exp_f32 v154, v154
    v_add_f32 v31, v31, v152
    v_exp_f32 v155, v155
    s_waitcnt lgkmcnt(6)
    v_mfma_f32_32x32x16_bf16 v[48:63], v[192:195], v[184:187], v[48:63]
    ds_read_b64_tr_b16 v[212:213], v23 offset:28672
    ds_read_b64_tr_b16 v[214:215], v23 offset:30720
    v_add_f32 v225, v225, v153
    v_cvt_pk_bf16_f32 v180, v152, v153
    v_exp_f32 v156, v156
    v_mfma_f32_32x32x16_bf16 v[64:79], v[196:199], v[184:187], v[64:79]
    ds_read_b64_tr_b16 v[216:217], v24 offset:28672
    ds_read_b64_tr_b16 v[218:219], v24 offset:30720
    v_add_f32 v31, v31, v154
    v_exp_f32 v157, v157
    v_add_f32 v225, v225, v155
    s_waitcnt lgkmcnt(6)
    v_mfma_f32_32x32x16_bf16 v[80:95], v[200:203], v[184:187], v[80:95]
    ds_read_b64_tr_b16 v[220:221], v25 offset:28672
    ds_read_b64_tr_b16 v[222:223], v25 offset:30720
    v_cvt_pk_bf16_f32 v181, v154, v155
    v_exp_f32 v158, v158
    v_add_f32 v31, v31, v156
    v_mfma_f32_32x32x16_bf16 v[96:111], v[204:207], v[184:187], v[96:111]
    ds_read_b128 v[192:195], v2 offset:0
    v_exp_f32 v159, v159
    v_add_f32 v225, v225, v157
    v_cvt_pk_bf16_f32 v182, v156, v157
    s_waitcnt lgkmcnt(5)
    v_mfma_f32_32x32x16_bf16 v[48:63], v[208:211], v[188:191], v[48:63]
    ds_read_b128 v[196:199], v3 offset:0
    v_add_f32 v31, v31, v158
    v_add_f32 v225, v225, v159
    v_cvt_pk_bf16_f32 v183, v158, v159
    v_mfma_f32_32x32x16_bf16 v[64:79], v[212:215], v[188:191], v[64:79]
    ds_read_b128 v[200:203], v4 offset:0
    v_max3_f32 v224, v160, v161, v162
    v_max3_f32 v226, v163, v164, v165
    v_max3_f32 v224, v224, v166, v167
    s_waitcnt lgkmcnt(3)
    v_mfma_f32_32x32x16_bf16 v[80:95], v[216:219], v[188:191], v[80:95]
    ds_read_b128 v[204:207], v5 offset:0
    v_max3_f32 v226, v226, v168, v169
    v_max3_f32 v224, v224, v170, v171
    v_max3_f32 v226, v226, v172, v173
    v_mfma_f32_32x32x16_bf16 v[96:111], v[220:223], v[188:191], v[96:111]
    ds_read_b128 v[208:211], v6 offset:0
    v_max3_f32 v224, v224, v174, v175
    v_max_f32 v224, v224, v226
    v_cmp_lt_f32 vcc, s32, v224
    s_barrier
    s_cbranch_vccnz SLOW_0_7
BACK_0_7:
    s_waitcnt lgkmcnt(3)
    v_mfma_f32_32x32x16_bf16 v[144:159], v[192:195], v[112:115], v[32:47]
    ds_read_b128 v[212:215], v7 offset:0
    v_exp_f32 v160, v160
    v_exp_f32 v161, v161
    v_exp_f32 v162, v162
    v_add_f32 v31, v31, v160
    v_mfma_f32_32x32x16_bf16 v[144:159], v[196:199], v[116:119], v[144:159]
    ds_read_b128 v[216:219], v8 offset:0
    v_exp_f32 v163, v163
    v_add_f32 v225, v225, v161
    v_cvt_pk_bf16_f32 v184, v160, v161
    s_waitcnt lgkmcnt(3)
    v_mfma_f32_32x32x16_bf16 v[144:159], v[200:203], v[120:123], v[144:159]
    ds_read_b128 v[220:223], v9 offset:0
    v_exp_f32 v164, v164
    v_add_f32 v31, v31, v162
    v_exp_f32 v165, v165
    v_mfma_f32_32x32x16_bf16 v[144:159], v[204:207], v[124:127], v[144:159]
    ds_read_b64_tr_b16 v[192:193], v18 offset:16384
    ds_read_b64_tr_b16 v[194:195], v18 offset:18432
    v_add_f32 v225, v225, v163
    v_cvt_pk_bf16_f32 v185, v162, v163
    v_exp_f32 v166, v166
    s_waitcnt lgkmcnt(4)
    v_mfma_f32_32x32x16_bf16 v[144:159], v[208:211], v[128:131], v[144:159]
    ds_read_b64_tr_b16 v[196:197], v19 offset:16384
    ds_read_b64_tr_b16 v[198:199], v19 offset:18432
    v_add_f32 v31, v31, v164
    v_exp_f32 v167, v167
    v_add_f32 v225, v225, v165
    v_mfma_f32_32x32x16_bf16 v[144:159], v[212:215], v[132:135], v[144:159]
    ds_read_b64_tr_b16 v[200:201], v20 offset:16384
    ds_read_b64_tr_b16 v[202:203], v20 offset:18432
    v_cvt_pk_bf16_f32 v186, v164, v165
    v_exp_f32 v168, v168
    v_add_f32 v31, v31, v166
    s_waitcnt lgkmcnt(6)
    v_mfma_f32_32x32x16_bf16 v[144:159], v[216:219], v[136:139], v[144:159]
    ds_read_b64_tr_b16 v[204:205], v21 offset:16384
    ds_read_b64_tr_b16 v[206:207], v21 offset:18432
    v_exp_f32 v169, v169
    v_add_f32 v225, v225, v167
    v_cvt_pk_bf16_f32 v187, v166, v167
    v_mfma_f32_32x32x16_bf16 v[144:159], v[220:223], v[140:143], v[144:159]
    ds_read_b64_tr_b16 v[208:209], v18 offset:20480
    ds_read_b64_tr_b16 v[210:211], v18 offset:22528
    v_exp_f32 v170, v170
    v_add_f32 v31, v31, v168
    v_exp_f32 v171, v171
    s_waitcnt lgkmcnt(6)
    v_mfma_f32_32x32x16_bf16 v[48:63], v[192:195], v[176:179], v[48:63]
    ds_read_b64_tr_b16 v[212:213], v19 offset:20480
    ds_read_b64_tr_b16 v[214:215], v19 offset:22528
    v_add_f32 v225, v225, v169
    v_cvt_pk_bf16_f32 v188, v168, v169
    v_exp_f32 v172, v172
    v_mfma_f32_32x32x16_bf16 v[64:79], v[196:199], v[176:179], v[64:79]
    ds_read_b64_tr_b16 v[216:217], v20 offset:20480
    ds_read_b64_tr_b16 v[218:219], v20 offset:22528
    v_add_f32 v31, v31, v170
    v_exp_f32 v173, v173
    v_add_f32 v225, v225, v171
    s_waitcnt lgkmcnt(6)
    v_mfma_f32_32x32x16_bf16 v[80:95], v[200:203], v[176:179], v[80:95]
    ds_read_b64_tr_b16 v[220:221], v21 offset:20480
    ds_read_b64_tr_b16 v[222:223], v21 offset:22528
    v_cvt_pk_bf16_f32 v189, v170, v171
    v_exp_f32 v174, v174
    v_add_f32 v31, v31, v172
    v_mfma_f32_32x32x16_bf16 v[96:111], v[204:207], v[176:179], v[96:111]
    ds_read_b128 v[192:195], v2 offset:8192
    v_exp_f32 v175, v175
    v_add_f32 v225, v225, v173
    v_cvt_pk_bf16_f32 v190, v172, v173
    s_waitcnt lgkmcnt(5)
    v_mfma_f32_32x32x16_bf16 v[48:63], v[208:211], v[180:183], v[48:63]
    ds_read_b128 v[196:199], v3 offset:8192
    v_add_f32 v31, v31, v174
    v_add_f32 v225, v225, v175
    v_cvt_pk_bf16_f32 v191, v174, v175
    v_mfma_f32_32x32x16_bf16 v[64:79], v[212:215], v[180:183], v[64:79]
    ds_read_b128 v[200:203], v4 offset:8192
    v_max3_f32 v224, v144, v145, v146
    v_max3_f32 v226, v147, v148, v149
    v_max3_f32 v224, v224, v150, v151
    s_waitcnt lgkmcnt(3)
    v_mfma_f32_32x32x16_bf16 v[80:95], v[216:219], v[180:183], v[80:95]
    ds_read_b128 v[204:207], v5 offset:8192
    v_max3_f32 v226, v226, v152, v153
    v_max3_f32 v224, v224, v154, v155
    v_max3_f32 v226, v226, v156, v157
    v_mfma_f32_32x32x16_bf16 v[96:111], v[220:223], v[180:183], v[96:111]
    ds_read_b128 v[208:211], v6 offset:8192
    v_max3_f32 v224, v224, v158, v159
    v_max_f32 v224, v224, v226
    v_cmp_lt_f32 vcc, s32, v224
    s_cbranch_vccnz SLOW_0_8
BACK_0_8:
    s_waitcnt lgkmcnt(3)
    v_mfma_f32_32x32x16_bf16 v[160:175], v[192:195], v[112:115], v[32:47]
    ds_read_b128 v[212:215], v7 offset:8192
    v_exp_f32 v144, v144
    v_exp_f32 v145, v145
    v_exp_f32 v146, v146
    v_add_f32 v31, v31, v144
    v_mfma_f32_32x32x16_bf16 v[160:175], v[196:199], v[116:119], v[160:175]
    ds_read_b128 v[216:219], v8 offset:8192
    v_exp_f32 v147, v147
    v_add_f32 v225, v225, v145
    v_cvt_pk_bf16_f32 v176, v144, v145
    s_waitcnt lgkmcnt(3)
    v_mfma_f32_32x32x16_bf16 v[160:175], v[200:203], v[120:123], v[160:175]
    ds_read_b128 v[220:223], v9 offset:8192
    v_exp_f32 v148, v148
    v_add_f32 v31, v31, v146
    v_exp_f32 v149, v149
    v_mfma_f32_32x32x16_bf16 v[160:175], v[204:207], v[124:127], v[160:175]
    ds_read_b64_tr_b16 v[192:193], v18 offset:24576
    ds_read_b64_tr_b16 v[194:195], v18 offset:26624
    v_add_f32 v225, v225, v147
    v_cvt_pk_bf16_f32 v177, v146, v147
    v_exp_f32 v150, v150
    s_waitcnt lgkmcnt(4)
    v_mfma_f32_32x32x16_bf16 v[160:175], v[208:211], v[128:131], v[160:175]
    ds_read_b64_tr_b16 v[196:197], v19 offset:24576
    ds_read_b64_tr_b16 v[198:199], v19 offset:26624
    v_add_f32 v31, v31, v148
    v_exp_f32 v151, v151
    v_add_f32 v225, v225, v149
    v_mfma_f32_32x32x16_bf16 v[160:175], v[212:215], v[132:135], v[160:175]
    ds_read_b64_tr_b16 v[200:201], v20 offset:24576
    ds_read_b64_tr_b16 v[202:203], v20 offset:26624
    v_cvt_pk_bf16_f32 v178, v148, v149
    v_exp_f32 v152, v152
    v_add_f32 v31, v31, v150
    s_waitcnt lgkmcnt(6)
    v_mfma_f32_32x32x16_bf16 v[160:175], v[216:219], v[136:139], v[160:175]
    ds_read_b64_tr_b16 v[204:205], v21 offset:24576
    ds_read_b64_tr_b16 v[206:207], v21 offset:26624
    v_exp_f32 v153, v153
    v_add_f32 v225, v225, v151
    v_cvt_pk_bf16_f32 v179, v150, v151
    v_mfma_f32_32x32x16_bf16 v[160:175], v[220:223], v[140:143], v[160:175]
    ds_read_b64_tr_b16 v[208:209], v18 offset:28672
    ds_read_b64_tr_b16 v[210:211], v18 offset:30720
    v_exp_f32 v154, v154
    v_add_f32 v31, v31, v152
    v_exp_f32 v155, v155
    s_waitcnt lgkmcnt(6)
    v_mfma_f32_32x32x16_bf16 v[48:63], v[192:195], v[184:187], v[48:63]
    ds_read_b64_tr_b16 v[212:213], v19 offset:28672
    ds_read_b64_tr_b16 v[214:215], v19 offset:30720
    v_add_f32 v225, v225, v153
    v_cvt_pk_bf16_f32 v180, v152, v153
    v_exp_f32 v156, v156
    v_mfma_f32_32x32x16_bf16 v[64:79], v[196:199], v[184:187], v[64:79]
    ds_read_b64_tr_b16 v[216:217], v20 offset:28672
    ds_read_b64_tr_b16 v[218:219], v20 offset:30720
    v_add_f32 v31, v31, v154
    v_exp_f32 v157, v157
    v_add_f32 v225, v225, v155
    s_waitcnt lgkmcnt(6)
    v_mfma_f32_32x32x16_bf16 v[80:95], v[200:203], v[184:187], v[80:95]
    ds_read_b64_tr_b16 v[220:221], v21 offset:28672
    ds_read_b64_tr_b16 v[222:223], v21 offset:30720
    v_cvt_pk_bf16_f32 v181, v154, v155
    v_exp_f32 v158, v158
    v_add_f32 v31, v31, v156
    v_mfma_f32_32x32x16_bf16 v[96:111], v[204:207], v[184:187], v[96:111]
    ds_read_b128 v[192:195], v2 offset:32768
    v_exp_f32 v159, v159
    v_add_f32 v225, v225, v157
    v_cvt_pk_bf16_f32 v182, v156, v157
    s_waitcnt lgkmcnt(5)
    v_mfma_f32_32x32x16_bf16 v[48:63], v[208:211], v[188:191], v[48:63]
    ds_read_b128 v[196:199], v3 offset:32768
    v_add_f32 v31, v31, v158
    v_add_f32 v225, v225, v159
    v_cvt_pk_bf16_f32 v183, v158, v159
    v_mfma_f32_32x32x16_bf16 v[64:79], v[212:215], v[188:191], v[64:79]
    ds_read_b128 v[200:203], v4 offset:32768
    v_max3_f32 v224, v160, v161, v162
    v_max3_f32 v226, v163, v164, v165
    v_max3_f32 v224, v224, v166, v167
    s_waitcnt lgkmcnt(3)
    v_mfma_f32_32x32x16_bf16 v[80:95], v[216:219], v[188:191], v[80:95]
    ds_read_b128 v[204:207], v5 offset:32768
    v_max3_f32 v226, v226, v168, v169
    v_max3_f32 v224, v224, v170, v171
    v_max3_f32 v226, v226, v172, v173
    v_mfma_f32_32x32x16_bf16 v[96:111], v[220:223], v[188:191], v[96:111]
    ds_read_b128 v[208:211], v6 offset:32768
    v_max3_f32 v224, v224, v174, v175
    v_max_f32 v224, v224, v226
    v_cmp_lt_f32 vcc, s32, v224
    s_barrier
    s_cbranch_vccnz SLOW_0_9
BACK_0_9:
    s_waitcnt lgkmcnt(3)
    v_mfma_f32_32x32x16_bf16 v[144:159], v[192:195], v[112:115], v[32:47]
    ds_read_b128 v[212:215], v7 offset:32768
    v_exp_f32 v160, v160
    v_exp_f32 v161, v161
    v_exp_f32 v162, v162
    v_add_f32 v31, v31, v160
    v_mfma_f32_32x32x16_bf16 v[144:159], v[196:199], v[116:119], v[144:159]
    ds_read_b128 v[216:219], v8 offset:32768
    v_exp_f32 v163, v163
    v_add_f32 v225, v225, v161
    v_cvt_pk_bf16_f32 v184, v160, v161
    s_waitcnt lgkmcnt(3)
    v_mfma_f32_32x32x16_bf16 v[144:159], v[200:203], v[120:123], v[144:159]
    ds_read_b128 v[220:223], v9 offset:32768
    v_exp_f32 v164, v164
    v_add_f32 v31, v31, v162
    v_exp_f32 v165, v165
    v_mfma_f32_32x32x16_bf16 v[144:159], v[204:207], v[124:127], v[144:159]
    ds_read_b64_tr_b16 v[192:193], v18 offset:49152
    ds_read_b64_tr_b16 v[194:195], v18 offset:51200
    v_add_f32 v225, v225, v163
    v_cvt_pk_bf16_f32 v185, v162, v163
    v_exp_f32 v166, v166
    s_waitcnt lgkmcnt(4)
    v_mfma_f32_32x32x16_bf16 v[144:159], v[208:211], v[128:131], v[144:159]
    ds_read_b64_tr_b16 v[196:197], v19 offset:49152
    ds_read_b64_tr_b16 v[198:199], v19 offset:51200
    v_add_f32 v31, v31, v164
    v_exp_f32 v167, v167
    v_add_f32 v225, v225, v165
    v_mfma_f32_32x32x16_bf16 v[144:159], v[212:215], v[132:135], v[144:159]
    ds_read_b64_tr_b16 v[200:201], v20 offset:49152
    ds_read_b64_tr_b16 v[202:203], v20 offset:51200
    v_cvt_pk_bf16_f32 v186, v164, v165
    v_exp_f32 v168, v168
    v_add_f32 v31, v31, v166
    s_waitcnt lgkmcnt(6)
    v_mfma_f32_32x32x16_bf16 v[144:159], v[216:219], v[136:139], v[144:159]
    ds_read_b64_tr_b16 v[204:205], v21 offset:49152
    ds_read_b64_tr_b16 v[206:207], v21 offset:51200
    v_exp_f32 v169, v169
    v_add_f32 v225, v225, v167
    v_cvt_pk_bf16_f32 v187, v166, v167
    v_mfma_f32_32x32x16_bf16 v[144:159], v[220:223], v[140:143], v[144:159]
    ds_read_b64_tr_b16 v[208:209], v18 offset:53248
    ds_read_b64_tr_b16 v[210:211], v18 offset:55296
    v_exp_f32 v170, v170
    v_add_f32 v31, v31, v168
    v_exp_f32 v171, v171
    s_waitcnt lgkmcnt(6)
    v_mfma_f32_32x32x16_bf16 v[48:63], v[192:195], v[176:179], v[48:63]
    ds_read_b64_tr_b16 v[212:213], v19 offset:53248
    ds_read_b64_tr_b16 v[214:215], v19 offset:55296
    v_add_f32 v225, v225, v169
    v_cvt_pk_bf16_f32 v188, v168, v169
    v_exp_f32 v172, v172
    v_mfma_f32_32x32x16_bf16 v[64:79], v[196:199], v[176:179], v[64:79]
    ds_read_b64_tr_b16 v[216:217], v20 offset:53248
    ds_read_b64_tr_b16 v[218:219], v20 offset:55296
    v_add_f32 v31, v31, v170
    v_exp_f32 v173, v173
    v_add_f32 v225, v225, v171
    s_waitcnt lgkmcnt(6)
    v_mfma_f32_32x32x16_bf16 v[80:95], v[200:203], v[176:179], v[80:95]
    ds_read_b64_tr_b16 v[220:221], v21 offset:53248
    ds_read_b64_tr_b16 v[222:223], v21 offset:55296
    v_cvt_pk_bf16_f32 v189, v170, v171
    v_exp_f32 v174, v174
    v_add_f32 v31, v31, v172
    v_mfma_f32_32x32x16_bf16 v[96:111], v[204:207], v[176:179], v[96:111]
    ds_read_b128 v[192:195], v2 offset:40960
    v_exp_f32 v175, v175
    v_add_f32 v225, v225, v173
    v_cvt_pk_bf16_f32 v190, v172, v173
    s_waitcnt lgkmcnt(5)
    v_mfma_f32_32x32x16_bf16 v[48:63], v[208:211], v[180:183], v[48:63]
    ds_read_b128 v[196:199], v3 offset:40960
    v_add_f32 v31, v31, v174
    v_add_f32 v225, v225, v175
    v_cvt_pk_bf16_f32 v191, v174, v175
    v_mfma_f32_32x32x16_bf16 v[64:79], v[212:215], v[180:183], v[64:79]
    ds_read_b128 v[200:203], v4 offset:40960
    v_max3_f32 v224, v144, v145, v146
    v_max3_f32 v226, v147, v148, v149
    v_max3_f32 v224, v224, v150, v151
    s_waitcnt lgkmcnt(3)
    v_mfma_f32_32x32x16_bf16 v[80:95], v[216:219], v[180:183], v[80:95]
    ds_read_b128 v[204:207], v5 offset:40960
    v_max3_f32 v226, v226, v152, v153
    v_max3_f32 v224, v224, v154, v155
    v_max3_f32 v226, v226, v156, v157
    v_mfma_f32_32x32x16_bf16 v[96:111], v[220:223], v[180:183], v[96:111]
    ds_read_b128 v[208:211], v6 offset:40960
    v_max3_f32 v224, v224, v158, v159
    v_max_f32 v224, v224, v226
    v_cmp_lt_f32 vcc, s32, v224
    s_cbranch_vccnz SLOW_0_10
BACK_0_10:
    s_waitcnt lgkmcnt(3)
    v_mfma_f32_32x32x16_bf16 v[160:175], v[192:195], v[112:115], v[32:47]
    ds_read_b128 v[212:215], v7 offset:40960
    v_exp_f32 v144, v144
    v_exp_f32 v145, v145
    v_exp_f32 v146, v146
    v_add_f32 v31, v31, v144
    v_mfma_f32_32x32x16_bf16 v[160:175], v[196:199], v[116:119], v[160:175]
    ds_read_b128 v[216:219], v8 offset:40960
    v_exp_f32 v147, v147
    v_add_f32 v225, v225, v145
    v_cvt_pk_bf16_f32 v176, v144, v145
    s_waitcnt lgkmcnt(3)
    v_mfma_f32_32x32x16_bf16 v[160:175], v[200:203], v[120:123], v[160:175]
    ds_read_b128 v[220:223], v9 offset:40960
    v_exp_f32 v148, v148
    v_add_f32 v31, v31, v146
    v_exp_f32 v149, v149
    v_mfma_f32_32x32x16_bf16 v[160:175], v[204:207], v[124:127], v[160:175]
    ds_read_b64_tr_b16 v[192:193], v18 offset:57344
    ds_read_b64_tr_b16 v[194:195], v18 offset:59392
    v_add_f32 v225, v225, v147
    v_cvt_pk_bf16_f32 v177, v146, v147
    v_exp_f32 v150, v150
    s_waitcnt lgkmcnt(4)
    v_mfma_f32_32x32x16_bf16 v[160:175], v[208:211], v[128:131], v[160:175]
    ds_read_b64_tr_b16 v[196:197], v19 offset:57344
    ds_read_b64_tr_b16 v[198:199], v19 offset:59392
    v_add_f32 v31, v31, v148
    v_exp_f32 v151, v151
    v_add_f32 v225, v225, v149
    v_mfma_f32_32x32x16_bf16 v[160:175], v[212:215], v[132:135], v[160:175]
    ds_read_b64_tr_b16 v[200:201], v20 offset:57344
    ds_read_b64_tr_b16 v[202:203], v20 offset:59392
    v_cvt_pk_bf16_f32 v178, v148, v149
    v_exp_f32 v152, v152
    v_add_f32 v31, v31, v150
    s_waitcnt lgkmcnt(6)
    v_mfma_f32_32x32x16_bf16 v[160:175], v[216:219], v[136:139], v[160:175]
    ds_read_b64_tr_b16 v[204:205], v21 offset:57344
    ds_read_b64_tr_b16 v[206:207], v21 offset:59392
    v_exp_f32 v153, v153
    v_add_f32 v225, v225, v151
    v_cvt_pk_bf16_f32 v179, v150, v151
    v_mfma_f32_32x32x16_bf16 v[160:175], v[220:223], v[140:143], v[160:175]
    ds_read_b64_tr_b16 v[208:209], v18 offset:61440
    ds_read_b64_tr_b16 v[210:211], v18 offset:63488
    v_exp_f32 v154, v154
    v_add_f32 v31, v31, v152
    v_exp_f32 v155, v155
    s_waitcnt lgkmcnt(6)
    v_mfma_f32_32x32x16_bf16 v[48:63], v[192:195], v[184:187], v[48:63]
    ds_read_b64_tr_b16 v[212:213], v19 offset:61440
    ds_read_b64_tr_b16 v[214:215], v19 offset:63488
    v_add_f32 v225, v225, v153
    v_cvt_pk_bf16_f32 v180, v152, v153
    v_exp_f32 v156, v156
    v_mfma_f32_32x32x16_bf16 v[64:79], v[196:199], v[184:187], v[64:79]
    ds_read_b64_tr_b16 v[216:217], v20 offset:61440
    ds_read_b64_tr_b16 v[218:219], v20 offset:63488
    v_add_f32 v31, v31, v154
    v_exp_f32 v157, v157
    v_add_f32 v225, v225, v155
    s_waitcnt lgkmcnt(6)
    v_mfma_f32_32x32x16_bf16 v[80:95], v[200:203], v[184:187], v[80:95]
    ds_read_b64_tr_b16 v[220:221], v21 offset:61440
    ds_read_b64_tr_b16 v[222:223], v21 offset:63488
    v_cvt_pk_bf16_f32 v181, v154, v155
    v_exp_f32 v158, v158
    v_add_f32 v31, v31, v156
    v_mfma_f32_32x32x16_bf16 v[96:111], v[204:207], v[184:187], v[96:111]
    ds_read_b128 v[192:195], v10 offset:32768
    v_exp_f32 v159, v159
    v_add_f32 v225, v225, v157
    v_cvt_pk_bf16_f32 v182, v156, v157
    s_waitcnt lgkmcnt(5)
    v_mfma_f32_32x32x16_bf16 v[48:63], v[208:211], v[188:191], v[48:63]
    ds_read_b128 v[196:199], v11 offset:32768
    v_add_f32 v31, v31, v158
    v_add_f32 v225, v225, v159
    v_cvt_pk_bf16_f32 v183, v158, v159
    v_mfma_f32_32x32x16_bf16 v[64:79], v[212:215], v[188:191], v[64:79]
    ds_read_b128 v[200:203], v12 offset:32768
    v_max3_f32 v224, v160, v161, v162
    v_max3_f32 v226, v163, v164, v165
    v_max3_f32 v224, v224, v166, v167
    s_waitcnt lgkmcnt(3)
    v_mfma_f32_32x32x16_bf16 v[80:95], v[216:219], v[188:191], v[80:95]
    ds_read_b128 v[204:207], v13 offset:32768
    v_max3_f32 v226, v226, v168, v169
    v_max3_f32 v224, v224, v170, v171
    v_max3_f32 v226, v226, v172, v173
    v_mfma_f32_32x32x16_bf16 v[96:111], v[220:223], v[188:191], v[96:111]
    ds_read_b128 v[208:211], v14 offset:32768
    v_max3_f32 v224, v224, v174, v175
    v_max_f32 v224, v224, v226
    v_cmp_lt_f32 vcc, s32, v224
    s_barrier
    s_cbranch_vccnz SLOW_0_11
BACK_0_11:
    s_waitcnt lgkmcnt(3)
    v_mfma_f32_32x32x16_bf16 v[144:159], v[192:195], v[112:115], v[32:47]
    ds_read_b128 v[212:215], v15 offset:32768
    v_exp_f32 v160, v160
    v_exp_f32 v161, v161
    v_exp_f32 v162, v162
    v_add_f32 v31, v31, v160
    v_mfma_f32_32x32x16_bf16 v[144:159], v[196:199], v[116:119], v[144:159]
    ds_read_b128 v[216:219], v16 offset:32768
    v_exp_f32 v163, v163
    v_add_f32 v225, v225, v161
    v_cvt_pk_bf16_f32 v184, v160, v161
    s_waitcnt lgkmcnt(3)
    v_mfma_f32_32x32x16_bf16 v[144:159], v[200:203], v[120:123], v[144:159]
    ds_read_b128 v[220:223], v17 offset:32768
    v_exp_f32 v164, v164
    v_add_f32 v31, v31, v162
    v_exp_f32 v165, v165
    v_mfma_f32_32x32x16_bf16 v[144:159], v[204:207], v[124:127], v[144:159]
    ds_read_b64_tr_b16 v[192:193], v22 offset:0
    ds_read_b64_tr_b16 v[194:195], v22 offset:2048
    v_add_f32 v225, v225, v163
    v_cvt_pk_bf16_f32 v185, v162, v163
    v_exp_f32 v166, v166
    s_waitcnt lgkmcnt(4)
    v_mfma_f32_32x32x16_bf16 v[144:159], v[208:211], v[128:131], v[144:159]
    ds_read_b64_tr_b16 v[196:197], v23 offset:0
    ds_read_b64_tr_b16 v[198:199], v23 offset:2048
    v_add_f32 v31, v31, v164
    v_exp_f32 v167, v167
    v_add_f32 v225, v225, v165
    v_mfma_f32_32x32x16_bf16 v[144:159], v[212:215], v[132:135], v[144:159]
    ds_read_b64_tr_b16 v[200:201], v24 offset:0
    ds_read_b64_tr_b16 v[202:203], v24 offset:2048
    v_cvt_pk_bf16_f32 v186, v164, v165
    v_exp_f32 v168, v168
    v_add_f32 v31, v31, v166
    s_waitcnt lgkmcnt(6)
    v_mfma_f32_32x32x16_bf16 v[144:159], v[216:219], v[136:139], v[144:159]
    ds_read_b64_tr_b16 v[204:205], v25 offset:0
    ds_read_b64_tr_b16 v[206:207], v25 offset:2048
    v_exp_f32 v169, v169
    v_add_f32 v225, v225, v167
    v_cvt_pk_bf16_f32 v187, v166, v167
    v_mfma_f32_32x32x16_bf16 v[144:159], v[220:223], v[140:143], v[144:159]
    ds_read_b64_tr_b16 v[208:209], v22 offset:4096
    ds_read_b64_tr_b16 v[210:211], v22 offset:6144
    v_exp_f32 v170, v170
    v_add_f32 v31, v31, v168
    v_exp_f32 v171, v171
    s_waitcnt lgkmcnt(6)
    v_mfma_f32_32x32x16_bf16 v[48:63], v[192:195], v[176:179], v[48:63]
    ds_read_b64_tr_b16 v[212:213], v23 offset:4096
    ds_read_b64_tr_b16 v[214:215], v23 offset:6144
    v_add_f32 v225, v225, v169
    v_cvt_pk_bf16_f32 v188, v168, v169
    v_exp_f32 v172, v172
    v_mfma_f32_32x32x16_bf16 v[64:79], v[196:199], v[176:179], v[64:79]
    ds_read_b64_tr_b16 v[216:217], v24 offset:4096
    ds_read_b64_tr_b16 v[218:219], v24 offset:6144
    v_add_f32 v31, v31, v170
    v_exp_f32 v173, v173
    v_add_f32 v225, v225, v171
    s_waitcnt lgkmcnt(6)
    v_mfma_f32_32x32x16_bf16 v[80:95], v[200:203], v[176:179], v[80:95]
    ds_read_b64_tr_b16 v[220:221], v25 offset:4096
    ds_read_b64_tr_b16 v[222:223], v25 offset:6144
    v_cvt_pk_bf16_f32 v189, v170, v171
    v_exp_f32 v174, v174
    v_add_f32 v31, v31, v172
    v_mfma_f32_32x32x16_bf16 v[96:111], v[204:207], v[176:179], v[96:111]
    ds_read_b128 v[192:195], v10 offset:40960
    v_exp_f32 v175, v175
    v_add_f32 v225, v225, v173
    v_cvt_pk_bf16_f32 v190, v172, v173
    s_waitcnt lgkmcnt(5)
    v_mfma_f32_32x32x16_bf16 v[48:63], v[208:211], v[180:183], v[48:63]
    ds_read_b128 v[196:199], v11 offset:40960
    v_add_f32 v31, v31, v174
    v_add_f32 v225, v225, v175
    v_cvt_pk_bf16_f32 v191, v174, v175
    v_mfma_f32_32x32x16_bf16 v[64:79], v[212:215], v[180:183], v[64:79]
    ds_read_b128 v[200:203], v12 offset:40960
    v_max3_f32 v224, v144, v145, v146
    v_max3_f32 v226, v147, v148, v149
    v_max3_f32 v224, v224, v150, v151
    s_waitcnt lgkmcnt(3)
    v_mfma_f32_32x32x16_bf16 v[80:95], v[216:219], v[180:183], v[80:95]
    ds_read_b128 v[204:207], v13 offset:40960
    v_max3_f32 v226, v226, v152, v153
    v_max3_f32 v224, v224, v154, v155
    v_max3_f32 v226, v226, v156, v157
    v_mfma_f32_32x32x16_bf16 v[96:111], v[220:223], v[180:183], v[96:111]
    ds_read_b128 v[208:211], v14 offset:40960
    v_max3_f32 v224, v224, v158, v159
    v_max_f32 v224, v224, v226
    v_cmp_lt_f32 vcc, s32, v224
    s_cbranch_vccnz SLOW_0_12
BACK_0_12:
    s_waitcnt lgkmcnt(3)
    v_mfma_f32_32x32x16_bf16 v[160:175], v[192:195], v[112:115], v[32:47]
    ds_read_b128 v[212:215], v15 offset:40960
    v_exp_f32 v144, v144
    v_exp_f32 v145, v145
    v_exp_f32 v146, v146
    v_add_f32 v31, v31, v144
    v_mfma_f32_32x32x16_bf16 v[160:175], v[196:199], v[116:119], v[160:175]
    ds_read_b128 v[216:219], v16 offset:40960
    v_exp_f32 v147, v147
    v_add_f32 v225, v225, v145
    v_cvt_pk_bf16_f32 v176, v144, v145
    s_waitcnt lgkmcnt(3)
    v_mfma_f32_32x32x16_bf16 v[160:175], v[200:203], v[120:123], v[160:175]
    ds_read_b128 v[220:223], v17 offset:40960
    v_exp_f32 v148, v148
    v_add_f32 v31, v31, v146
    v_exp_f32 v149, v149
    v_mfma_f32_32x32x16_bf16 v[160:175], v[204:207], v[124:127], v[160:175]
    ds_read_b64_tr_b16 v[192:193], v22 offset:8192
    ds_read_b64_tr_b16 v[194:195], v22 offset:10240
    v_add_f32 v225, v225, v147
    v_cvt_pk_bf16_f32 v177, v146, v147
    v_exp_f32 v150, v150
    s_waitcnt lgkmcnt(4)
    v_mfma_f32_32x32x16_bf16 v[160:175], v[208:211], v[128:131], v[160:175]
    ds_read_b64_tr_b16 v[196:197], v23 offset:8192
    ds_read_b64_tr_b16 v[198:199], v23 offset:10240
    v_add_f32 v31, v31, v148
    v_exp_f32 v151, v151
    v_add_f32 v225, v225, v149
    v_mfma_f32_32x32x16_bf16 v[160:175], v[212:215], v[132:135], v[160:175]
    ds_read_b64_tr_b16 v[200:201], v24 offset:8192
    ds_read_b64_tr_b16 v[202:203], v24 offset:10240
    v_cvt_pk_bf16_f32 v178, v148, v149
    v_exp_f32 v152, v152
    v_add_f32 v31, v31, v150
    s_waitcnt lgkmcnt(6)
    v_mfma_f32_32x32x16_bf16 v[160:175], v[216:219], v[136:139], v[160:175]
    ds_read_b64_tr_b16 v[204:205], v25 offset:8192
    ds_read_b64_tr_b16 v[206:207], v25 offset:10240
    v_exp_f32 v153, v153
    v_add_f32 v225, v225, v151
    v_cvt_pk_bf16_f32 v179, v150, v151
    v_mfma_f32_32x32x16_bf16 v[160:175], v[220:223], v[140:143], v[160:175]
    ds_read_b64_tr_b16 v[208:209], v22 offset:12288
    ds_read_b64_tr_b16 v[210:211], v22 offset:14336
    v_exp_f32 v154, v154
    v_add_f32 v31, v31, v152
    v_exp_f32 v155, v155
    s_waitcnt lgkmcnt(6)
    v_mfma_f32_32x32x16_bf16 v[48:63], v[192:195], v[184:187], v[48:63]
    ds_read_b64_tr_b16 v[212:213], v23 offset:12288
    ds_read_b64_tr_b16 v[214:215], v23 offset:14336
    v_add_f32 v225, v225, v153
    v_cvt_pk_bf16_f32 v180, v152, v153
    v_exp_f32 v156, v156
    v_mfma_f32_32x32x16_bf16 v[64:79], v[196:199], v[184:187], v[64:79]
    ds_read_b64_tr_b16 v[216:217], v24 offset:12288
    ds_read_b64_tr_b16 v[218:219], v24 offset:14336
    v_add_f32 v31, v31, v154
    v_exp_f32 v157, v157
    v_add_f32 v225, v225, v155
    s_waitcnt lgkmcnt(6)
    v_mfma_f32_32x32x16_bf16 v[80:95], v[200:203], v[184:187], v[80:95]
    ds_read_b64_tr_b16 v[220:221], v25 offset:12288
    ds_read_b64_tr_b16 v[222:223], v25 offset:14336
    v_cvt_pk_bf16_f32 v181, v154, v155
    v_exp_f32 v158, v158
    v_add_f32 v31, v31, v156
    v_mfma_f32_32x32x16_bf16 v[96:111], v[204:207], v[184:187], v[96:111]
    ds_read_b128 v[192:195], v10 offset:16384
    v_exp_f32 v159, v159
    v_add_f32 v225, v225, v157
    v_cvt_pk_bf16_f32 v182, v156, v157
    s_waitcnt lgkmcnt(5)
    v_mfma_f32_32x32x16_bf16 v[48:63], v[208:211], v[188:191], v[48:63]
    ds_read_b128 v[196:199], v11 offset:16384
    v_add_f32 v31, v31, v158
    v_add_f32 v225, v225, v159
    v_cvt_pk_bf16_f32 v183, v158, v159
    v_mfma_f32_32x32x16_bf16 v[64:79], v[212:215], v[188:191], v[64:79]
    ds_read_b128 v[200:203], v12 offset:16384
    v_max3_f32 v224, v160, v161, v162
    v_max3_f32 v226, v163, v164, v165
    v_max3_f32 v224, v224, v166, v167
    s_waitcnt lgkmcnt(3)
    v_mfma_f32_32x32x16_bf16 v[80:95], v[216:219], v[188:191], v[80:95]
    ds_read_b128 v[204:207], v13 offset:16384
    v_max3_f32 v226, v226, v168, v169
    v_max3_f32 v224, v224, v170, v171
    v_max3_f32 v226, v226, v172, v173
    v_mfma_f32_32x32x16_bf16 v[96:111], v[220:223], v[188:191], v[96:111]
    ds_read_b128 v[208:211], v14 offset:16384
    v_max3_f32 v224, v224, v174, v175
    v_max_f32 v224, v224, v226
    v_cmp_lt_f32 vcc, s32, v224
    s_barrier
    s_cbranch_vccnz SLOW_0_13
BACK_0_13:
    s_waitcnt lgkmcnt(3)
    v_mfma_f32_32x32x16_bf16 v[144:159], v[192:195], v[112:115], v[32:47]
    ds_read_b128 v[212:215], v15 offset:16384
    v_exp_f32 v160, v160
    v_exp_f32 v161, v161
    v_exp_f32 v162, v162
    v_add_f32 v31, v31, v160
    v_mfma_f32_32x32x16_bf16 v[144:159], v[196:199], v[116:119], v[144:159]
    ds_read_b128 v[216:219], v16 offset:16384
    v_exp_f32 v163, v163
    v_add_f32 v225, v225, v161
    v_cvt_pk_bf16_f32 v184, v160, v161
    s_waitcnt lgkmcnt(3)
    v_mfma_f32_32x32x16_bf16 v[144:159], v[200:203], v[120:123], v[144:159]
    ds_read_b128 v[220:223], v17 offset:16384
    v_exp_f32 v164, v164
    v_add_f32 v31, v31, v162
    v_exp_f32 v165, v165
    v_mfma_f32_32x32x16_bf16 v[144:159], v[204:207], v[124:127], v[144:159]
    ds_read_b64_tr_b16 v[192:193], v18 offset:0
    ds_read_b64_tr_b16 v[194:195], v18 offset:2048
    v_add_f32 v225, v225, v163
    v_cvt_pk_bf16_f32 v185, v162, v163
    v_exp_f32 v166, v166
    s_waitcnt lgkmcnt(4)
    v_mfma_f32_32x32x16_bf16 v[144:159], v[208:211], v[128:131], v[144:159]
    ds_read_b64_tr_b16 v[196:197], v19 offset:0
    ds_read_b64_tr_b16 v[198:199], v19 offset:2048
    v_add_f32 v31, v31, v164
    v_exp_f32 v167, v167
    v_add_f32 v225, v225, v165
    v_mfma_f32_32x32x16_bf16 v[144:159], v[212:215], v[132:135], v[144:159]
    ds_read_b64_tr_b16 v[200:201], v20 offset:0
    ds_read_b64_tr_b16 v[202:203], v20 offset:2048
    v_cvt_pk_bf16_f32 v186, v164, v165
    v_exp_f32 v168, v168
    v_add_f32 v31, v31, v166
    s_waitcnt lgkmcnt(6)
    v_mfma_f32_32x32x16_bf16 v[144:159], v[216:219], v[136:139], v[144:159]
    ds_read_b64_tr_b16 v[204:205], v21 offset:0
    ds_read_b64_tr_b16 v[206:207], v21 offset:2048
    v_exp_f32 v169, v169
    v_add_f32 v225, v225, v167
    v_cvt_pk_bf16_f32 v187, v166, v167
    v_mfma_f32_32x32x16_bf16 v[144:159], v[220:223], v[140:143], v[144:159]
    ds_read_b64_tr_b16 v[208:209], v18 offset:4096
    ds_read_b64_tr_b16 v[210:211], v18 offset:6144
    v_exp_f32 v170, v170
    v_add_f32 v31, v31, v168
    v_exp_f32 v171, v171
    s_waitcnt lgkmcnt(6)
    v_mfma_f32_32x32x16_bf16 v[48:63], v[192:195], v[176:179], v[48:63]
    ds_read_b64_tr_b16 v[212:213], v19 offset:4096
    ds_read_b64_tr_b16 v[214:215], v19 offset:6144
    v_add_f32 v225, v225, v169
    v_cvt_pk_bf16_f32 v188, v168, v169
    v_exp_f32 v172, v172
    v_mfma_f32_32x32x16_bf16 v[64:79], v[196:199], v[176:179], v[64:79]
    ds_read_b64_tr_b16 v[216:217], v20 offset:4096
    ds_read_b64_tr_b16 v[218:219], v20 offset:6144
    v_add_f32 v31, v31, v170
    v_exp_f32 v173, v173
    v_add_f32 v225, v225, v171
    s_waitcnt lgkmcnt(6)
    v_mfma_f32_32x32x16_bf16 v[80:95], v[200:203], v[176:179], v[80:95]
    ds_read_b64_tr_b16 v[220:221], v21 offset:4096
    ds_read_b64_tr_b16 v[222:223], v21 offset:6144
    v_cvt_pk_bf16_f32 v189, v170, v171
    v_exp_f32 v174, v174
    v_add_f32 v31, v31, v172
    v_mfma_f32_32x32x16_bf16 v[96:111], v[204:207], v[176:179], v[96:111]
    ds_read_b128 v[192:195], v10 offset:24576
    v_exp_f32 v175, v175
    v_add_f32 v225, v225, v173
    v_cvt_pk_bf16_f32 v190, v172, v173
    s_waitcnt lgkmcnt(5)
    v_mfma_f32_32x32x16_bf16 v[48:63], v[208:211], v[180:183], v[48:63]
    ds_read_b128 v[196:199], v11 offset:24576
    v_add_f32 v31, v31, v174
    v_add_f32 v225, v225, v175
    v_cvt_pk_bf16_f32 v191, v174, v175
    v_mfma_f32_32x32x16_bf16 v[64:79], v[212:215], v[180:183], v[64:79]
    ds_read_b128 v[200:203], v12 offset:24576
    v_max3_f32 v224, v144, v145, v146
    v_max3_f32 v226, v147, v148, v149
    v_max3_f32 v224, v224, v150, v151
    s_waitcnt lgkmcnt(3)
    v_mfma_f32_32x32x16_bf16 v[80:95], v[216:219], v[180:183], v[80:95]
    ds_read_b128 v[204:207], v13 offset:24576
    v_max3_f32 v226, v226, v152, v153
    v_max3_f32 v224, v224, v154, v155
    v_max3_f32 v226, v226, v156, v157
    v_mfma_f32_32x32x16_bf16 v[96:111], v[220:223], v[180:183], v[96:111]
    ds_read_b128 v[208:211], v14 offset:24576
    v_max3_f32 v224, v224, v158, v159
    v_max_f32 v224, v224, v226
    v_cmp_lt_f32 vcc, s32, v224
    s_cbranch_vccnz SLOW_0_14
BACK_0_14:
    s_waitcnt lgkmcnt(3)
    v_mfma_f32_32x32x16_bf16 v[160:175], v[192:195], v[112:115], v[32:47]
    ds_read_b128 v[212:215], v15 offset:24576
    v_exp_f32 v144, v144
    v_exp_f32 v145, v145
    v_exp_f32 v146, v146
    v_add_f32 v31, v31, v144
    v_mfma_f32_32x32x16_bf16 v[160:175], v[196:199], v[116:119], v[160:175]
    ds_read_b128 v[216:219], v16 offset:24576
    v_exp_f32 v147, v147
    v_add_f32 v225, v225, v145
    v_cvt_pk_bf16_f32 v176, v144, v145
    s_waitcnt lgkmcnt(3)
    v_mfma_f32_32x32x16_bf16 v[160:175], v[200:203], v[120:123], v[160:175]
    ds_read_b128 v[220:223], v17 offset:24576
    v_exp_f32 v148, v148
    v_add_f32 v31, v31, v146
    v_exp_f32 v149, v149
    v_mfma_f32_32x32x16_bf16 v[160:175], v[204:207], v[124:127], v[160:175]
    ds_read_b64_tr_b16 v[192:193], v18 offset:8192
    ds_read_b64_tr_b16 v[194:195], v18 offset:10240
    v_add_f32 v225, v225, v147
    v_cvt_pk_bf16_f32 v177, v146, v147
    v_exp_f32 v150, v150
    s_waitcnt lgkmcnt(4)
    v_mfma_f32_32x32x16_bf16 v[160:175], v[208:211], v[128:131], v[160:175]
    ds_read_b64_tr_b16 v[196:197], v19 offset:8192
    ds_read_b64_tr_b16 v[198:199], v19 offset:10240
    v_add_f32 v31, v31, v148
    v_exp_f32 v151, v151
    v_add_f32 v225, v225, v149
    v_mfma_f32_32x32x16_bf16 v[160:175], v[212:215], v[132:135], v[160:175]
    ds_read_b64_tr_b16 v[200:201], v20 offset:8192
    ds_read_b64_tr_b16 v[202:203], v20 offset:10240
    v_cvt_pk_bf16_f32 v178, v148, v149
    v_exp_f32 v152, v152
    v_add_f32 v31, v31, v150
    s_waitcnt lgkmcnt(6)
    v_mfma_f32_32x32x16_bf16 v[160:175], v[216:219], v[136:139], v[160:175]
    ds_read_b64_tr_b16 v[204:205], v21 offset:8192
    ds_read_b64_tr_b16 v[206:207], v21 offset:10240
    v_exp_f32 v153, v153
    v_add_f32 v225, v225, v151
    v_cvt_pk_bf16_f32 v179, v150, v151
    v_mfma_f32_32x32x16_bf16 v[160:175], v[220:223], v[140:143], v[160:175]
    ds_read_b64_tr_b16 v[208:209], v18 offset:12288
    ds_read_b64_tr_b16 v[210:211], v18 offset:14336
    v_exp_f32 v154, v154
    v_add_f32 v31, v31, v152
    v_exp_f32 v155, v155
    s_waitcnt lgkmcnt(6)
    v_mfma_f32_32x32x16_bf16 v[48:63], v[192:195], v[184:187], v[48:63]
    ds_read_b64_tr_b16 v[212:213], v19 offset:12288
    ds_read_b64_tr_b16 v[214:215], v19 offset:14336
    v_add_f32 v225, v225, v153
    v_cvt_pk_bf16_f32 v180, v152, v153
    v_exp_f32 v156, v156
    v_mfma_f32_32x32x16_bf16 v[64:79], v[196:199], v[184:187], v[64:79]
    ds_read_b64_tr_b16 v[216:217], v20 offset:12288
    ds_read_b64_tr_b16 v[218:219], v20 offset:14336
    v_add_f32 v31, v31, v154
    v_exp_f32 v157, v157
    v_add_f32 v225, v225, v155
    s_waitcnt lgkmcnt(6)
    v_mfma_f32_32x32x16_bf16 v[80:95], v[200:203], v[184:187], v[80:95]
    ds_read_b64_tr_b16 v[220:221], v21 offset:12288
    ds_read_b64_tr_b16 v[222:223], v21 offset:14336
    v_cvt_pk_bf16_f32 v181, v154, v155
    v_exp_f32 v158, v158
    v_add_f32 v31, v31, v156
    v_mfma_f32_32x32x16_bf16 v[96:111], v[204:207], v[184:187], v[96:111]
    ds_read_b64_tr_b16 v[192:193], v18 offset:16384
    ds_read_b64_tr_b16 v[194:195], v18 offset:18432
    v_exp_f32 v159, v159
    v_add_f32 v225, v225, v157
    v_cvt_pk_bf16_f32 v182, v156, v157
    s_waitcnt lgkmcnt(6)
    v_mfma_f32_32x32x16_bf16 v[48:63], v[208:211], v[188:191], v[48:63]
    ds_read_b64_tr_b16 v[196:197], v19 offset:16384
    ds_read_b64_tr_b16 v[198:199], v19 offset:18432
    v_add_f32 v31, v31, v158
    v_add_f32 v225, v225, v159
    v_cvt_pk_bf16_f32 v183, v158, v159
    v_mfma_f32_32x32x16_bf16 v[64:79], v[212:215], v[188:191], v[64:79]
    ds_read_b64_tr_b16 v[200:201], v20 offset:16384
    ds_read_b64_tr_b16 v[202:203], v20 offset:18432
    v_max3_f32 v224, v160, v161, v162
    v_max3_f32 v226, v163, v164, v165
    v_max3_f32 v224, v224, v166, v167
    s_waitcnt lgkmcnt(6)
    v_mfma_f32_32x32x16_bf16 v[80:95], v[216:219], v[188:191], v[80:95]
    ds_read_b64_tr_b16 v[204:205], v21 offset:16384
    ds_read_b64_tr_b16 v[206:207], v21 offset:18432
    v_max3_f32 v226, v226, v168, v169
    v_max3_f32 v224, v224, v170, v171
    v_max3_f32 v226, v226, v172, v173
    v_mfma_f32_32x32x16_bf16 v[96:111], v[220:223], v[188:191], v[96:111]
    ds_read_b64_tr_b16 v[208:209], v18 offset:20480
    ds_read_b64_tr_b16 v[210:211], v18 offset:22528
    v_max3_f32 v224, v224, v174, v175
    v_max_f32 v224, v224, v226
    v_cmp_lt_f32 vcc, s32, v224
    s_barrier
    s_cbranch_vccnz SLOW_0_15
BACK_0_15:
    s_waitcnt lgkmcnt(6)
    v_mfma_f32_32x32x16_bf16 v[48:63], v[192:195], v[176:179], v[48:63]
    ds_read_b64_tr_b16 v[212:213], v19 offset:20480
    ds_read_b64_tr_b16 v[214:215], v19 offset:22528
    v_exp_f32 v160, v160
    v_exp_f32 v161, v161
    v_exp_f32 v162, v162
    v_add_f32 v31, v31, v160
    v_mfma_f32_32x32x16_bf16 v[64:79], v[196:199], v[176:179], v[64:79]
    ds_read_b64_tr_b16 v[216:217], v20 offset:20480
    ds_read_b64_tr_b16 v[218:219], v20 offset:22528
    v_exp_f32 v163, v163
    v_add_f32 v225, v225, v161
    v_cvt_pk_bf16_f32 v184, v160, v161
    v_exp_f32 v164, v164
    s_waitcnt lgkmcnt(6)
    v_mfma_f32_32x32x16_bf16 v[80:95], v[200:203], v[176:179], v[80:95]
    ds_read_b64_tr_b16 v[220:221], v21 offset:20480
    ds_read_b64_tr_b16 v[222:223], v21 offset:22528
    v_add_f32 v31, v31, v162
    v_exp_f32 v165, v165
    v_add_f32 v225, v225, v163
    v_mfma_f32_32x32x16_bf16 v[96:111], v[204:207], v[176:179], v[96:111]
    ds_read_b64_tr_b16 v[192:193], v18 offset:24576
    ds_read_b64_tr_b16 v[194:195], v18 offset:26624
    v_cvt_pk_bf16_f32 v185, v162, v163
    v_exp_f32 v166, v166
    v_add_f32 v31, v31, v164
    v_exp_f32 v167, v167
    s_waitcnt lgkmcnt(6)
    v_mfma_f32_32x32x16_bf16 v[48:63], v[208:211], v[180:183], v[48:63]
    ds_read_b64_tr_b16 v[196:197], v19 offset:24576
    ds_read_b64_tr_b16 v[198:199], v19 offset:26624
    v_add_f32 v225, v225, v165
    v_cvt_pk_bf16_f32 v186, v164, v165
    v_exp_f32 v168, v168
    v_add_f32 v31, v31, v166
    v_mfma_f32_32x32x16_bf16 v[64:79], v[212:215], v[180:183], v[64:79]
    ds_read_b64_tr_b16 v[200:201], v20 offset:24576
    ds_read_b64_tr_b16 v[202:203], v20 offset:26624
    v_exp_f32 v169, v169
    v_add_f32 v225, v225, v167
    v_cvt_pk_bf16_f32 v187, v166, v167
    s_waitcnt lgkmcnt(6)
    v_mfma_f32_32x32x16_bf16 v[80:95], v[216:219], v[180:183], v[80:95]
    ds_read_b64_tr_b16 v[204:205], v21 offset:24576
    ds_read_b64_tr_b16 v[206:207], v21 offset:26624
    v_exp_f32 v170, v170
    v_add_f32 v31, v31, v168
    v_exp_f32 v171, v171
    v_add_f32 v225, v225, v169
    v_mfma_f32_32x32x16_bf16 v[96:111], v[220:223], v[180:183], v[96:111]
    ds_read_b64_tr_b16 v[208:209], v18 offset:28672
    ds_read_b64_tr_b16 v[210:211], v18 offset:30720
    v_cvt_pk_bf16_f32 v188, v168, v169
    v_exp_f32 v172, v172
    v_add_f32 v31, v31, v170
    v_exp_f32 v173, v173
    s_waitcnt lgkmcnt(6)
    v_mfma_f32_32x32x16_bf16 v[48:63], v[192:195], v[184:187], v[48:63]
    ds_read_b64_tr_b16 v[212:213], v19 offset:28672
    ds_read_b64_tr_b16 v[214:215], v19 offset:30720
    v_add_f32 v225, v225, v171
    v_cvt_pk_bf16_f32 v189, v170, v171
    v_exp_f32 v174, v174
    v_mfma_f32_32x32x16_bf16 v[64:79], v[196:199], v[184:187], v[64:79]
    ds_read_b64_tr_b16 v[216:217], v20 offset:28672
    ds_read_b64_tr_b16 v[218:219], v20 offset:30720
    v_add_f32 v31, v31, v172
    v_exp_f32 v175, v175
    v_add_f32 v225, v225, v173
    v_cvt_pk_bf16_f32 v190, v172, v173
    s_waitcnt lgkmcnt(6)
    v_mfma_f32_32x32x16_bf16 v[80:95], v[200:203], v[184:187], v[80:95]
    ds_read_b64_tr_b16 v[220:221], v21 offset:28672
    ds_read_b64_tr_b16 v[222:223], v21 offset:30720
    v_add_f32 v31, v31, v174
    v_add_f32 v225, v225, v175
    v_cvt_pk_bf16_f32 v191, v174, v175
    v_mfma_f32_32x32x16_bf16 v[96:111], v[204:207], v[184:187], v[96:111]
    s_waitcnt lgkmcnt(4)
    v_mfma_f32_32x32x16_bf16 v[48:63], v[208:211], v[188:191], v[48:63]
    v_mfma_f32_32x32x16_bf16 v[64:79], v[212:215], v[188:191], v[64:79]
    s_waitcnt lgkmcnt(0)
    v_mfma_f32_32x32x16_bf16 v[80:95], v[216:219], v[188:191], v[80:95]
    v_mfma_f32_32x32x16_bf16 v[96:111], v[220:223], v[188:191], v[96:111]
    v_add_f32 v226, v31, v225
    v_mov_b32 v227, v226
    s_nop 1
    v_permlane32_swap_b32 v226, v227
    v_add_f32 v226, v226, v227
    v_rcp_f32 v226, v226
    v_lshlrev_b32 v227, 4, v0
    s_lshl_b32 s30, s28, 13
    v_add_u32 v227, s30, v227
    v_add_u32 v228, 4096, v227
    s_mov_b32 s31, 32768
    v_mul_f32 v48, v48, v226
    v_mul_f32 v49, v49, v226
    v_mul_f32 v50, v50, v226
    v_mul_f32 v51, v51, v226
    v_mul_f32 v52, v52, v226
    v_mul_f32 v53, v53, v226
    v_mul_f32 v54, v54, v226
    v_mul_f32 v55, v55, v226
    v_mul_f32 v56, v56, v226
    v_mul_f32 v57, v57, v226
    v_mul_f32 v58, v58, v226
    v_mul_f32 v59, v59, v226
    v_mul_f32 v60, v60, v226
    v_mul_f32 v61, v61, v226
    v_mul_f32 v62, v62, v226
    v_mul_f32 v63, v63, v226
    v_cvt_pk_bf16_f32 v176, v48, v49
    v_cvt_pk_bf16_f32 v177, v50, v51
    v_cvt_pk_bf16_f32 v178, v52, v53
    v_cvt_pk_bf16_f32 v179, v54, v55
    buffer_store_dwordx4 v[176:179], v227, s[20:23], s31 offen offset:0 sc1
    v_cvt_pk_bf16_f32 v180, v56, v57
    v_cvt_pk_bf16_f32 v181, v58, v59
    v_cvt_pk_bf16_f32 v182, v60, v61
    v_cvt_pk_bf16_f32 v183, v62, v63
    buffer_store_dwordx4 v[180:183], v227, s[20:23], s31 offen offset:1024 sc1
    v_mul_f32 v64, v64, v226
    v_mul_f32 v65, v65, v226
    v_mul_f32 v66, v66, v226
    v_mul_f32 v67, v67, v226
    v_mul_f32 v68, v68, v226
    v_mul_f32 v69, v69, v226
    v_mul_f32 v70, v70, v226
    v_mul_f32 v71, v71, v226
    v_mul_f32 v72, v72, v226
    v_mul_f32 v73, v73, v226
    v_mul_f32 v74, v74, v226
    v_mul_f32 v75, v75, v226
    v_mul_f32 v76, v76, v226
    v_mul_f32 v77, v77, v226
    v_mul_f32 v78, v78, v226
    v_mul_f32 v79, v79, v226
    v_cvt_pk_bf16_f32 v184, v64, v65
    v_cvt_pk_bf16_f32 v185, v66, v67
    v_cvt_pk_bf16_f32 v186, v68, v69
    v_cvt_pk_bf16_f32 v187, v70, v71
    buffer_store_dwordx4 v[184:187], v227, s[20:23], s31 offen offset:2048 sc1
    v_cvt_pk_bf16_f32 v188, v72, v73
    v_cvt_pk_bf16_f32 v189, v74, v75
    v_cvt_pk_bf16_f32 v190, v76, v77
    v_cvt_pk_bf16_f32 v191, v78, v79
    buffer_store_dwordx4 v[188:191], v227, s[20:23], s31 offen offset:3072 sc1
    v_mul_f32 v80, v80, v226
    v_mul_f32 v81, v81, v226
    v_mul_f32 v82, v82, v226
    v_mul_f32 v83, v83, v226
    v_mul_f32 v84, v84, v226
    v_mul_f32 v85, v85, v226
    v_mul_f32 v86, v86, v226
    v_mul_f32 v87, v87, v226
    v_mul_f32 v88, v88, v226
    v_mul_f32 v89, v89, v226
    v_mul_f32 v90, v90, v226
    v_mul_f32 v91, v91, v226
    v_mul_f32 v92, v92, v226
    v_mul_f32 v93, v93, v226
    v_mul_f32 v94, v94, v226
    v_mul_f32 v95, v95, v226
    v_cvt_pk_bf16_f32 v240, v80, v81
    v_cvt_pk_bf16_f32 v241, v82, v83
    v_cvt_pk_bf16_f32 v242, v84, v85
    v_cvt_pk_bf16_f32 v243, v86, v87
    buffer_store_dwordx4 v[240:243], v228, s[20:23], s31 offen offset:0 sc1
    v_cvt_pk_bf16_f32 v244, v88, v89
    v_cvt_pk_bf16_f32 v245, v90, v91
    v_cvt_pk_bf16_f32 v246, v92, v93
    v_cvt_pk_bf16_f32 v247, v94, v95
    buffer_store_dwordx4 v[244:247], v228, s[20:23], s31 offen offset:1024 sc1
    v_mul_f32 v96, v96, v226
    v_mul_f32 v97, v97, v226
    v_mul_f32 v98, v98, v226
    v_mul_f32 v99, v99, v226
    v_mul_f32 v100, v100, v226
    v_mul_f32 v101, v101, v226
    v_mul_f32 v102, v102, v226
    v_mul_f32 v103, v103, v226
    v_mul_f32 v104, v104, v226
    v_mul_f32 v105, v105, v226
    v_mul_f32 v106, v106, v226
    v_mul_f32 v107, v107, v226
    v_mul_f32 v108, v108, v226
    v_mul_f32 v109, v109, v226
    v_mul_f32 v110, v110, v226
    v_mul_f32 v111, v111, v226
    v_cvt_pk_bf16_f32 v248, v96, v97
    v_cvt_pk_bf16_f32 v249, v98, v99
    v_cvt_pk_bf16_f32 v250, v100, v101
    v_cvt_pk_bf16_f32 v251, v102, v103
    buffer_store_dwordx4 v[248:251], v228, s[20:23], s31 offen offset:2048 sc1
    v_cvt_pk_bf16_f32 v252, v104, v105
    v_cvt_pk_bf16_f32 v253, v106, v107
    v_cvt_pk_bf16_f32 v254, v108, v109
    v_cvt_pk_bf16_f32 v255, v110, v111
    buffer_store_dwordx4 v[252:255], v228, s[20:23], s31 offen offset:3072 sc1
    s_barrier
    ds_read_b128 v[112:115], v232 offset:16384
    ds_read_b128 v[116:119], v232 offset:17408
    ds_read_b128 v[120:123], v232 offset:18432
    ds_read_b128 v[124:127], v232 offset:19456
    ds_read_b128 v[128:131], v232 offset:32768
    ds_read_b128 v[132:135], v232 offset:33792
    ds_read_b128 v[136:139], v232 offset:34816
    ds_read_b128 v[140:143], v232 offset:35840
    ds_read_b128 v[192:195], v2 offset:32768
    ds_read_b128 v[196:199], v3 offset:32768
    ds_read_b128 v[200:203], v4 offset:32768
    ds_read_b128 v[204:207], v5 offset:32768
    ds_read_b128 v[208:211], v6 offset:32768
    s_waitcnt lgkmcnt(5)
    ds_write_b128 v232, v[176:179] offset:16384
    ds_write_b128 v232, v[180:183] offset:17408
    ds_write_b128 v232, v[184:187] offset:18432
    ds_write_b128 v232, v[188:191] offset:19456
    ds_write_b128 v232, v[240:243] offset:32768
    ds_write_b128 v232, v[244:247] offset:33792
    ds_write_b128 v232, v[248:251] offset:34816
    ds_write_b128 v232, v[252:255] offset:35840
    s_waitcnt lgkmcnt(11)
    v_mfma_f32_32x32x16_bf16 v[144:159], v[192:195], v[112:115], 0
    ds_read_b128 v[212:215], v7 offset:32768
    v_mfma_f32_32x32x16_bf16 v[144:159], v[196:199], v[116:119], v[144:159]
    ds_read_b128 v[216:219], v8 offset:32768
    s_waitcnt lgkmcnt(11)
    v_mfma_f32_32x32x16_bf16 v[144:159], v[200:203], v[120:123], v[144:159]
    ds_read_b128 v[220:223], v9 offset:32768
    v_mfma_f32_32x32x16_bf16 v[144:159], v[204:207], v[124:127], v[144:159]
    ds_read_b128 v[192:195], v2 offset:40960
    s_waitcnt lgkmcnt(3)
    v_mfma_f32_32x32x16_bf16 v[144:159], v[208:211], v[128:131], v[144:159]
    ds_read_b128 v[196:199], v3 offset:40960
    v_mfma_f32_32x32x16_bf16 v[144:159], v[212:215], v[132:135], v[144:159]
    ds_read_b128 v[200:203], v4 offset:40960
    s_waitcnt lgkmcnt(3)
    v_mfma_f32_32x32x16_bf16 v[144:159], v[216:219], v[136:139], v[144:159]
    ds_read_b128 v[204:207], v5 offset:40960
    v_mfma_f32_32x32x16_bf16 v[144:159], v[220:223], v[140:143], v[144:159]
    ds_read_b128 v[208:211], v6 offset:40960
    s_nop 10
    v_max3_f32 v224, v144, v145, v146
    v_max3_f32 v226, v147, v148, v149
    v_max3_f32 v224, v224, v150, v151
    v_max3_f32 v226, v226, v152, v153
    v_max3_f32 v224, v224, v154, v155
    v_max3_f32 v226, v226, v156, v157
    v_max3_f32 v224, v224, v158, v159
    v_max_f32 v224, v224, v226
    v_mov_b32 v226, v224
    s_nop 1
    v_permlane32_swap_b32 v224, v226
    v_max_f32 v226, v226, v224
    v_mov_b32 v31, 0
    v_mov_b32 v225, 0
    v_sub_f32 v144, v144, v226
    v_sub_f32 v145, v145, v226
    v_sub_f32 v146, v146, v226
    v_sub_f32 v147, v147, v226
    v_sub_f32 v148, v148, v226
    v_sub_f32 v149, v149, v226
    v_sub_f32 v150, v150, v226
    v_sub_f32 v151, v151, v226
    v_sub_f32 v152, v152, v226
    v_sub_f32 v153, v153, v226
    v_sub_f32 v154, v154, v226
    v_sub_f32 v155, v155, v226
    v_sub_f32 v156, v156, v226
    v_sub_f32 v157, v157, v226
    v_sub_f32 v158, v158, v226
    v_sub_f32 v159, v159, v226
    v_sub_f32 v32, 0, v226
    v_sub_f32 v33, 0, v226
    v_sub_f32 v34, 0, v226
    v_sub_f32 v35, 0, v226
    v_sub_f32 v36, 0, v226
    v_sub_f32 v37, 0, v226
    v_sub_f32 v38, 0, v226
    v_sub_f32 v39, 0, v226
    v_sub_f32 v40, 0, v226
    v_sub_f32 v41, 0, v226
    v_sub_f32 v42, 0, v226
    v_sub_f32 v43, 0, v226
    v_sub_f32 v44, 0, v226
    v_sub_f32 v45, 0, v226
    v_sub_f32 v46, 0, v226
    v_sub_f32 v47, 0, v226
    s_waitcnt lgkmcnt(3)
    s_nop 0
    v_mfma_f32_32x32x16_bf16 v[160:175], v[192:195], v[112:115], v[32:47]
    ds_read_b128 v[212:215], v7 offset:40960
    v_exp_f32 v144, v144
    v_exp_f32 v145, v145
    v_exp_f32 v146, v146
    v_add_f32 v31, v31, v144
    v_exp_f32 v147, v147
    v_mfma_f32_32x32x16_bf16 v[160:175], v[196:199], v[116:119], v[160:175]
    ds_read_b128 v[216:219], v8 offset:40960
    v_add_f32 v225, v225, v145
    v_cvt_pk_bf16_f32 v176, v144, v145
    v_exp_f32 v148, v148
    v_add_f32 v31, v31, v146
    v_exp_f32 v149, v149
    s_waitcnt lgkmcnt(3)
    v_mfma_f32_32x32x16_bf16 v[160:175], v[200:203], v[120:123], v[160:175]
    ds_read_b128 v[220:223], v9 offset:40960
    v_add_f32 v225, v225, v147
    v_cvt_pk_bf16_f32 v177, v146, v147
    v_exp_f32 v150, v150
    v_add_f32 v31, v31, v148
    v_exp_f32 v151, v151
    v_mfma_f32_32x32x16_bf16 v[160:175], v[204:207], v[124:127], v[160:175]
    ds_read_b128 v[192:195], v2 offset:49152
    v_add_f32 v225, v225, v149
    v_cvt_pk_bf16_f32 v178, v148, v149
    v_exp_f32 v152, v152
    v_add_f32 v31, v31, v150
    v_exp_f32 v153, v153
    s_waitcnt lgkmcnt(3)
    v_mfma_f32_32x32x16_bf16 v[160:175], v[208:211], v[128:131], v[160:175]
    ds_read_b128 v[196:199], v3 offset:49152
    v_add_f32 v225, v225, v151
    v_cvt_pk_bf16_f32 v179, v150, v151
    v_exp_f32 v154, v154
    v_add_f32 v31, v31, v152
    v_exp_f32 v155, v155
    v_mfma_f32_32x32x16_bf16 v[160:175], v[212:215], v[132:135], v[160:175]
    ds_read_b128 v[200:203], v4 offset:49152
    v_add_f32 v225, v225, v153
    v_cvt_pk_bf16_f32 v180, v152, v153
    v_exp_f32 v156, v156
    v_add_f32 v31, v31, v154
    v_exp_f32 v157, v157
    s_waitcnt lgkmcnt(3)
    v_mfma_f32_32x32x16_bf16 v[160:175], v[216:219], v[136:139], v[160:175]
    ds_read_b128 v[204:207], v5 offset:49152
    v_add_f32 v225, v225, v155
    v_cvt_pk_bf16_f32 v181, v154, v155
    v_exp_f32 v158, v158
    v_add_f32 v31, v31, v156
    v_exp_f32 v159, v159
    v_mfma_f32_32x32x16_bf16 v[160:175], v[220:223], v[140:143], v[160:175]
    ds_read_b128 v[208:211], v6 offset:49152
    v_add_f32 v225, v225, v157
    v_cvt_pk_bf16_f32 v182, v156, v157
    v_add_f32 v31, v31, v158
    v_add_f32 v225, v225, v159
    v_cvt_pk_bf16_f32 v183, v158, v159
    s_barrier
    s_nop 4
    v_max3_f32 v224, v160, v161, v162
    v_max3_f32 v226, v163, v164, v165
    v_max3_f32 v224, v224, v166, v167
    v_max3_f32 v226, v226, v168, v169
    v_max3_f32 v224, v224, v170, v171
    v_max3_f32 v226, v226, v172, v173
    v_max3_f32 v224, v224, v174, v175
    v_max_f32 v224, v224, v226
    v_cmp_lt_f32 vcc, s32, v224
    s_cbranch_vccnz SLOW_1_1
BACK_1_1:
    s_waitcnt lgkmcnt(3)
    v_mfma_f32_32x32x16_bf16 v[144:159], v[192:195], v[112:115], v[32:47]
    ds_read_b128 v[212:215], v7 offset:49152
    v_exp_f32 v160, v160
    v_exp_f32 v161, v161
    v_exp_f32 v162, v162
    v_add_f32 v31, v31, v160
    v_mfma_f32_32x32x16_bf16 v[144:159], v[196:199], v[116:119], v[144:159]
    ds_read_b128 v[216:219], v8 offset:49152
    v_exp_f32 v163, v163
    v_add_f32 v225, v225, v161
    v_cvt_pk_bf16_f32 v184, v160, v161
    s_waitcnt lgkmcnt(3)
    v_mfma_f32_32x32x16_bf16 v[144:159], v[200:203], v[120:123], v[144:159]
    ds_read_b128 v[220:223], v9 offset:49152
    v_exp_f32 v164, v164
    v_add_f32 v31, v31, v162
    v_exp_f32 v165, v165
    v_mfma_f32_32x32x16_bf16 v[144:159], v[204:207], v[124:127], v[144:159]
    ds_read_b64_tr_b16 v[192:193], v22 offset:32768
    ds_read_b64_tr_b16 v[194:195], v22 offset:34816
    v_add_f32 v225, v225, v163
    v_cvt_pk_bf16_f32 v185, v162, v163
    v_exp_f32 v166, v166
    s_waitcnt lgkmcnt(4)
    v_mfma_f32_32x32x16_bf16 v[144:159], v[208:211], v[128:131], v[144:159]
    ds_read_b64_tr_b16 v[196:197], v23 offset:32768
    ds_read_b64_tr_b16 v[198:199], v23 offset:34816
    v_add_f32 v31, v31, v164
    v_exp_f32 v167, v167
    v_add_f32 v225, v225, v165
    v_mfma_f32_32x32x16_bf16 v[144:159], v[212:215], v[132:135], v[144:159]
    ds_read_b64_tr_b16 v[200:201], v24 offset:32768
    ds_read_b64_tr_b16 v[202:203], v24 offset:34816
    v_cvt_pk_bf16_f32 v186, v164, v165
    v_exp_f32 v168, v168
    v_add_f32 v31, v31, v166
    s_waitcnt lgkmcnt(6)
    v_mfma_f32_32x32x16_bf16 v[144:159], v[216:219], v[136:139], v[144:159]
    ds_read_b64_tr_b16 v[204:205], v25 offset:32768
    ds_read_b64_tr_b16 v[206:207], v25 offset:34816
    v_exp_f32 v169, v169
    v_add_f32 v225, v225, v167
    v_cvt_pk_bf16_f32 v187, v166, v167
    v_mfma_f32_32x32x16_bf16 v[144:159], v[220:223], v[140:143], v[144:159]
    ds_read_b64_tr_b16 v[208:209], v22 offset:36864
    ds_read_b64_tr_b16 v[210:211], v22 offset:38912
    v_exp_f32 v170, v170
    v_add_f32 v31, v31, v168
    v_exp_f32 v171, v171
    s_waitcnt lgkmcnt(6)
    v_mfma_f32_32x32x16_bf16 v[48:63], v[192:195], v[176:179], 0
    ds_read_b64_tr_b16 v[212:213], v23 offset:36864
    ds_read_b64_tr_b16 v[214:215], v23 offset:38912
    v_add_f32 v225, v225, v169
    v_cvt_pk_bf16_f32 v188, v168, v169
    v_exp_f32 v172, v172
    v_mfma_f32_32x32x16_bf16 v[64:79], v[196:199], v[176:179], 0
    ds_read_b64_tr_b16 v[216:217], v24 offset:36864
    ds_read_b64_tr_b16 v[218:219], v24 offset:38912
    v_add_f32 v31, v31, v170
    v_exp_f32 v173, v173
    v_add_f32 v225, v225, v171
    s_waitcnt lgkmcnt(6)
    v_mfma_f32_32x32x16_bf16 v[80:95], v[200:203], v[176:179], 0
    ds_read_b64_tr_b16 v[220:221], v25 offset:36864
    ds_read_b64_tr_b16 v[222:223], v25 offset:38912
    v_cvt_pk_bf16_f32 v189, v170, v171
    v_exp_f32 v174, v174
    v_add_f32 v31, v31, v172
    v_mfma_f32_32x32x16_bf16 v[96:111], v[204:207], v[176:179], 0
    ds_read_b128 v[192:195], v2 offset:57344
    v_exp_f32 v175, v175
    v_add_f32 v225, v225, v173
    v_cvt_pk_bf16_f32 v190, v172, v173
    s_waitcnt lgkmcnt(5)
    v_mfma_f32_32x32x16_bf16 v[48:63], v[208:211], v[180:183], v[48:63]
    ds_read_b128 v[196:199], v3 offset:57344
    v_add_f32 v31, v31, v174
    v_add_f32 v225, v225, v175
    v_cvt_pk_bf16_f32 v191, v174, v175
    v_mfma_f32_32x32x16_bf16 v[64:79], v[212:215], v[180:183], v[64:79]
    ds_read_b128 v[200:203], v4 offset:57344
    v_max3_f32 v224, v144, v145, v146
    v_max3_f32 v226, v147, v148, v149
    v_max3_f32 v224, v224, v150, v151
    s_waitcnt lgkmcnt(3)
    v_mfma_f32_32x32x16_bf16 v[80:95], v[216:219], v[180:183], v[80:95]
    ds_read_b128 v[204:207], v5 offset:57344
    v_max3_f32 v226, v226, v152, v153
    v_max3_f32 v224, v224, v154, v155
    v_max3_f32 v226, v226, v156, v157
    v_mfma_f32_32x32x16_bf16 v[96:111], v[220:223], v[180:183], v[96:111]
    ds_read_b128 v[208:211], v6 offset:57344
    v_max3_f32 v224, v224, v158, v159
    v_max_f32 v224, v224, v226
    v_cmp_lt_f32 vcc, s32, v224
    s_cbranch_vccnz SLOW_1_2
BACK_1_2:
    s_waitcnt lgkmcnt(3)
    v_mfma_f32_32x32x16_bf16 v[160:175], v[192:195], v[112:115], v[32:47]
    ds_read_b128 v[212:215], v7 offset:57344
    v_exp_f32 v144, v144
    v_exp_f32 v145, v145
    v_exp_f32 v146, v146
    v_add_f32 v31, v31, v144
    v_mfma_f32_32x32x16_bf16 v[160:175], v[196:199], v[116:119], v[160:175]
    ds_read_b128 v[216:219], v8 offset:57344
    v_exp_f32 v147, v147
    v_add_f32 v225, v225, v145
    v_cvt_pk_bf16_f32 v176, v144, v145
    s_waitcnt lgkmcnt(3)
    v_mfma_f32_32x32x16_bf16 v[160:175], v[200:203], v[120:123], v[160:175]
    ds_read_b128 v[220:223], v9 offset:57344
    v_exp_f32 v148, v148
    v_add_f32 v31, v31, v146
    v_exp_f32 v149, v149
    v_mfma_f32_32x32x16_bf16 v[160:175], v[204:207], v[124:127], v[160:175]
    ds_read_b64_tr_b16 v[192:193], v22 offset:40960
    ds_read_b64_tr_b16 v[194:195], v22 offset:43008
    v_add_f32 v225, v225, v147
    v_cvt_pk_bf16_f32 v177, v146, v147
    v_exp_f32 v150, v150
    s_waitcnt lgkmcnt(4)
    v_mfma_f32_32x32x16_bf16 v[160:175], v[208:211], v[128:131], v[160:175]
    ds_read_b64_tr_b16 v[196:197], v23 offset:40960
    ds_read_b64_tr_b16 v[198:199], v23 offset:43008
    v_add_f32 v31, v31, v148
    v_exp_f32 v151, v151
    v_add_f32 v225, v225, v149
    v_mfma_f32_32x32x16_bf16 v[160:175], v[212:215], v[132:135], v[160:175]
    ds_read_b64_tr_b16 v[200:201], v24 offset:40960
    ds_read_b64_tr_b16 v[202:203], v24 offset:43008
    v_cvt_pk_bf16_f32 v178, v148, v149
    v_exp_f32 v152, v152
    v_add_f32 v31, v31, v150
    s_waitcnt lgkmcnt(6)
    v_mfma_f32_32x32x16_bf16 v[160:175], v[216:219], v[136:139], v[160:175]
    ds_read_b64_tr_b16 v[204:205], v25 offset:40960
    ds_read_b64_tr_b16 v[206:207], v25 offset:43008
    v_exp_f32 v153, v153
    v_add_f32 v225, v225, v151
    v_cvt_pk_bf16_f32 v179, v150, v151
    v_mfma_f32_32x32x16_bf16 v[160:175], v[220:223], v[140:143], v[160:175]
    ds_read_b64_tr_b16 v[208:209], v22 offset:45056
    ds_read_b64_tr_b16 v[210:211], v22 offset:47104
    v_exp_f32 v154, v154
    v_add_f32 v31, v31, v152
    v_exp_f32 v155, v155
    s_waitcnt lgkmcnt(6)
    v_mfma_f32_32x32x16_bf16 v[48:63], v[192:195], v[184:187], v[48:63]
    ds_read_b64_tr_b16 v[212:213], v23 offset:45056
    ds_read_b64_tr_b16 v[214:215], v23 offset:47104
    v_add_f32 v225, v225, v153
    v_cvt_pk_bf16_f32 v180, v152, v153
    v_exp_f32 v156, v156
    v_mfma_f32_32x32x16_bf16 v[64:79], v[196:199], v[184:187], v[64:79]
    ds_read_b64_tr_b16 v[216:217], v24 offset:45056
    ds_read_b64_tr_b16 v[218:219], v24 offset:47104
    v_add_f32 v31, v31, v154
    v_exp_f32 v157, v157
    v_add_f32 v225, v225, v155
    s_waitcnt lgkmcnt(6)
    v_mfma_f32_32x32x16_bf16 v[80:95], v[200:203], v[184:187], v[80:95]
    ds_read_b64_tr_b16 v[220:221], v25 offset:45056
    ds_read_b64_tr_b16 v[222:223], v25 offset:47104
    v_cvt_pk_bf16_f32 v181, v154, v155
    v_exp_f32 v158, v158
    v_add_f32 v31, v31, v156
    v_mfma_f32_32x32x16_bf16 v[96:111], v[204:207], v[184:187], v[96:111]
    ds_read_b128 v[192:195], v10 offset:0
    v_exp_f32 v159, v159
    v_add_f32 v225, v225, v157
    v_cvt_pk_bf16_f32 v182, v156, v157
    s_waitcnt lgkmcnt(5)
    v_mfma_f32_32x32x16_bf16 v[48:63], v[208:211], v[188:191], v[48:63]
    ds_read_b128 v[196:199], v11 offset:0
    v_add_f32 v31, v31, v158
    v_add_f32 v225, v225, v159
    v_cvt_pk_bf16_f32 v183, v158, v159
    v_mfma_f32_32x32x16_bf16 v[64:79], v[212:215], v[188:191], v[64:79]
    ds_read_b128 v[200:203], v12 offset:0
    v_max3_f32 v224, v160, v161, v162
    v_max3_f32 v226, v163, v164, v165
    v_max3_f32 v224, v224, v166, v167
    s_waitcnt lgkmcnt(3)
    v_mfma_f32_32x32x16_bf16 v[80:95], v[216:219], v[188:191], v[80:95]
    ds_read_b128 v[204:207], v13 offset:0
    v_max3_f32 v226, v226, v168, v169
    v_max3_f32 v224, v224, v170, v171
    v_max3_f32 v226, v226, v172, v173
    v_mfma_f32_32x32x16_bf16 v[96:111], v[220:223], v[188:191], v[96:111]
    ds_read_b128 v[208:211], v14 offset:0
    v_max3_f32 v224, v224, v174, v175
    v_max_f32 v224, v224, v226
    v_cmp_lt_f32 vcc, s32, v224
    s_waitcnt vmcnt(0)
    s_lshl_b32 s31, s28, 5
    s_add_u32 s30, s35, s31
    s_lshl_b32 s30, s30, 2
    v_mov_b32 v229, 0
    v_mov_b32 v230, s89
    s_mov_b64 exec, 1
    buffer_store_dword v230, v229, s[24:27], s30 offen sc1
    s_mov_b64 exec, -1
    s_barrier
    s_cbranch_vccnz SLOW_1_3
BACK_1_3:
    s_waitcnt lgkmcnt(3)
    v_mfma_f32_32x32x16_bf16 v[144:159], v[192:195], v[112:115], v[32:47]
    ds_read_b128 v[212:215], v15 offset:0
    v_exp_f32 v160, v160
    v_exp_f32 v161, v161
    v_exp_f32 v162, v162
    v_add_f32 v31, v31, v160
    v_mfma_f32_32x32x16_bf16 v[144:159], v[196:199], v[116:119], v[144:159]
    ds_read_b128 v[216:219], v16 offset:0
    v_exp_f32 v163, v163
    v_add_f32 v225, v225, v161
    v_cvt_pk_bf16_f32 v184, v160, v161
    s_waitcnt lgkmcnt(3)
    v_mfma_f32_32x32x16_bf16 v[144:159], v[200:203], v[120:123], v[144:159]
    ds_read_b128 v[220:223], v17 offset:0
    v_exp_f32 v164, v164
    v_add_f32 v31, v31, v162
    v_exp_f32 v165, v165
    v_mfma_f32_32x32x16_bf16 v[144:159], v[204:207], v[124:127], v[144:159]
    ds_read_b64_tr_b16 v[192:193], v22 offset:16384
    ds_read_b64_tr_b16 v[194:195], v22 offset:18432
    v_add_f32 v225, v225, v163
    v_cvt_pk_bf16_f32 v185, v162, v163
    v_exp_f32 v166, v166
    s_waitcnt lgkmcnt(4)
    v_mfma_f32_32x32x16_bf16 v[144:159], v[208:211], v[128:131], v[144:159]
    ds_read_b64_tr_b16 v[196:197], v23 offset:16384
    ds_read_b64_tr_b16 v[198:199], v23 offset:18432
    v_add_f32 v31, v31, v164
    v_exp_f32 v167, v167
    v_add_f32 v225, v225, v165
    v_mfma_f32_32x32x16_bf16 v[144:159], v[212:215], v[132:135], v[144:159]
    ds_read_b64_tr_b16 v[200:201], v24 offset:16384
    ds_read_b64_tr_b16 v[202:203], v24 offset:18432
    v_cvt_pk_bf16_f32 v186, v164, v165
    v_exp_f32 v168, v168
    v_add_f32 v31, v31, v166
    s_waitcnt lgkmcnt(6)
    v_mfma_f32_32x32x16_bf16 v[144:159], v[216:219], v[136:139], v[144:159]
    ds_read_b64_tr_b16 v[204:205], v25 offset:16384
    ds_read_b64_tr_b16 v[206:207], v25 offset:18432
    v_exp_f32 v169, v169
    v_add_f32 v225, v225, v167
    v_cvt_pk_bf16_f32 v187, v166, v167
    v_mfma_f32_32x32x16_bf16 v[144:159], v[220:223], v[140:143], v[144:159]
    ds_read_b64_tr_b16 v[208:209], v22 offset:20480
    ds_read_b64_tr_b16 v[210:211], v22 offset:22528
    v_exp_f32 v170, v170
    v_add_f32 v31, v31, v168
    v_exp_f32 v171, v171
    s_waitcnt lgkmcnt(6)
    v_mfma_f32_32x32x16_bf16 v[48:63], v[192:195], v[176:179], v[48:63]
    ds_read_b64_tr_b16 v[212:213], v23 offset:20480
    ds_read_b64_tr_b16 v[214:215], v23 offset:22528
    v_add_f32 v225, v225, v169
    v_cvt_pk_bf16_f32 v188, v168, v169
    v_exp_f32 v172, v172
    v_mfma_f32_32x32x16_bf16 v[64:79], v[196:199], v[176:179], v[64:79]
    ds_read_b64_tr_b16 v[216:217], v24 offset:20480
    ds_read_b64_tr_b16 v[218:219], v24 offset:22528
    v_add_f32 v31, v31, v170
    v_exp_f32 v173, v173
    v_add_f32 v225, v225, v171
    s_waitcnt lgkmcnt(6)
    v_mfma_f32_32x32x16_bf16 v[80:95], v[200:203], v[176:179], v[80:95]
    ds_read_b64_tr_b16 v[220:221], v25 offset:20480
    ds_read_b64_tr_b16 v[222:223], v25 offset:22528
    v_cvt_pk_bf16_f32 v189, v170, v171
    v_exp_f32 v174, v174
    v_add_f32 v31, v31, v172
    v_mfma_f32_32x32x16_bf16 v[96:111], v[204:207], v[176:179], v[96:111]
    ds_read_b128 v[192:195], v10 offset:8192
    v_exp_f32 v175, v175
    v_add_f32 v225, v225, v173
    v_cvt_pk_bf16_f32 v190, v172, v173
    s_waitcnt lgkmcnt(5)
    v_mfma_f32_32x32x16_bf16 v[48:63], v[208:211], v[180:183], v[48:63]
    ds_read_b128 v[196:199], v11 offset:8192
    v_add_f32 v31, v31, v174
    v_add_f32 v225, v225, v175
    v_cvt_pk_bf16_f32 v191, v174, v175
    v_mfma_f32_32x32x16_bf16 v[64:79], v[212:215], v[180:183], v[64:79]
    ds_read_b128 v[200:203], v12 offset:8192
    v_max3_f32 v224, v144, v145, v146
    v_max3_f32 v226, v147, v148, v149
    v_max3_f32 v224, v224, v150, v151
    s_waitcnt lgkmcnt(3)
    v_mfma_f32_32x32x16_bf16 v[80:95], v[216:219], v[180:183], v[80:95]
    ds_read_b128 v[204:207], v13 offset:8192
    v_max3_f32 v226, v226, v152, v153
    v_max3_f32 v224, v224, v154, v155
    v_max3_f32 v226, v226, v156, v157
    v_mfma_f32_32x32x16_bf16 v[96:111], v[220:223], v[180:183], v[96:111]
    ds_read_b128 v[208:211], v14 offset:8192
    v_max3_f32 v224, v224, v158, v159
    v_max_f32 v224, v224, v226
    v_cmp_lt_f32 vcc, s32, v224
    s_cbranch_vccnz SLOW_1_4
BACK_1_4:
    s_waitcnt lgkmcnt(3)
    v_mfma_f32_32x32x16_bf16 v[160:175], v[192:195], v[112:115], v[32:47]
    ds_read_b128 v[212:215], v15 offset:8192
    v_exp_f32 v144, v144
    v_exp_f32 v145, v145
    v_exp_f32 v146, v146
    v_add_f32 v31, v31, v144
    v_mfma_f32_32x32x16_bf16 v[160:175], v[196:199], v[116:119], v[160:175]
    ds_read_b128 v[216:219], v16 offset:8192
    v_exp_f32 v147, v147
    v_add_f32 v225, v225, v145
    v_cvt_pk_bf16_f32 v176, v144, v145
    s_waitcnt lgkmcnt(3)
    v_mfma_f32_32x32x16_bf16 v[160:175], v[200:203], v[120:123], v[160:175]
    ds_read_b128 v[220:223], v17 offset:8192
    v_exp_f32 v148, v148
    v_add_f32 v31, v31, v146
    v_exp_f32 v149, v149
    v_mfma_f32_32x32x16_bf16 v[160:175], v[204:207], v[124:127], v[160:175]
    ds_read_b64_tr_b16 v[192:193], v22 offset:24576
    ds_read_b64_tr_b16 v[194:195], v22 offset:26624
    v_add_f32 v225, v225, v147
    v_cvt_pk_bf16_f32 v177, v146, v147
    v_exp_f32 v150, v150
    s_waitcnt lgkmcnt(4)
    v_mfma_f32_32x32x16_bf16 v[160:175], v[208:211], v[128:131], v[160:175]
    ds_read_b64_tr_b16 v[196:197], v23 offset:24576
    ds_read_b64_tr_b16 v[198:199], v23 offset:26624
    v_add_f32 v31, v31, v148
    v_exp_f32 v151, v151
    v_add_f32 v225, v225, v149
    v_mfma_f32_32x32x16_bf16 v[160:175], v[212:215], v[132:135], v[160:175]
    ds_read_b64_tr_b16 v[200:201], v24 offset:24576
    ds_read_b64_tr_b16 v[202:203], v24 offset:26624
    v_cvt_pk_bf16_f32 v178, v148, v149
    v_exp_f32 v152, v152
    v_add_f32 v31, v31, v150
    s_waitcnt lgkmcnt(6)
    v_mfma_f32_32x32x16_bf16 v[160:175], v[216:219], v[136:139], v[160:175]
    ds_read_b64_tr_b16 v[204:205], v25 offset:24576
    ds_read_b64_tr_b16 v[206:207], v25 offset:26624
    v_exp_f32 v153, v153
    v_add_f32 v225, v225, v151
    v_cvt_pk_bf16_f32 v179, v150, v151
    v_mfma_f32_32x32x16_bf16 v[160:175], v[220:223], v[140:143], v[160:175]
    ds_read_b64_tr_b16 v[208:209], v22 offset:28672
    ds_read_b64_tr_b16 v[210:211], v22 offset:30720
    v_exp_f32 v154, v154
    v_add_f32 v31, v31, v152
    v_exp_f32 v155, v155
    s_waitcnt lgkmcnt(6)
    v_mfma_f32_32x32x16_bf16 v[48:63], v[192:195], v[184:187], v[48:63]
    ds_read_b64_tr_b16 v[212:213], v23 offset:28672
    ds_read_b64_tr_b16 v[214:215], v23 offset:30720
    v_add_f32 v225, v225, v153
    v_cvt_pk_bf16_f32 v180, v152, v153
    v_exp_f32 v156, v156
    v_mfma_f32_32x32x16_bf16 v[64:79], v[196:199], v[184:187], v[64:79]
    ds_read_b64_tr_b16 v[216:217], v24 offset:28672
    ds_read_b64_tr_b16 v[218:219], v24 offset:30720
    v_add_f32 v31, v31, v154
    v_exp_f32 v157, v157
    v_add_f32 v225, v225, v155
    s_waitcnt lgkmcnt(6)
    v_mfma_f32_32x32x16_bf16 v[80:95], v[200:203], v[184:187], v[80:95]
    ds_read_b64_tr_b16 v[220:221], v25 offset:28672
    ds_read_b64_tr_b16 v[222:223], v25 offset:30720
    v_cvt_pk_bf16_f32 v181, v154, v155
    v_exp_f32 v158, v158
    v_add_f32 v31, v31, v156
    v_mfma_f32_32x32x16_bf16 v[96:111], v[204:207], v[184:187], v[96:111]
    ds_read_b128 v[192:195], v2 offset:0
    v_exp_f32 v159, v159
    v_add_f32 v225, v225, v157
    v_cvt_pk_bf16_f32 v182, v156, v157
    s_waitcnt lgkmcnt(5)
    v_mfma_f32_32x32x16_bf16 v[48:63], v[208:211], v[188:191], v[48:63]
    ds_read_b128 v[196:199], v3 offset:0
    v_add_f32 v31, v31, v158
    v_add_f32 v225, v225, v159
    v_cvt_pk_bf16_f32 v183, v158, v159
    v_mfma_f32_32x32x16_bf16 v[64:79], v[212:215], v[188:191], v[64:79]
    ds_read_b128 v[200:203], v4 offset:0
    v_max3_f32 v224, v160, v161, v162
    v_max3_f32 v226, v163, v164, v165
    v_max3_f32 v224, v224, v166, v167
    s_waitcnt lgkmcnt(3)
    v_mfma_f32_32x32x16_bf16 v[80:95], v[216:219], v[188:191], v[80:95]
    ds_read_b128 v[204:207], v5 offset:0
    v_max3_f32 v226, v226, v168, v169
    v_max3_f32 v224, v224, v170, v171
    v_max3_f32 v226, v226, v172, v173
    v_mfma_f32_32x32x16_bf16 v[96:111], v[220:223], v[188:191], v[96:111]
    ds_read_b128 v[208:211], v6 offset:0
    v_max3_f32 v224, v224, v174, v175
    v_max_f32 v224, v224, v226
    v_cmp_lt_f32 vcc, s32, v224
    s_barrier
    s_cbranch_vccnz SLOW_1_5
BACK_1_5:
    s_waitcnt lgkmcnt(3)
    v_mfma_f32_32x32x16_bf16 v[144:159], v[192:195], v[112:115], v[32:47]
    ds_read_b128 v[212:215], v7 offset:0
    v_exp_f32 v160, v160
    v_exp_f32 v161, v161
    v_exp_f32 v162, v162
    v_add_f32 v31, v31, v160
    v_mfma_f32_32x32x16_bf16 v[144:159], v[196:199], v[116:119], v[144:159]
    ds_read_b128 v[216:219], v8 offset:0
    v_exp_f32 v163, v163
    v_add_f32 v225, v225, v161
    v_cvt_pk_bf16_f32 v184, v160, v161
    s_waitcnt lgkmcnt(3)
    v_mfma_f32_32x32x16_bf16 v[144:159], v[200:203], v[120:123], v[144:159]
    ds_read_b128 v[220:223], v9 offset:0
    v_exp_f32 v164, v164
    v_add_f32 v31, v31, v162
    v_exp_f32 v165, v165
    v_mfma_f32_32x32x16_bf16 v[144:159], v[204:207], v[124:127], v[144:159]
    ds_read_b64_tr_b16 v[192:193], v18 offset:16384
    ds_read_b64_tr_b16 v[194:195], v18 offset:18432
    v_add_f32 v225, v225, v163
    v_cvt_pk_bf16_f32 v185, v162, v163
    v_exp_f32 v166, v166
    s_waitcnt lgkmcnt(4)
    v_mfma_f32_32x32x16_bf16 v[144:159], v[208:211], v[128:131], v[144:159]
    ds_read_b64_tr_b16 v[196:197], v19 offset:16384
    ds_read_b64_tr_b16 v[198:199], v19 offset:18432
    v_add_f32 v31, v31, v164
    v_exp_f32 v167, v167
    v_add_f32 v225, v225, v165
    v_mfma_f32_32x32x16_bf16 v[144:159], v[212:215], v[132:135], v[144:159]
    ds_read_b64_tr_b16 v[200:201], v20 offset:16384
    ds_read_b64_tr_b16 v[202:203], v20 offset:18432
    v_cvt_pk_bf16_f32 v186, v164, v165
    v_exp_f32 v168, v168
    v_add_f32 v31, v31, v166
    s_waitcnt lgkmcnt(6)
    v_mfma_f32_32x32x16_bf16 v[144:159], v[216:219], v[136:139], v[144:159]
    ds_read_b64_tr_b16 v[204:205], v21 offset:16384
    ds_read_b64_tr_b16 v[206:207], v21 offset:18432
    v_exp_f32 v169, v169
    v_add_f32 v225, v225, v167
    v_cvt_pk_bf16_f32 v187, v166, v167
    v_mfma_f32_32x32x16_bf16 v[144:159], v[220:223], v[140:143], v[144:159]
    ds_read_b64_tr_b16 v[208:209], v18 offset:20480
    ds_read_b64_tr_b16 v[210:211], v18 offset:22528
    v_exp_f32 v170, v170
    v_add_f32 v31, v31, v168
    v_exp_f32 v171, v171
    s_waitcnt lgkmcnt(6)
    v_mfma_f32_32x32x16_bf16 v[48:63], v[192:195], v[176:179], v[48:63]
    ds_read_b64_tr_b16 v[212:213], v19 offset:20480
    ds_read_b64_tr_b16 v[214:215], v19 offset:22528
    v_add_f32 v225, v225, v169
    v_cvt_pk_bf16_f32 v188, v168, v169
    v_exp_f32 v172, v172
    v_mfma_f32_32x32x16_bf16 v[64:79], v[196:199], v[176:179], v[64:79]
    ds_read_b64_tr_b16 v[216:217], v20 offset:20480
    ds_read_b64_tr_b16 v[218:219], v20 offset:22528
    v_add_f32 v31, v31, v170
    v_exp_f32 v173, v173
    v_add_f32 v225, v225, v171
    s_waitcnt lgkmcnt(6)
    v_mfma_f32_32x32x16_bf16 v[80:95], v[200:203], v[176:179], v[80:95]
    ds_read_b64_tr_b16 v[220:221], v21 offset:20480
    ds_read_b64_tr_b16 v[222:223], v21 offset:22528
    v_cvt_pk_bf16_f32 v189, v170, v171
    v_exp_f32 v174, v174
    v_add_f32 v31, v31, v172
    v_mfma_f32_32x32x16_bf16 v[96:111], v[204:207], v[176:179], v[96:111]
    ds_read_b128 v[192:195], v2 offset:8192
    v_exp_f32 v175, v175
    v_add_f32 v225, v225, v173
    v_cvt_pk_bf16_f32 v190, v172, v173
    s_waitcnt lgkmcnt(5)
    v_mfma_f32_32x32x16_bf16 v[48:63], v[208:211], v[180:183], v[48:63]
    ds_read_b128 v[196:199], v3 offset:8192
    v_add_f32 v31, v31, v174
    v_add_f32 v225, v225, v175
    v_cvt_pk_bf16_f32 v191, v174, v175
    v_mfma_f32_32x32x16_bf16 v[64:79], v[212:215], v[180:183], v[64:79]
    ds_read_b128 v[200:203], v4 offset:8192
    v_max3_f32 v224, v144, v145, v146
    v_max3_f32 v226, v147, v148, v149
    v_max3_f32 v224, v224, v150, v151
    s_waitcnt lgkmcnt(3)
    v_mfma_f32_32x32x16_bf16 v[80:95], v[216:219], v[180:183], v[80:95]
    ds_read_b128 v[204:207], v5 offset:8192
    v_max3_f32 v226, v226, v152, v153
    v_max3_f32 v224, v224, v154, v155
    v_max3_f32 v226, v226, v156, v157
    v_mfma_f32_32x32x16_bf16 v[96:111], v[220:223], v[180:183], v[96:111]
    ds_read_b128 v[208:211], v6 offset:8192
    v_max3_f32 v224, v224, v158, v159
    v_max_f32 v224, v224, v226
    v_cmp_lt_f32 vcc, s32, v224
    s_cbranch_vccnz SLOW_1_6
BACK_1_6:
    s_waitcnt lgkmcnt(3)
    v_mfma_f32_32x32x16_bf16 v[160:175], v[192:195], v[112:115], v[32:47]
    ds_read_b128 v[212:215], v7 offset:8192
    v_exp_f32 v144, v144
    v_exp_f32 v145, v145
    v_exp_f32 v146, v146
    v_add_f32 v31, v31, v144
    v_mfma_f32_32x32x16_bf16 v[160:175], v[196:199], v[116:119], v[160:175]
    ds_read_b128 v[216:219], v8 offset:8192
    v_exp_f32 v147, v147
    v_add_f32 v225, v225, v145
    v_cvt_pk_bf16_f32 v176, v144, v145
    s_waitcnt lgkmcnt(3)
    v_mfma_f32_32x32x16_bf16 v[160:175], v[200:203], v[120:123], v[160:175]
    ds_read_b128 v[220:223], v9 offset:8192
    v_exp_f32 v148, v148
    v_add_f32 v31, v31, v146
    v_exp_f32 v149, v149
    v_mfma_f32_32x32x16_bf16 v[160:175], v[204:207], v[124:127], v[160:175]
    ds_read_b64_tr_b16 v[192:193], v18 offset:24576
    ds_read_b64_tr_b16 v[194:195], v18 offset:26624
    v_add_f32 v225, v225, v147
    v_cvt_pk_bf16_f32 v177, v146, v147
    v_exp_f32 v150, v150
    s_waitcnt lgkmcnt(4)
    v_mfma_f32_32x32x16_bf16 v[160:175], v[208:211], v[128:131], v[160:175]
    ds_read_b64_tr_b16 v[196:197], v19 offset:24576
    ds_read_b64_tr_b16 v[198:199], v19 offset:26624
    v_add_f32 v31, v31, v148
    v_exp_f32 v151, v151
    v_add_f32 v225, v225, v149
    v_mfma_f32_32x32x16_bf16 v[160:175], v[212:215], v[132:135], v[160:175]
    ds_read_b64_tr_b16 v[200:201], v20 offset:24576
    ds_read_b64_tr_b16 v[202:203], v20 offset:26624
    v_cvt_pk_bf16_f32 v178, v148, v149
    v_exp_f32 v152, v152
    v_add_f32 v31, v31, v150
    s_waitcnt lgkmcnt(6)
    v_mfma_f32_32x32x16_bf16 v[160:175], v[216:219], v[136:139], v[160:175]
    ds_read_b64_tr_b16 v[204:205], v21 offset:24576
    ds_read_b64_tr_b16 v[206:207], v21 offset:26624
    v_exp_f32 v153, v153
    v_add_f32 v225, v225, v151
    v_cvt_pk_bf16_f32 v179, v150, v151
    v_mfma_f32_32x32x16_bf16 v[160:175], v[220:223], v[140:143], v[160:175]
    ds_read_b64_tr_b16 v[208:209], v18 offset:28672
    ds_read_b64_tr_b16 v[210:211], v18 offset:30720
    v_exp_f32 v154, v154
    v_add_f32 v31, v31, v152
    v_exp_f32 v155, v155
    s_waitcnt lgkmcnt(6)
    v_mfma_f32_32x32x16_bf16 v[48:63], v[192:195], v[184:187], v[48:63]
    ds_read_b64_tr_b16 v[212:213], v19 offset:28672
    ds_read_b64_tr_b16 v[214:215], v19 offset:30720
    v_add_f32 v225, v225, v153
    v_cvt_pk_bf16_f32 v180, v152, v153
    v_exp_f32 v156, v156
    v_mfma_f32_32x32x16_bf16 v[64:79], v[196:199], v[184:187], v[64:79]
    ds_read_b64_tr_b16 v[216:217], v20 offset:28672
    ds_read_b64_tr_b16 v[218:219], v20 offset:30720
    v_add_f32 v31, v31, v154
    v_exp_f32 v157, v157
    v_add_f32 v225, v225, v155
    s_waitcnt lgkmcnt(6)
    v_mfma_f32_32x32x16_bf16 v[80:95], v[200:203], v[184:187], v[80:95]
    ds_read_b64_tr_b16 v[220:221], v21 offset:28672
    ds_read_b64_tr_b16 v[222:223], v21 offset:30720
    v_cvt_pk_bf16_f32 v181, v154, v155
    v_exp_f32 v158, v158
    v_add_f32 v31, v31, v156
    v_mfma_f32_32x32x16_bf16 v[96:111], v[204:207], v[184:187], v[96:111]
    ds_read_b128 v[192:195], v2 offset:32768
    v_exp_f32 v159, v159
    v_add_f32 v225, v225, v157
    v_cvt_pk_bf16_f32 v182, v156, v157
    s_waitcnt lgkmcnt(5)
    v_mfma_f32_32x32x16_bf16 v[48:63], v[208:211], v[188:191], v[48:63]
    ds_read_b128 v[196:199], v3 offset:32768
    v_add_f32 v31, v31, v158
    v_add_f32 v225, v225, v159
    v_cvt_pk_bf16_f32 v183, v158, v159
    v_mfma_f32_32x32x16_bf16 v[64:79], v[212:215], v[188:191], v[64:79]
    ds_read_b128 v[200:203], v4 offset:32768
    v_max3_f32 v224, v160, v161, v162
    v_max3_f32 v226, v163, v164, v165
    v_max3_f32 v224, v224, v166, v167
    s_waitcnt lgkmcnt(3)
    v_mfma_f32_32x32x16_bf16 v[80:95], v[216:219], v[188:191], v[80:95]
    ds_read_b128 v[204:207], v5 offset:32768
    v_max3_f32 v226, v226, v168, v169
    v_max3_f32 v224, v224, v170, v171
    v_max3_f32 v226, v226, v172, v173
    v_mfma_f32_32x32x16_bf16 v[96:111], v[220:223], v[188:191], v[96:111]
    ds_read_b128 v[208:211], v6 offset:32768
    v_max3_f32 v224, v224, v174, v175
    v_max_f32 v224, v224, v226
    v_cmp_lt_f32 vcc, s32, v224
    v_mov_b32 v233, 0
    s_lshl_b32 s30, s28, 7
    buffer_load_dwordx4 v[236:239], v233, s[24:27], s30 offen sc1
    s_barrier
    s_cbranch_vccnz SLOW_1_7
BACK_1_7:
    s_waitcnt lgkmcnt(3)
    v_mfma_f32_32x32x16_bf16 v[144:159], v[192:195], v[112:115], v[32:47]
    ds_read_b128 v[212:215], v7 offset:32768
    v_exp_f32 v160, v160
    v_exp_f32 v161, v161
    v_exp_f32 v162, v162
    v_add_f32 v31, v31, v160
    v_mfma_f32_32x32x16_bf16 v[144:159], v[196:199], v[116:119], v[144:159]
    ds_read_b128 v[216:219], v8 offset:32768
    v_exp_f32 v163, v163
    v_add_f32 v225, v225, v161
    v_cvt_pk_bf16_f32 v184, v160, v161
    s_waitcnt lgkmcnt(3)
    v_mfma_f32_32x32x16_bf16 v[144:159], v[200:203], v[120:123], v[144:159]
    ds_read_b128 v[220:223], v9 offset:32768
    v_exp_f32 v164, v164
    v_add_f32 v31, v31, v162
    v_exp_f32 v165, v165
    v_mfma_f32_32x32x16_bf16 v[144:159], v[204:207], v[124:127], v[144:159]
    ds_read_b64_tr_b16 v[192:193], v18 offset:49152
    ds_read_b64_tr_b16 v[194:195], v18 offset:51200
    v_add_f32 v225, v225, v163
    v_cvt_pk_bf16_f32 v185, v162, v163
    v_exp_f32 v166, v166
    s_waitcnt lgkmcnt(4)
    v_mfma_f32_32x32x16_bf16 v[144:159], v[208:211], v[128:131], v[144:159]
    ds_read_b64_tr_b16 v[196:197], v19 offset:49152
    ds_read_b64_tr_b16 v[198:199], v19 offset:51200
    v_add_f32 v31, v31, v164
    v_exp_f32 v167, v167
    v_add_f32 v225, v225, v165
    v_mfma_f32_32x32x16_bf16 v[144:159], v[212:215], v[132:135], v[144:159]
    ds_read_b64_tr_b16 v[200:201], v20 offset:49152
    ds_read_b64_tr_b16 v[202:203], v20 offset:51200
    v_cvt_pk_bf16_f32 v186, v164, v165
    v_exp_f32 v168, v168
    v_add_f32 v31, v31, v166
    s_waitcnt lgkmcnt(6)
    v_mfma_f32_32x32x16_bf16 v[144:159], v[216:219], v[136:139], v[144:159]
    ds_read_b64_tr_b16 v[204:205], v21 offset:49152
    ds_read_b64_tr_b16 v[206:207], v21 offset:51200
    v_exp_f32 v169, v169
    v_add_f32 v225, v225, v167
    v_cvt_pk_bf16_f32 v187, v166, v167
    v_mfma_f32_32x32x16_bf16 v[144:159], v[220:223], v[140:143], v[144:159]
    ds_read_b64_tr_b16 v[208:209], v18 offset:53248
    ds_read_b64_tr_b16 v[210:211], v18 offset:55296
    v_exp_f32 v170, v170
    v_add_f32 v31, v31, v168
    v_exp_f32 v171, v171
    s_waitcnt lgkmcnt(6)
    v_mfma_f32_32x32x16_bf16 v[48:63], v[192:195], v[176:179], v[48:63]
    ds_read_b64_tr_b16 v[212:213], v19 offset:53248
    ds_read_b64_tr_b16 v[214:215], v19 offset:55296
    v_add_f32 v225, v225, v169
    v_cvt_pk_bf16_f32 v188, v168, v169
    v_exp_f32 v172, v172
    v_mfma_f32_32x32x16_bf16 v[64:79], v[196:199], v[176:179], v[64:79]
    ds_read_b64_tr_b16 v[216:217], v20 offset:53248
    ds_read_b64_tr_b16 v[218:219], v20 offset:55296
    v_add_f32 v31, v31, v170
    v_exp_f32 v173, v173
    v_add_f32 v225, v225, v171
    s_waitcnt lgkmcnt(6)
    v_mfma_f32_32x32x16_bf16 v[80:95], v[200:203], v[176:179], v[80:95]
    ds_read_b64_tr_b16 v[220:221], v21 offset:53248
    ds_read_b64_tr_b16 v[222:223], v21 offset:55296
    v_cvt_pk_bf16_f32 v189, v170, v171
    v_exp_f32 v174, v174
    v_add_f32 v31, v31, v172
    v_mfma_f32_32x32x16_bf16 v[96:111], v[204:207], v[176:179], v[96:111]
    ds_read_b128 v[192:195], v2 offset:40960
    v_exp_f32 v175, v175
    v_add_f32 v225, v225, v173
    v_cvt_pk_bf16_f32 v190, v172, v173
    s_waitcnt lgkmcnt(5)
    v_mfma_f32_32x32x16_bf16 v[48:63], v[208:211], v[180:183], v[48:63]
    ds_read_b128 v[196:199], v3 offset:40960
    v_add_f32 v31, v31, v174
    v_add_f32 v225, v225, v175
    v_cvt_pk_bf16_f32 v191, v174, v175
    v_mfma_f32_32x32x16_bf16 v[64:79], v[212:215], v[180:183], v[64:79]
    ds_read_b128 v[200:203], v4 offset:40960
    v_max3_f32 v224, v144, v145, v146
    v_max3_f32 v226, v147, v148, v149
    v_max3_f32 v224, v224, v150, v151
    s_waitcnt lgkmcnt(3)
    v_mfma_f32_32x32x16_bf16 v[80:95], v[216:219], v[180:183], v[80:95]
    ds_read_b128 v[204:207], v5 offset:40960
    v_max3_f32 v226, v226, v152, v153
    v_max3_f32 v224, v224, v154, v155
    v_max3_f32 v226, v226, v156, v157
    v_mfma_f32_32x32x16_bf16 v[96:111], v[220:223], v[180:183], v[96:111]
    ds_read_b128 v[208:211], v6 offset:40960
    v_max3_f32 v224, v224, v158, v159
    v_max_f32 v224, v224, v226
    v_cmp_lt_f32 vcc, s32, v224
    s_cbranch_vccnz SLOW_1_8
BACK_1_8:
    s_waitcnt lgkmcnt(3)
    v_mfma_f32_32x32x16_bf16 v[160:175], v[192:195], v[112:115], v[32:47]
    ds_read_b128 v[212:215], v7 offset:40960
    v_exp_f32 v144, v144
    v_exp_f32 v145, v145
    v_exp_f32 v146, v146
    v_add_f32 v31, v31, v144
    v_mfma_f32_32x32x16_bf16 v[160:175], v[196:199], v[116:119], v[160:175]
    ds_read_b128 v[216:219], v8 offset:40960
    v_exp_f32 v147, v147
    v_add_f32 v225, v225, v145
    v_cvt_pk_bf16_f32 v176, v144, v145
    s_waitcnt lgkmcnt(3)
    v_mfma_f32_32x32x16_bf16 v[160:175], v[200:203], v[120:123], v[160:175]
    ds_read_b128 v[220:223], v9 offset:40960
    v_exp_f32 v148, v148
    v_add_f32 v31, v31, v146
    v_exp_f32 v149, v149
    v_mfma_f32_32x32x16_bf16 v[160:175], v[204:207], v[124:127], v[160:175]
    ds_read_b64_tr_b16 v[192:193], v18 offset:57344
    ds_read_b64_tr_b16 v[194:195], v18 offset:59392
    v_add_f32 v225, v225, v147
    v_cvt_pk_bf16_f32 v177, v146, v147
    v_exp_f32 v150, v150
    s_waitcnt lgkmcnt(4)
    v_mfma_f32_32x32x16_bf16 v[160:175], v[208:211], v[128:131], v[160:175]
    ds_read_b64_tr_b16 v[196:197], v19 offset:57344
    ds_read_b64_tr_b16 v[198:199], v19 offset:59392
    v_add_f32 v31, v31, v148
    v_exp_f32 v151, v151
    v_add_f32 v225, v225, v149
    v_mfma_f32_32x32x16_bf16 v[160:175], v[212:215], v[132:135], v[160:175]
    ds_read_b64_tr_b16 v[200:201], v20 offset:57344
    ds_read_b64_tr_b16 v[202:203], v20 offset:59392
    v_cvt_pk_bf16_f32 v178, v148, v149
    v_exp_f32 v152, v152
    v_add_f32 v31, v31, v150
    s_waitcnt lgkmcnt(6)
    v_mfma_f32_32x32x16_bf16 v[160:175], v[216:219], v[136:139], v[160:175]
    ds_read_b64_tr_b16 v[204:205], v21 offset:57344
    ds_read_b64_tr_b16 v[206:207], v21 offset:59392
    v_exp_f32 v153, v153
    v_add_f32 v225, v225, v151
    v_cvt_pk_bf16_f32 v179, v150, v151
    v_mfma_f32_32x32x16_bf16 v[160:175], v[220:223], v[140:143], v[160:175]
    ds_read_b64_tr_b16 v[208:209], v18 offset:61440
    ds_read_b64_tr_b16 v[210:211], v18 offset:63488
    v_exp_f32 v154, v154
    v_add_f32 v31, v31, v152
    v_exp_f32 v155, v155
    s_waitcnt lgkmcnt(6)
    v_mfma_f32_32x32x16_bf16 v[48:63], v[192:195], v[184:187], v[48:63]
    ds_read_b64_tr_b16 v[212:213], v19 offset:61440
    ds_read_b64_tr_b16 v[214:215], v19 offset:63488
    v_add_f32 v225, v225, v153
    v_cvt_pk_bf16_f32 v180, v152, v153
    v_exp_f32 v156, v156
    v_mfma_f32_32x32x16_bf16 v[64:79], v[196:199], v[184:187], v[64:79]
    ds_read_b64_tr_b16 v[216:217], v20 offset:61440
    ds_read_b64_tr_b16 v[218:219], v20 offset:63488
    v_add_f32 v31, v31, v154
    v_exp_f32 v157, v157
    v_add_f32 v225, v225, v155
    s_waitcnt lgkmcnt(6)
    v_mfma_f32_32x32x16_bf16 v[80:95], v[200:203], v[184:187], v[80:95]
    ds_read_b64_tr_b16 v[220:221], v21 offset:61440
    ds_read_b64_tr_b16 v[222:223], v21 offset:63488
    v_cvt_pk_bf16_f32 v181, v154, v155
    v_exp_f32 v158, v158
    v_add_f32 v31, v31, v156
    v_mfma_f32_32x32x16_bf16 v[96:111], v[204:207], v[184:187], v[96:111]
    ds_read_b128 v[192:195], v10 offset:32768
    v_exp_f32 v159, v159
    v_add_f32 v225, v225, v157
    v_cvt_pk_bf16_f32 v182, v156, v157
    s_waitcnt lgkmcnt(5)
    v_mfma_f32_32x32x16_bf16 v[48:63], v[208:211], v[188:191], v[48:63]
    ds_read_b128 v[196:199], v11 offset:32768
    v_add_f32 v31, v31, v158
    v_add_f32 v225, v225, v159
    v_cvt_pk_bf16_f32 v183, v158, v159
    v_mfma_f32_32x32x16_bf16 v[64:79], v[212:215], v[188:191], v[64:79]
    ds_read_b128 v[200:203], v12 offset:32768
    v_max3_f32 v224, v160, v161, v162
    v_max3_f32 v226, v163, v164, v165
    v_max3_f32 v224, v224, v166, v167
    s_waitcnt lgkmcnt(3)
    v_mfma_f32_32x32x16_bf16 v[80:95], v[216:219], v[188:191], v[80:95]
    ds_read_b128 v[204:207], v13 offset:32768
    v_max3_f32 v226, v226, v168, v169
    v_max3_f32 v224, v224, v170, v171
    v_max3_f32 v226, v226, v172, v173
    v_mfma_f32_32x32x16_bf16 v[96:111], v[220:223], v[188:191], v[96:111]
    ds_read_b128 v[208:211], v14 offset:32768
    v_max3_f32 v224, v224, v174, v175
    v_max_f32 v224, v224, v226
    v_cmp_lt_f32 vcc, s32, v224
    s_waitcnt vmcnt(0)
    s_mov_b32 s31, 20000
FA_L:
    v_xor_b32 v236, s89, v236
    v_xor_b32 v237, s89, v237
    v_xor_b32 v238, s89, v238
    v_xor_b32 v239, s89, v239
    v_or3_b32 v236, v236, v237, v238
    v_or_b32 v236, v236, v239
    s_nop 0
    v_readfirstlane_b32 s51, v236
    s_cmp_eq_u32 s51, 0
    s_cbranch_scc1 FA_X
    s_sub_u32 s31, s31, 1
    s_cmp_eq_u32 s31, 0
    s_cbranch_scc1 FA_X
    s_lshl_b32 s30, s28, 7
    buffer_load_dwordx4 v[236:239], v233, s[24:27], s30 offen sc1
    s_waitcnt vmcnt(0)
    s_branch FA_L
FA_X:
    s_barrier
    s_cbranch_vccnz SLOW_1_9
BACK_1_9:
    s_waitcnt lgkmcnt(3)
    v_mfma_f32_32x32x16_bf16 v[144:159], v[192:195], v[112:115], v[32:47]
    ds_read_b128 v[212:215], v15 offset:32768
    v_exp_f32 v160, v160
    v_exp_f32 v161, v161
    v_exp_f32 v162, v162
    v_add_f32 v31, v31, v160
    v_mfma_f32_32x32x16_bf16 v[144:159], v[196:199], v[116:119], v[144:159]
    ds_read_b128 v[216:219], v16 offset:32768
    v_exp_f32 v163, v163
    v_add_f32 v225, v225, v161
    v_cvt_pk_bf16_f32 v184, v160, v161
    s_waitcnt lgkmcnt(3)
    v_mfma_f32_32x32x16_bf16 v[144:159], v[200:203], v[120:123], v[144:159]
    ds_read_b128 v[220:223], v17 offset:32768
    v_exp_f32 v164, v164
    v_add_f32 v31, v31, v162
    v_exp_f32 v165, v165
    v_mfma_f32_32x32x16_bf16 v[144:159], v[204:207], v[124:127], v[144:159]
    ds_read_b64_tr_b16 v[192:193], v22 offset:0
    ds_read_b64_tr_b16 v[194:195], v22 offset:2048
    v_add_f32 v225, v225, v163
    v_cvt_pk_bf16_f32 v185, v162, v163
    v_exp_f32 v166, v166
    s_waitcnt lgkmcnt(4)
    v_mfma_f32_32x32x16_bf16 v[144:159], v[208:211], v[128:131], v[144:159]
    ds_read_b64_tr_b16 v[196:197], v23 offset:0
    ds_read_b64_tr_b16 v[198:199], v23 offset:2048
    v_add_f32 v31, v31, v164
    v_exp_f32 v167, v167
    v_add_f32 v225, v225, v165
    v_mfma_f32_32x32x16_bf16 v[144:159], v[212:215], v[132:135], v[144:159]
    ds_read_b64_tr_b16 v[200:201], v24 offset:0
    ds_read_b64_tr_b16 v[202:203], v24 offset:2048
    v_cvt_pk_bf16_f32 v186, v164, v165
    v_exp_f32 v168, v168
    v_add_f32 v31, v31, v166
    s_waitcnt lgkmcnt(6)
    v_mfma_f32_32x32x16_bf16 v[144:159], v[216:219], v[136:139], v[144:159]
    ds_read_b64_tr_b16 v[204:205], v25 offset:0
    ds_read_b64_tr_b16 v[206:207], v25 offset:2048
    v_exp_f32 v169, v169
    v_add_f32 v225, v225, v167
    v_cvt_pk_bf16_f32 v187, v166, v167
    v_mfma_f32_32x32x16_bf16 v[144:159], v[220:223], v[140:143], v[144:159]
    ds_read_b64_tr_b16 v[208:209], v22 offset:4096
    ds_read_b64_tr_b16 v[210:211], v22 offset:6144
    v_exp_f32 v170, v170
    v_add_f32 v31, v31, v168
    v_exp_f32 v171, v171
    s_waitcnt lgkmcnt(6)
    v_mfma_f32_32x32x16_bf16 v[48:63], v[192:195], v[176:179], v[48:63]
    ds_read_b64_tr_b16 v[212:213], v23 offset:4096
    ds_read_b64_tr_b16 v[214:215], v23 offset:6144
    v_add_f32 v225, v225, v169
    v_cvt_pk_bf16_f32 v188, v168, v169
    v_exp_f32 v172, v172
    v_mfma_f32_32x32x16_bf16 v[64:79], v[196:199], v[176:179], v[64:79]
    ds_read_b64_tr_b16 v[216:217], v24 offset:4096
    ds_read_b64_tr_b16 v[218:219], v24 offset:6144
    v_add_f32 v31, v31, v170
    v_exp_f32 v173, v173
    v_add_f32 v225, v225, v171
    s_waitcnt lgkmcnt(6)
    v_mfma_f32_32x32x16_bf16 v[80:95], v[200:203], v[176:179], v[80:95]
    ds_read_b64_tr_b16 v[220:221], v25 offset:4096
    ds_read_b64_tr_b16 v[222:223], v25 offset:6144
    v_cvt_pk_bf16_f32 v189, v170, v171
    v_exp_f32 v174, v174
    v_add_f32 v31, v31, v172
    v_mfma_f32_32x32x16_bf16 v[96:111], v[204:207], v[176:179], v[96:111]
    ds_read_b128 v[192:195], v10 offset:40960
    v_exp_f32 v175, v175
    v_add_f32 v225, v225, v173
    v_cvt_pk_bf16_f32 v190, v172, v173
    s_waitcnt lgkmcnt(5)
    v_mfma_f32_32x32x16_bf16 v[48:63], v[208:211], v[180:183], v[48:63]
    ds_read_b128 v[196:199], v11 offset:40960
    v_add_f32 v31, v31, v174
    v_add_f32 v225, v225, v175
    v_cvt_pk_bf16_f32 v191, v174, v175
    v_mfma_f32_32x32x16_bf16 v[64:79], v[212:215], v[180:183], v[64:79]
    ds_read_b128 v[200:203], v12 offset:40960
    v_max3_f32 v224, v144, v145, v146
    v_max3_f32 v226, v147, v148, v149
    v_max3_f32 v224, v224, v150, v151
    s_waitcnt lgkmcnt(3)
    v_mfma_f32_32x32x16_bf16 v[80:95], v[216:219], v[180:183], v[80:95]
    ds_read_b128 v[204:207], v13 offset:40960
    v_max3_f32 v226, v226, v152, v153
    v_max3_f32 v224, v224, v154, v155
    v_max3_f32 v226, v226, v156, v157
    v_mfma_f32_32x32x16_bf16 v[96:111], v[220:223], v[180:183], v[96:111]
    ds_read_b128 v[208:211], v14 offset:40960
    v_max3_f32 v224, v224, v158, v159
    v_max_f32 v224, v224, v226
    v_cmp_lt_f32 vcc, s32, v224
    s_cbranch_vccnz SLOW_1_10
BACK_1_10:
    s_waitcnt lgkmcnt(3)
    v_mfma_f32_32x32x16_bf16 v[160:175], v[192:195], v[112:115], v[32:47]
    ds_read_b128 v[212:215], v15 offset:40960
    v_exp_f32 v144, v144
    v_exp_f32 v145, v145
    v_exp_f32 v146, v146
    v_add_f32 v31, v31, v144
    v_mfma_f32_32x32x16_bf16 v[160:175], v[196:199], v[116:119], v[160:175]
    ds_read_b128 v[216:219], v16 offset:40960
    v_exp_f32 v147, v147
    v_add_f32 v225, v225, v145
    v_cvt_pk_bf16_f32 v176, v144, v145
    s_waitcnt lgkmcnt(3)
    v_mfma_f32_32x32x16_bf16 v[160:175], v[200:203], v[120:123], v[160:175]
    ds_read_b128 v[220:223], v17 offset:40960
    v_exp_f32 v148, v148
    v_add_f32 v31, v31, v146
    v_exp_f32 v149, v149
    v_mfma_f32_32x32x16_bf16 v[160:175], v[204:207], v[124:127], v[160:175]
    ds_read_b64_tr_b16 v[192:193], v22 offset:8192
    ds_read_b64_tr_b16 v[194:195], v22 offset:10240
    v_add_f32 v225, v225, v147
    v_cvt_pk_bf16_f32 v177, v146, v147
    v_exp_f32 v150, v150
    s_waitcnt lgkmcnt(4)
    v_mfma_f32_32x32x16_bf16 v[160:175], v[208:211], v[128:131], v[160:175]
    ds_read_b64_tr_b16 v[196:197], v23 offset:8192
    ds_read_b64_tr_b16 v[198:199], v23 offset:10240
    v_add_f32 v31, v31, v148
    v_exp_f32 v151, v151
    v_add_f32 v225, v225, v149
    v_mfma_f32_32x32x16_bf16 v[160:175], v[212:215], v[132:135], v[160:175]
    ds_read_b64_tr_b16 v[200:201], v24 offset:8192
    ds_read_b64_tr_b16 v[202:203], v24 offset:10240
    v_cvt_pk_bf16_f32 v178, v148, v149
    v_exp_f32 v152, v152
    v_add_f32 v31, v31, v150
    s_waitcnt lgkmcnt(6)
    v_mfma_f32_32x32x16_bf16 v[160:175], v[216:219], v[136:139], v[160:175]
    ds_read_b64_tr_b16 v[204:205], v25 offset:8192
    ds_read_b64_tr_b16 v[206:207], v25 offset:10240
    v_exp_f32 v153, v153
    v_add_f32 v225, v225, v151
    v_cvt_pk_bf16_f32 v179, v150, v151
    v_mfma_f32_32x32x16_bf16 v[160:175], v[220:223], v[140:143], v[160:175]
    ds_read_b64_tr_b16 v[208:209], v22 offset:12288
    ds_read_b64_tr_b16 v[210:211], v22 offset:14336
    v_exp_f32 v154, v154
    v_add_f32 v31, v31, v152
    v_exp_f32 v155, v155
    s_waitcnt lgkmcnt(6)
    v_mfma_f32_32x32x16_bf16 v[48:63], v[192:195], v[184:187], v[48:63]
    ds_read_b64_tr_b16 v[212:213], v23 offset:12288
    ds_read_b64_tr_b16 v[214:215], v23 offset:14336
    v_add_f32 v225, v225, v153
    v_cvt_pk_bf16_f32 v180, v152, v153
    v_exp_f32 v156, v156
    v_mfma_f32_32x32x16_bf16 v[64:79], v[196:199], v[184:187], v[64:79]
    ds_read_b64_tr_b16 v[216:217], v24 offset:12288
    ds_read_b64_tr_b16 v[218:219], v24 offset:14336
    v_add_f32 v31, v31, v154
    v_exp_f32 v157, v157
    v_add_f32 v225, v225, v155
    s_waitcnt lgkmcnt(6)
    v_mfma_f32_32x32x16_bf16 v[80:95], v[200:203], v[184:187], v[80:95]
    ds_read_b64_tr_b16 v[220:221], v25 offset:12288
    ds_read_b64_tr_b16 v[222:223], v25 offset:14336
    v_cvt_pk_bf16_f32 v181, v154, v155
    v_exp_f32 v158, v158
    v_add_f32 v31, v31, v156
    v_mfma_f32_32x32x16_bf16 v[96:111], v[204:207], v[184:187], v[96:111]
    ds_read_b128 v[192:195], v10 offset:16384
    v_exp_f32 v159, v159
    v_add_f32 v225, v225, v157
    v_cvt_pk_bf16_f32 v182, v156, v157
    s_waitcnt lgkmcnt(5)
    v_mfma_f32_32x32x16_bf16 v[48:63], v[208:211], v[188:191], v[48:63]
    ds_read_b128 v[196:199], v11 offset:16384
    v_add_f32 v31, v31, v158
    v_add_f32 v225, v225, v159
    v_cvt_pk_bf16_f32 v183, v158, v159
    v_mfma_f32_32x32x16_bf16 v[64:79], v[212:215], v[188:191], v[64:79]
    ds_read_b128 v[200:203], v12 offset:16384
    v_max3_f32 v224, v160, v161, v162
    v_max3_f32 v226, v163, v164, v165
    v_max3_f32 v224, v224, v166, v167
    s_waitcnt lgkmcnt(3)
    v_mfma_f32_32x32x16_bf16 v[80:95], v[216:219], v[188:191], v[80:95]
    ds_read_b128 v[204:207], v13 offset:16384
    v_max3_f32 v226, v226, v168, v169
    v_max3_f32 v224, v224, v170, v171
    v_max3_f32 v226, v226, v172, v173
    v_mfma_f32_32x32x16_bf16 v[96:111], v[220:223], v[188:191], v[96:111]
    ds_read_b128 v[208:211], v14 offset:16384
    v_max3_f32 v224, v224, v174, v175
    v_max_f32 v224, v224, v226
    v_cmp_lt_f32 vcc, s32, v224
    s_barrier
    s_cbranch_vccnz SLOW_1_11
BACK_1_11:
    s_waitcnt lgkmcnt(3)
    v_mfma_f32_32x32x16_bf16 v[144:159], v[192:195], v[112:115], v[32:47]
    ds_read_b128 v[212:215], v15 offset:16384
    v_exp_f32 v160, v160
    v_exp_f32 v161, v161
    v_exp_f32 v162, v162
    v_add_f32 v31, v31, v160
    v_mfma_f32_32x32x16_bf16 v[144:159], v[196:199], v[116:119], v[144:159]
    ds_read_b128 v[216:219], v16 offset:16384
    v_exp_f32 v163, v163
    v_add_f32 v225, v225, v161
    v_cvt_pk_bf16_f32 v184, v160, v161
    s_waitcnt lgkmcnt(3)
    v_mfma_f32_32x32x16_bf16 v[144:159], v[200:203], v[120:123], v[144:159]
    ds_read_b128 v[220:223], v17 offset:16384
    v_exp_f32 v164, v164
    v_add_f32 v31, v31, v162
    v_exp_f32 v165, v165
    v_mfma_f32_32x32x16_bf16 v[144:159], v[204:207], v[124:127], v[144:159]
    ds_read_b64_tr_b16 v[192:193], v18 offset:0
    ds_read_b64_tr_b16 v[194:195], v18 offset:2048
    v_add_f32 v225, v225, v163
    v_cvt_pk_bf16_f32 v185, v162, v163
    v_exp_f32 v166, v166
    s_waitcnt lgkmcnt(4)
    v_mfma_f32_32x32x16_bf16 v[144:159], v[208:211], v[128:131], v[144:159]
    ds_read_b64_tr_b16 v[196:197], v19 offset:0
    ds_read_b64_tr_b16 v[198:199], v19 offset:2048
    v_add_f32 v31, v31, v164
    v_exp_f32 v167, v167
    v_add_f32 v225, v225, v165
    v_mfma_f32_32x32x16_bf16 v[144:159], v[212:215], v[132:135], v[144:159]
    ds_read_b64_tr_b16 v[200:201], v20 offset:0
    ds_read_b64_tr_b16 v[202:203], v20 offset:2048
    v_cvt_pk_bf16_f32 v186, v164, v165
    v_exp_f32 v168, v168
    v_add_f32 v31, v31, v166
    s_waitcnt lgkmcnt(6)
    v_mfma_f32_32x32x16_bf16 v[144:159], v[216:219], v[136:139], v[144:159]
    ds_read_b64_tr_b16 v[204:205], v21 offset:0
    ds_read_b64_tr_b16 v[206:207], v21 offset:2048
    v_exp_f32 v169, v169
    v_add_f32 v225, v225, v167
    v_cvt_pk_bf16_f32 v187, v166, v167
    v_mfma_f32_32x32x16_bf16 v[144:159], v[220:223], v[140:143], v[144:159]
    ds_read_b64_tr_b16 v[208:209], v18 offset:4096
    ds_read_b64_tr_b16 v[210:211], v18 offset:6144
    v_exp_f32 v170, v170
    v_add_f32 v31, v31, v168
    v_exp_f32 v171, v171
    s_waitcnt lgkmcnt(6)
    v_mfma_f32_32x32x16_bf16 v[48:63], v[192:195], v[176:179], v[48:63]
    ds_read_b64_tr_b16 v[212:213], v19 offset:4096
    ds_read_b64_tr_b16 v[214:215], v19 offset:6144
    v_add_f32 v225, v225, v169
    v_cvt_pk_bf16_f32 v188, v168, v169
    v_exp_f32 v172, v172
    v_mfma_f32_32x32x16_bf16 v[64:79], v[196:199], v[176:179], v[64:79]
    ds_read_b64_tr_b16 v[216:217], v20 offset:4096
    ds_read_b64_tr_b16 v[218:219], v20 offset:6144
    v_add_f32 v31, v31, v170
    v_exp_f32 v173, v173
    v_add_f32 v225, v225, v171
    s_waitcnt lgkmcnt(6)
    v_mfma_f32_32x32x16_bf16 v[80:95], v[200:203], v[176:179], v[80:95]
    ds_read_b64_tr_b16 v[220:221], v21 offset:4096
    ds_read_b64_tr_b16 v[222:223], v21 offset:6144
    v_cvt_pk_bf16_f32 v189, v170, v171
    v_exp_f32 v174, v174
    v_add_f32 v31, v31, v172
    v_mfma_f32_32x32x16_bf16 v[96:111], v[204:207], v[176:179], v[96:111]
    ds_read_b128 v[192:195], v10 offset:24576
    v_exp_f32 v175, v175
    v_add_f32 v225, v225, v173
    v_cvt_pk_bf16_f32 v190, v172, v173
    s_waitcnt lgkmcnt(5)
    v_mfma_f32_32x32x16_bf16 v[48:63], v[208:211], v[180:183], v[48:63]
    ds_read_b128 v[196:199], v11 offset:24576
    v_add_f32 v31, v31, v174
    v_add_f32 v225, v225, v175
    v_cvt_pk_bf16_f32 v191, v174, v175
    v_mfma_f32_32x32x16_bf16 v[64:79], v[212:215], v[180:183], v[64:79]
    ds_read_b128 v[200:203], v12 offset:24576
    v_max3_f32 v224, v144, v145, v146
    v_max3_f32 v226, v147, v148, v149
    v_max3_f32 v224, v224, v150, v151
    s_waitcnt lgkmcnt(3)
    v_mfma_f32_32x32x16_bf16 v[80:95], v[216:219], v[180:183], v[80:95]
    ds_read_b128 v[204:207], v13 offset:24576
    v_max3_f32 v226, v226, v152, v153
    v_max3_f32 v224, v224, v154, v155
    v_max3_f32 v226, v226, v156, v157
    v_mfma_f32_32x32x16_bf16 v[96:111], v[220:223], v[180:183], v[96:111]
    ds_read_b128 v[208:211], v14 offset:24576
    v_max3_f32 v224, v224, v158, v159
    v_max_f32 v224, v224, v226
    v_cmp_lt_f32 vcc, s32, v224
    s_cbranch_vccnz SLOW_1_12
BACK_1_12:
    s_waitcnt lgkmcnt(3)
    v_mfma_f32_32x32x16_bf16 v[160:175], v[192:195], v[112:115], v[32:47]
    ds_read_b128 v[212:215], v15 offset:24576
    v_exp_f32 v144, v144
    v_exp_f32 v145, v145
    v_exp_f32 v146, v146
    v_add_f32 v31, v31, v144
    v_mfma_f32_32x32x16_bf16 v[160:175], v[196:199], v[116:119], v[160:175]
    ds_read_b128 v[216:219], v16 offset:24576
    v_exp_f32 v147, v147
    v_add_f32 v225, v225, v145
    v_cvt_pk_bf16_f32 v176, v144, v145
    s_waitcnt lgkmcnt(3)
    v_mfma_f32_32x32x16_bf16 v[160:175], v[200:203], v[120:123], v[160:175]
    ds_read_b128 v[220:223], v17 offset:24576
    v_exp_f32 v148, v148
    v_add_f32 v31, v31, v146
    v_exp_f32 v149, v149
    v_mfma_f32_32x32x16_bf16 v[160:175], v[204:207], v[124:127], v[160:175]
    ds_read_b64_tr_b16 v[192:193], v18 offset:8192
    ds_read_b64_tr_b16 v[194:195], v18 offset:10240
    v_add_f32 v225, v225, v147
    v_cvt_pk_bf16_f32 v177, v146, v147
    v_exp_f32 v150, v150
    s_waitcnt lgkmcnt(4)
    v_mfma_f32_32x32x16_bf16 v[160:175], v[208:211], v[128:131], v[160:175]
    ds_read_b64_tr_b16 v[196:197], v19 offset:8192
    ds_read_b64_tr_b16 v[198:199], v19 offset:10240
    v_add_f32 v31, v31, v148
    v_exp_f32 v151, v151
    v_add_f32 v225, v225, v149
    v_mfma_f32_32x32x16_bf16 v[160:175], v[212:215], v[132:135], v[160:175]
    ds_read_b64_tr_b16 v[200:201], v20 offset:8192
    ds_read_b64_tr_b16 v[202:203], v20 offset:10240
    v_cvt_pk_bf16_f32 v178, v148, v149
    v_exp_f32 v152, v152
    v_add_f32 v31, v31, v150
    s_waitcnt lgkmcnt(6)
    v_mfma_f32_32x32x16_bf16 v[160:175], v[216:219], v[136:139], v[160:175]
    ds_read_b64_tr_b16 v[204:205], v21 offset:8192
    ds_read_b64_tr_b16 v[206:207], v21 offset:10240
    v_exp_f32 v153, v153
    v_add_f32 v225, v225, v151
    v_cvt_pk_bf16_f32 v179, v150, v151
    v_mfma_f32_32x32x16_bf16 v[160:175], v[220:223], v[140:143], v[160:175]
    ds_read_b64_tr_b16 v[208:209], v18 offset:12288
    ds_read_b64_tr_b16 v[210:211], v18 offset:14336
    v_exp_f32 v154, v154
    v_add_f32 v31, v31, v152
    v_exp_f32 v155, v155
    s_waitcnt lgkmcnt(6)
    v_mfma_f32_32x32x16_bf16 v[48:63], v[192:195], v[184:187], v[48:63]
    ds_read_b64_tr_b16 v[212:213], v19 offset:12288
    ds_read_b64_tr_b16 v[214:215], v19 offset:14336
    v_add_f32 v225, v225, v153
    v_cvt_pk_bf16_f32 v180, v152, v153
    v_exp_f32 v156, v156
    v_mfma_f32_32x32x16_bf16 v[64:79], v[196:199], v[184:187], v[64:79]
    ds_read_b64_tr_b16 v[216:217], v20 offset:12288
    ds_read_b64_tr_b16 v[218:219], v20 offset:14336
    v_add_f32 v31, v31, v154
    v_exp_f32 v157, v157
    v_add_f32 v225, v225, v155
    s_waitcnt lgkmcnt(6)
    v_mfma_f32_32x32x16_bf16 v[80:95], v[200:203], v[184:187], v[80:95]
    ds_read_b64_tr_b16 v[220:221], v21 offset:12288
    ds_read_b64_tr_b16 v[222:223], v21 offset:14336
    v_cvt_pk_bf16_f32 v181, v154, v155
    v_exp_f32 v158, v158
    v_add_f32 v31, v31, v156
    v_mfma_f32_32x32x16_bf16 v[96:111], v[204:207], v[184:187], v[96:111]
    ds_read_b128 v[192:195], v2 offset:16384
    v_exp_f32 v159, v159
    v_add_f32 v225, v225, v157
    v_cvt_pk_bf16_f32 v182, v156, v157
    s_waitcnt lgkmcnt(5)
    v_mfma_f32_32x32x16_bf16 v[48:63], v[208:211], v[188:191], v[48:63]
    ds_read_b128 v[196:199], v3 offset:16384
    v_add_f32 v31, v31, v158
    v_add_f32 v225, v225, v159
    v_cvt_pk_bf16_f32 v183, v158, v159
    v_mfma_f32_32x32x16_bf16 v[64:79], v[212:215], v[188:191], v[64:79]
    ds_read_b128 v[200:203], v4 offset:16384
    v_max3_f32 v224, v160, v161, v162
    v_max3_f32 v226, v163, v164, v165
    v_max3_f32 v224, v224, v166, v167
    s_waitcnt lgkmcnt(3)
    v_mfma_f32_32x32x16_bf16 v[80:95], v[216:219], v[188:191], v[80:95]
    ds_read_b128 v[204:207], v5 offset:16384
    v_max3_f32 v226, v226, v168, v169
    v_max3_f32 v224, v224, v170, v171
    v_max3_f32 v226, v226, v172, v173
    v_mfma_f32_32x32x16_bf16 v[96:111], v[220:223], v[188:191], v[96:111]
    ds_read_b128 v[208:211], v6 offset:16384
    v_max3_f32 v224, v224, v174, v175
    v_max_f32 v224, v224, v226
    v_cmp_lt_f32 vcc, s32, v224
    s_barrier
    s_cbranch_vccnz SLOW_1_13
BACK_1_13:
    s_waitcnt lgkmcnt(3)
    v_mfma_f32_32x32x16_bf16 v[144:159], v[192:195], v[112:115], v[32:47]
    ds_read_b128 v[212:215], v7 offset:16384
    v_exp_f32 v160, v160
    v_exp_f32 v161, v161
    v_exp_f32 v162, v162
    v_add_f32 v31, v31, v160
    v_mfma_f32_32x32x16_bf16 v[144:159], v[196:199], v[116:119], v[144:159]
    ds_read_b128 v[216:219], v8 offset:16384
    v_exp_f32 v163, v163
    v_add_f32 v225, v225, v161
    v_cvt_pk_bf16_f32 v184, v160, v161
    s_waitcnt lgkmcnt(3)
    v_mfma_f32_32x32x16_bf16 v[144:159], v[200:203], v[120:123], v[144:159]
    ds_read_b128 v[220:223], v9 offset:16384
    v_exp_f32 v164, v164
    v_add_f32 v31, v31, v162
    v_exp_f32 v165, v165
    v_mfma_f32_32x32x16_bf16 v[144:159], v[204:207], v[124:127], v[144:159]
    ds_read_b64_tr_b16 v[192:193], v18 offset:32768
    ds_read_b64_tr_b16 v[194:195], v18 offset:34816
    v_add_f32 v225, v225, v163
    v_cvt_pk_bf16_f32 v185, v162, v163
    v_exp_f32 v166, v166
    s_waitcnt lgkmcnt(4)
    v_mfma_f32_32x32x16_bf16 v[144:159], v[208:211], v[128:131], v[144:159]
    ds_read_b64_tr_b16 v[196:197], v19 offset:32768
    ds_read_b64_tr_b16 v[198:199], v19 offset:34816
    v_add_f32 v31, v31, v164
    v_exp_f32 v167, v167
    v_add_f32 v225, v225, v165
    v_mfma_f32_32x32x16_bf16 v[144:159], v[212:215], v[132:135], v[144:159]
    ds_read_b64_tr_b16 v[200:201], v20 offset:32768
    ds_read_b64_tr_b16 v[202:203], v20 offset:34816
    v_cvt_pk_bf16_f32 v186, v164, v165
    v_exp_f32 v168, v168
    v_add_f32 v31, v31, v166
    s_waitcnt lgkmcnt(6)
    v_mfma_f32_32x32x16_bf16 v[144:159], v[216:219], v[136:139], v[144:159]
    ds_read_b64_tr_b16 v[204:205], v21 offset:32768
    ds_read_b64_tr_b16 v[206:207], v21 offset:34816
    v_exp_f32 v169, v169
    v_add_f32 v225, v225, v167
    v_cvt_pk_bf16_f32 v187, v166, v167
    v_mfma_f32_32x32x16_bf16 v[144:159], v[220:223], v[140:143], v[144:159]
    ds_read_b64_tr_b16 v[208:209], v18 offset:36864
    ds_read_b64_tr_b16 v[210:211], v18 offset:38912
    v_exp_f32 v170, v170
    v_add_f32 v31, v31, v168
    v_exp_f32 v171, v171
    s_waitcnt lgkmcnt(6)
    v_mfma_f32_32x32x16_bf16 v[48:63], v[192:195], v[176:179], v[48:63]
    ds_read_b64_tr_b16 v[212:213], v19 offset:36864
    ds_read_b64_tr_b16 v[214:215], v19 offset:38912
    v_add_f32 v225, v225, v169
    v_cvt_pk_bf16_f32 v188, v168, v169
    v_exp_f32 v172, v172
    v_mfma_f32_32x32x16_bf16 v[64:79], v[196:199], v[176:179], v[64:79]
    ds_read_b64_tr_b16 v[216:217], v20 offset:36864
    ds_read_b64_tr_b16 v[218:219], v20 offset:38912
    v_add_f32 v31, v31, v170
    v_exp_f32 v173, v173
    v_add_f32 v225, v225, v171
    s_waitcnt lgkmcnt(6)
    v_mfma_f32_32x32x16_bf16 v[80:95], v[200:203], v[176:179], v[80:95]
    ds_read_b64_tr_b16 v[220:221], v21 offset:36864
    ds_read_b64_tr_b16 v[222:223], v21 offset:38912
    v_cvt_pk_bf16_f32 v189, v170, v171
    v_exp_f32 v174, v174
    v_add_f32 v31, v31, v172
    v_mfma_f32_32x32x16_bf16 v[96:111], v[204:207], v[176:179], v[96:111]
    ds_read_b128 v[192:195], v2 offset:24576
    v_exp_f32 v175, v175
    v_add_f32 v225, v225, v173
    v_cvt_pk_bf16_f32 v190, v172, v173
    s_waitcnt lgkmcnt(5)
    v_mfma_f32_32x32x16_bf16 v[48:63], v[208:211], v[180:183], v[48:63]
    ds_read_b128 v[196:199], v3 offset:24576
    v_add_f32 v31, v31, v174
    v_add_f32 v225, v225, v175
    v_cvt_pk_bf16_f32 v191, v174, v175
    v_mfma_f32_32x32x16_bf16 v[64:79], v[212:215], v[180:183], v[64:79]
    ds_read_b128 v[200:203], v4 offset:24576
    v_max3_f32 v224, v144, v145, v146
    v_max3_f32 v226, v147, v148, v149
    v_max3_f32 v224, v224, v150, v151
    s_waitcnt lgkmcnt(3)
    v_mfma_f32_32x32x16_bf16 v[80:95], v[216:219], v[180:183], v[80:95]
    ds_read_b128 v[204:207], v5 offset:24576
    v_max3_f32 v226, v226, v152, v153
    v_max3_f32 v224, v224, v154, v155
    v_max3_f32 v226, v226, v156, v157
    v_mfma_f32_32x32x16_bf16 v[96:111], v[220:223], v[180:183], v[96:111]
    ds_read_b128 v[208:211], v6 offset:24576
    v_max3_f32 v224, v224, v158, v159
    v_max_f32 v224, v224, v226
    v_cmp_lt_f32 vcc, s32, v224
    s_cbranch_vccnz SLOW_1_14
BACK_1_14:
    s_waitcnt lgkmcnt(3)
    v_mfma_f32_32x32x16_bf16 v[160:175], v[192:195], v[112:115], v[32:47]
    ds_read_b128 v[212:215], v7 offset:24576
    v_exp_f32 v144, v144
    v_exp_f32 v145, v145
    v_exp_f32 v146, v146
    v_add_f32 v31, v31, v144
    v_mfma_f32_32x32x16_bf16 v[160:175], v[196:199], v[116:119], v[160:175]
    ds_read_b128 v[216:219], v8 offset:24576
    v_exp_f32 v147, v147
    v_add_f32 v225, v225, v145
    v_cvt_pk_bf16_f32 v176, v144, v145
    s_waitcnt lgkmcnt(3)
    v_mfma_f32_32x32x16_bf16 v[160:175], v[200:203], v[120:123], v[160:175]
    ds_read_b128 v[220:223], v9 offset:24576
    v_exp_f32 v148, v148
    v_add_f32 v31, v31, v146
    v_exp_f32 v149, v149
    v_mfma_f32_32x32x16_bf16 v[160:175], v[204:207], v[124:127], v[160:175]
    ds_read_b64_tr_b16 v[192:193], v18 offset:40960
    ds_read_b64_tr_b16 v[194:195], v18 offset:43008
    v_add_f32 v225, v225, v147
    v_cvt_pk_bf16_f32 v177, v146, v147
    v_exp_f32 v150, v150
    s_waitcnt lgkmcnt(4)
    v_mfma_f32_32x32x16_bf16 v[160:175], v[208:211], v[128:131], v[160:175]
    ds_read_b64_tr_b16 v[196:197], v19 offset:40960
    ds_read_b64_tr_b16 v[198:199], v19 offset:43008
    v_add_f32 v31, v31, v148
    v_exp_f32 v151, v151
    v_add_f32 v225, v225, v149
    v_mfma_f32_32x32x16_bf16 v[160:175], v[212:215], v[132:135], v[160:175]
    ds_read_b64_tr_b16 v[200:201], v20 offset:40960
    ds_read_b64_tr_b16 v[202:203], v20 offset:43008
    v_cvt_pk_bf16_f32 v178, v148, v149
    v_exp_f32 v152, v152
    v_add_f32 v31, v31, v150
    s_waitcnt lgkmcnt(6)
    v_mfma_f32_32x32x16_bf16 v[160:175], v[216:219], v[136:139], v[160:175]
    ds_read_b64_tr_b16 v[204:205], v21 offset:40960
    ds_read_b64_tr_b16 v[206:207], v21 offset:43008
    v_exp_f32 v153, v153
    v_add_f32 v225, v225, v151
    v_cvt_pk_bf16_f32 v179, v150, v151
    v_mfma_f32_32x32x16_bf16 v[160:175], v[220:223], v[140:143], v[160:175]
    ds_read_b64_tr_b16 v[208:209], v18 offset:45056
    ds_read_b64_tr_b16 v[210:211], v18 offset:47104
    v_exp_f32 v154, v154
    v_add_f32 v31, v31, v152
    v_exp_f32 v155, v155
    s_waitcnt lgkmcnt(6)
    v_mfma_f32_32x32x16_bf16 v[48:63], v[192:195], v[184:187], v[48:63]
    ds_read_b64_tr_b16 v[212:213], v19 offset:45056
    ds_read_b64_tr_b16 v[214:215], v19 offset:47104
    v_add_f32 v225, v225, v153
    v_cvt_pk_bf16_f32 v180, v152, v153
    v_exp_f32 v156, v156
    v_mfma_f32_32x32x16_bf16 v[64:79], v[196:199], v[184:187], v[64:79]
    ds_read_b64_tr_b16 v[216:217], v20 offset:45056
    ds_read_b64_tr_b16 v[218:219], v20 offset:47104
    v_add_f32 v31, v31, v154
    v_exp_f32 v157, v157
    v_add_f32 v225, v225, v155
    s_waitcnt lgkmcnt(6)
    v_mfma_f32_32x32x16_bf16 v[80:95], v[200:203], v[184:187], v[80:95]
    ds_read_b64_tr_b16 v[220:221], v21 offset:45056
    ds_read_b64_tr_b16 v[222:223], v21 offset:47104
    v_cvt_pk_bf16_f32 v181, v154, v155
    v_exp_f32 v158, v158
    v_add_f32 v31, v31, v156
    v_mfma_f32_32x32x16_bf16 v[96:111], v[204:207], v[184:187], v[96:111]
    ds_read_b64_tr_b16 v[192:193], v18 offset:49152
    ds_read_b64_tr_b16 v[194:195], v18 offset:51200
    v_exp_f32 v159, v159
    v_add_f32 v225, v225, v157
    v_cvt_pk_bf16_f32 v182, v156, v157
    s_waitcnt lgkmcnt(6)
    v_mfma_f32_32x32x16_bf16 v[48:63], v[208:211], v[188:191], v[48:63]
    ds_read_b64_tr_b16 v[196:197], v19 offset:49152
    ds_read_b64_tr_b16 v[198:199], v19 offset:51200
    v_add_f32 v31, v31, v158
    v_add_f32 v225, v225, v159
    v_cvt_pk_bf16_f32 v183, v158, v159
    v_mfma_f32_32x32x16_bf16 v[64:79], v[212:215], v[188:191], v[64:79]
    ds_read_b64_tr_b16 v[200:201], v20 offset:49152
    ds_read_b64_tr_b16 v[202:203], v20 offset:51200
    v_max3_f32 v224, v160, v161, v162
    v_max3_f32 v226, v163, v164, v165
    v_max3_f32 v224, v224, v166, v167
    s_waitcnt lgkmcnt(6)
    v_mfma_f32_32x32x16_bf16 v[80:95], v[216:219], v[188:191], v[80:95]
    ds_read_b64_tr_b16 v[204:205], v21 offset:49152
    ds_read_b64_tr_b16 v[206:207], v21 offset:51200
    v_max3_f32 v226, v226, v168, v169
    v_max3_f32 v224, v224, v170, v171
    v_max3_f32 v226, v226, v172, v173
    v_mfma_f32_32x32x16_bf16 v[96:111], v[220:223], v[188:191], v[96:111]
    ds_read_b64_tr_b16 v[208:209], v18 offset:53248
    ds_read_b64_tr_b16 v[210:211], v18 offset:55296
    v_max3_f32 v224, v224, v174, v175
    v_max_f32 v224, v224, v226
    v_cmp_lt_f32 vcc, s32, v224
    s_barrier
    s_cbranch_vccnz SLOW_1_15
BACK_1_15:
    s_waitcnt lgkmcnt(6)
    v_mfma_f32_32x32x16_bf16 v[48:63], v[192:195], v[176:179], v[48:63]
    ds_read_b64_tr_b16 v[212:213], v19 offset:53248
    ds_read_b64_tr_b16 v[214:215], v19 offset:55296
    v_exp_f32 v160, v160
    v_exp_f32 v161, v161
    v_exp_f32 v162, v162
    v_add_f32 v31, v31, v160
    v_mfma_f32_32x32x16_bf16 v[64:79], v[196:199], v[176:179], v[64:79]
    ds_read_b64_tr_b16 v[216:217], v20 offset:53248
    ds_read_b64_tr_b16 v[218:219], v20 offset:55296
    v_exp_f32 v163, v163
    v_add_f32 v225, v225, v161
    v_cvt_pk_bf16_f32 v184, v160, v161
    v_exp_f32 v164, v164
    s_waitcnt lgkmcnt(6)
    v_mfma_f32_32x32x16_bf16 v[80:95], v[200:203], v[176:179], v[80:95]
    ds_read_b64_tr_b16 v[220:221], v21 offset:53248
    ds_read_b64_tr_b16 v[222:223], v21 offset:55296
    v_add_f32 v31, v31, v162
    v_exp_f32 v165, v165
    v_add_f32 v225, v225, v163
    v_mfma_f32_32x32x16_bf16 v[96:111], v[204:207], v[176:179], v[96:111]
    ds_read_b64_tr_b16 v[192:193], v18 offset:57344
    ds_read_b64_tr_b16 v[194:195], v18 offset:59392
    v_cvt_pk_bf16_f32 v185, v162, v163
    v_exp_f32 v166, v166
    v_add_f32 v31, v31, v164
    v_exp_f32 v167, v167
    s_waitcnt lgkmcnt(6)
    v_mfma_f32_32x32x16_bf16 v[48:63], v[208:211], v[180:183], v[48:63]
    ds_read_b64_tr_b16 v[196:197], v19 offset:57344
    ds_read_b64_tr_b16 v[198:199], v19 offset:59392
    v_add_f32 v225, v225, v165
    v_cvt_pk_bf16_f32 v186, v164, v165
    v_exp_f32 v168, v168
    v_add_f32 v31, v31, v166
    v_mfma_f32_32x32x16_bf16 v[64:79], v[212:215], v[180:183], v[64:79]
    ds_read_b64_tr_b16 v[200:201], v20 offset:57344
    ds_read_b64_tr_b16 v[202:203], v20 offset:59392
    v_exp_f32 v169, v169
    v_add_f32 v225, v225, v167
    v_cvt_pk_bf16_f32 v187, v166, v167
    s_waitcnt lgkmcnt(6)
    v_mfma_f32_32x32x16_bf16 v[80:95], v[216:219], v[180:183], v[80:95]
    ds_read_b64_tr_b16 v[204:205], v21 offset:57344
    ds_read_b64_tr_b16 v[206:207], v21 offset:59392
    v_exp_f32 v170, v170
    v_add_f32 v31, v31, v168
    v_exp_f32 v171, v171
    v_add_f32 v225, v225, v169
    v_mfma_f32_32x32x16_bf16 v[96:111], v[220:223], v[180:183], v[96:111]
    ds_read_b64_tr_b16 v[208:209], v18 offset:61440
    ds_read_b64_tr_b16 v[210:211], v18 offset:63488
    v_cvt_pk_bf16_f32 v188, v168, v169
    v_exp_f32 v172, v172
    v_add_f32 v31, v31, v170
    v_exp_f32 v173, v173
    s_waitcnt lgkmcnt(6)
    v_mfma_f32_32x32x16_bf16 v[48:63], v[192:195], v[184:187], v[48:63]
    ds_read_b64_tr_b16 v[212:213], v19 offset:61440
    ds_read_b64_tr_b16 v[214:215], v19 offset:63488
    v_add_f32 v225, v225, v171
    v_cvt_pk_bf16_f32 v189, v170, v171
    v_exp_f32 v174, v174
    v_mfma_f32_32x32x16_bf16 v[64:79], v[196:199], v[184:187], v[64:79]
    ds_read_b64_tr_b16 v[216:217], v20 offset:61440
    ds_read_b64_tr_b16 v[218:219], v20 offset:63488
    v_add_f32 v31, v31, v172
    v_exp_f32 v175, v175
    v_add_f32 v225, v225, v173
    v_cvt_pk_bf16_f32 v190, v172, v173
    s_waitcnt lgkmcnt(6)
    v_mfma_f32_32x32x16_bf16 v[80:95], v[200:203], v[184:187], v[80:95]
    ds_read_b64_tr_b16 v[220:221], v21 offset:61440
    ds_read_b64_tr_b16 v[222:223], v21 offset:63488
    v_add_f32 v31, v31, v174
    v_add_f32 v225, v225, v175
    v_cvt_pk_bf16_f32 v191, v174, v175
    v_mfma_f32_32x32x16_bf16 v[96:111], v[204:207], v[184:187], v[96:111]
    s_waitcnt lgkmcnt(4)
    v_mfma_f32_32x32x16_bf16 v[48:63], v[208:211], v[188:191], v[48:63]
    v_mfma_f32_32x32x16_bf16 v[64:79], v[212:215], v[188:191], v[64:79]
    s_waitcnt lgkmcnt(0)
    v_mfma_f32_32x32x16_bf16 v[80:95], v[216:219], v[188:191], v[80:95]
    v_mfma_f32_32x32x16_bf16 v[96:111], v[220:223], v[188:191], v[96:111]
    v_add_f32 v226, v31, v225
    v_mov_b32 v227, v226
    s_nop 1
    v_permlane32_swap_b32 v226, v227
    v_add_f32 v226, v226, v227
    v_rcp_f32 v226, v226
    v_lshlrev_b32 v227, 4, v0
    s_lshl_b32 s30, s28, 13
    v_add_u32 v227, s30, v227
    v_add_u32 v228, 4096, v227
    s_mov_b32 s31, 0
    v_mul_f32 v48, v48, v226
    v_mul_f32 v49, v49, v226
    v_mul_f32 v50, v50, v226
    v_mul_f32 v51, v51, v226
    v_mul_f32 v52, v52, v226
    v_mul_f32 v53, v53, v226
    v_mul_f32 v54, v54, v226
    v_mul_f32 v55, v55, v226
    v_mul_f32 v56, v56, v226
    v_mul_f32 v57, v57, v226
    v_mul_f32 v58, v58, v226
    v_mul_f32 v59, v59, v226
    v_mul_f32 v60, v60, v226
    v_mul_f32 v61, v61, v226
    v_mul_f32 v62, v62, v226
    v_mul_f32 v63, v63, v226
    v_cvt_pk_bf16_f32 v176, v48, v49
    v_cvt_pk_bf16_f32 v177, v50, v51
    v_cvt_pk_bf16_f32 v178, v52, v53
    v_cvt_pk_bf16_f32 v179, v54, v55
    buffer_store_dwordx4 v[176:179], v227, s[20:23], s31 offen offset:0 sc1
    ds_write_b128 v231, v[176:179] offset:16384
    v_cvt_pk_bf16_f32 v180, v56, v57
    v_cvt_pk_bf16_f32 v181, v58, v59
    v_cvt_pk_bf16_f32 v182, v60, v61
    v_cvt_pk_bf16_f32 v183, v62, v63
    buffer_store_dwordx4 v[180:183], v227, s[20:23], s31 offen offset:1024 sc1
    ds_write_b128 v231, v[180:183] offset:17408
    v_mul_f32 v64, v64, v226
    v_mul_f32 v65, v65, v226
    v_mul_f32 v66, v66, v226
    v_mul_f32 v67, v67, v226
    v_mul_f32 v68, v68, v226
    v_mul_f32 v69, v69, v226
    v_mul_f32 v70, v70, v226
    v_mul_f32 v71, v71, v226
    v_mul_f32 v72, v72, v226
    v_mul_f32 v73, v73, v226
    v_mul_f32 v74, v74, v226
    v_mul_f32 v75, v75, v226
    v_mul_f32 v76, v76, v226
    v_mul_f32 v77, v77, v226
    v_mul_f32 v78, v78, v226
    v_mul_f32 v79, v79, v226
    v_cvt_pk_bf16_f32 v184, v64, v65
    v_cvt_pk_bf16_f32 v185, v66, v67
    v_cvt_pk_bf16_f32 v186, v68, v69
    v_cvt_pk_bf16_f32 v187, v70, v71
    buffer_store_dwordx4 v[184:187], v227, s[20:23], s31 offen offset:2048 sc1
    ds_write_b128 v231, v[184:187] offset:18432
    v_cvt_pk_bf16_f32 v188, v72, v73
    v_cvt_pk_bf16_f32 v189, v74, v75
    v_cvt_pk_bf16_f32 v190, v76, v77
    v_cvt_pk_bf16_f32 v191, v78, v79
    buffer_store_dwordx4 v[188:191], v227, s[20:23], s31 offen offset:3072 sc1
    ds_write_b128 v231, v[188:191] offset:19456
    v_mul_f32 v80, v80, v226
    v_mul_f32 v81, v81, v226
    v_mul_f32 v82, v82, v226
    v_mul_f32 v83, v83, v226
    v_mul_f32 v84, v84, v226
    v_mul_f32 v85, v85, v226
    v_mul_f32 v86, v86, v226
    v_mul_f32 v87, v87, v226
    v_mul_f32 v88, v88, v226
    v_mul_f32 v89, v89, v226
    v_mul_f32 v90, v90, v226
    v_mul_f32 v91, v91, v226
    v_mul_f32 v92, v92, v226
    v_mul_f32 v93, v93, v226
    v_mul_f32 v94, v94, v226
    v_mul_f32 v95, v95, v226
    v_cvt_pk_bf16_f32 v240, v80, v81
    v_cvt_pk_bf16_f32 v241, v82, v83
    v_cvt_pk_bf16_f32 v242, v84, v85
    v_cvt_pk_bf16_f32 v243, v86, v87
    buffer_store_dwordx4 v[240:243], v228, s[20:23], s31 offen offset:0 sc1
    ds_write_b128 v231, v[240:243] offset:32768
    v_cvt_pk_bf16_f32 v244, v88, v89
    v_cvt_pk_bf16_f32 v245, v90, v91
    v_cvt_pk_bf16_f32 v246, v92, v93
    v_cvt_pk_bf16_f32 v247, v94, v95
    buffer_store_dwordx4 v[244:247], v228, s[20:23], s31 offen offset:1024 sc1
    ds_write_b128 v231, v[244:247] offset:33792
    v_mul_f32 v96, v96, v226
    v_mul_f32 v97, v97, v226
    v_mul_f32 v98, v98, v226
    v_mul_f32 v99, v99, v226
    v_mul_f32 v100, v100, v226
    v_mul_f32 v101, v101, v226
    v_mul_f32 v102, v102, v226
    v_mul_f32 v103, v103, v226
    v_mul_f32 v104, v104, v226
    v_mul_f32 v105, v105, v226
    v_mul_f32 v106, v106, v226
    v_mul_f32 v107, v107, v226
    v_mul_f32 v108, v108, v226
    v_mul_f32 v109, v109, v226
    v_mul_f32 v110, v110, v226
    v_mul_f32 v111, v111, v226
    v_cvt_pk_bf16_f32 v248, v96, v97
    v_cvt_pk_bf16_f32 v249, v98, v99
    v_cvt_pk_bf16_f32 v250, v100, v101
    v_cvt_pk_bf16_f32 v251, v102, v103
    buffer_store_dwordx4 v[248:251], v228, s[20:23], s31 offen offset:2048 sc1
    ds_write_b128 v231, v[248:251] offset:34816
    v_cvt_pk_bf16_f32 v252, v104, v105
    v_cvt_pk_bf16_f32 v253, v106, v107
    v_cvt_pk_bf16_f32 v254, v108, v109
    v_cvt_pk_bf16_f32 v255, v110, v111
    buffer_store_dwordx4 v[252:255], v228, s[20:23], s31 offen offset:3072 sc1
    ds_write_b128 v231, v[252:255] offset:35840
    s_waitcnt lgkmcnt(0)
    s_barrier
    s_waitcnt vmcnt(0)
    s_lshl_b32 s31, s28, 5
    s_add_u32 s30, s35, s31
    s_lshl_b32 s30, s30, 2
    v_mov_b32 v226, 512
    v_mov_b32 v227, s89
    s_mov_b64 exec, 1
    buffer_store_dword v227, v226, s[24:27], s30 offen sc1
    s_mov_b64 exec, -1
    s_barrier
    s_endpgm
G2_START:
    s_setprio 1
    v_lshrrev_b32 v23, 4, v0
    v_and_b32 v24, 15, v0
    v_lshlrev_b32 v25, 2, v23
    v_xor_b32 v25, v24, v25
    v_lshlrev_b32 v25, 4, v25
    v_lshl_add_u32 v26, v23, 13, v25
    s_lshl_b32 s30, s28, 17
    v_add_u32 v2, s30, v26
    s_lshl_b32 s30, s35, 8
    s_add_u32 s30, s30, 0
    v_add_u32 v25, s30, v25
    v_and_b32 v25, 1023, v25
    v_lshl_add_u32 v26, v23, 10, v25
    s_lshl_b32 s30, s28, 14
    v_add_u32 v3, s30, v26
    v_and_b32 v23, 31, v0
    v_lshrrev_b32 v24, 5, v0
    v_lshrrev_b32 v25, 1, v23
    v_and_b32 v25, 7, v25
    v_xor_b32 v25, v25, v24
    v_lshlrev_b32 v25, 4, v25
    v_lshl_add_u32 v25, v23, 7, v25
    v_add_u32 v25, s29, v25
    v_add_u32 v12, 32768, v25
    v_add_u32 v28, 98304, v25
    v_xor_b32 v13, 32, v12
    v_xor_b32 v29, 32, v28
    v_xor_b32 v14, 64, v12
    v_xor_b32 v30, 64, v28
    v_xor_b32 v15, 96, v12
    v_xor_b32 v31, 96, v28
    v_lshrrev_b32 v23, 2, v0
    v_and_b32 v23, 3, v23
    v_lshrrev_b32 v25, 4, v0
    v_and_b32 v25, 1, v25
    v_lshlrev_b32 v25, 5, v25
    v_lshl_add_u32 v25, v23, 8, v25
    v_lshl_add_u32 v25, v23, 6, v25
    v_and_b32 v26, 1, v0
    v_lshl_add_u32 v4, v26, 4, v25
    v_lshrrev_b32 v26, 1, v0
    v_and_b32 v26, 1, v26
    v_lshl_add_u32 v4, v26, 3, v4
    v_lshl_add_u32 v4, v24, 11, v4
    v_add_u32 v8, 32768, v4
    v_add_u32 v4, 98304, v4
    v_xor_b32 v5, 64, v4
    v_xor_b32 v9, 64, v8
    v_xor_b32 v6, 128, v4
    v_xor_b32 v10, 128, v8
    v_xor_b32 v7, 192, v4
    v_xor_b32 v11, 192, v8
    v_and_b32 v26, 3, v0
    v_lshl_add_u32 v26, v26, 3, v25
    v_lshl_add_u32 v26, v24, 10, v26
    v_add_u32 v26, 98304, v26
    s_add_u32 s30, s46, 0
    s_and_b32 s30, s30, 3
    s_lshl_b32 s30, s30, 6
    v_xor_b32 v16, s30, v26
    s_add_u32 s30, s46, 1
    s_and_b32 s30, s30, 3
    s_lshl_b32 s30, s30, 6
    v_xor_b32 v17, s30, v26
    s_add_u32 s30, s46, 2
    s_and_b32 s30, s30, 3
    s_lshl_b32 s30, s30, 6
    v_xor_b32 v18, s30, v26
    s_add_u32 s30, s46, 3
    s_and_b32 s30, s30, 3
    s_lshl_b32 s30, s30, 6
    v_xor_b32 v19, s30, v26
    v_lshlrev_b32 v22, 4, v0
    s_lshl_b32 s30, s28, 13
    v_add_u32 v21, s30, v22
    s_lshl_b32 s30, s28, 12
    v_add_u32 v20, s30, v22
    v_add_u32 v22, s29, v22
    v_add_u32 v22, 114688, v22
    s_mov_b32 s33, 0x3e0293ee
    s_waitcnt lgkmcnt(0)
    s_cmp_eq_u32 s47, 0
    s_cselect_b32 s36, s36, s64
    s_cselect_b32 s37, s37, s65
    s_cselect_b32 s38, s38, s66
    s_cselect_b32 s39, s39, s67
    s_cselect_b32 s40, s40, s68
    s_cselect_b32 s41, s41, s69
    s_cselect_b32 s42, s42, s70
    s_cselect_b32 s43, s43, s71
    s_cselect_b32 s44, s44, s72
    s_cselect_b32 s45, s45, s73
    s_mov_b32 s56, s52
    s_mov_b32 s57, s53
    s_mov_b32 s52, s54
    s_mov_b32 s53, s55
    s_mov_b32 s54, s56
    s_mov_b32 s55, s57
    s_lshl_b32 s58, s34, 5
    s_add_u32 s58, s58, s48
    s_lshl_b32 s51, s58, 17
    s_add_u32 s4, s38, s51
    s_addc_u32 s5, s39, 0
    s_mov_b32 s6, 655360
    s_mov_b32 s7, 0x00020000
    s_add_u32 s8, s40, s51
    s_addc_u32 s9, s41, 0
    s_mov_b32 s10, 655360
    s_mov_b32 s11, 0x00020000
    s_lshl_b32 s51, s48, 8
    s_add_u32 s12, s42, s51
    s_addc_u32 s13, s43, 0
    s_mov_b32 s14, 4187392
    s_mov_b32 s15, 0x00020000
    s_lshl_b32 s58, s46, 20
    s_add_u32 s16, s44, s58
    s_addc_u32 s17, s45, 0
    s_mov_b32 s18, 1048576
    s_mov_b32 s19, 0x00020000
    s_lshl_b32 s58, s46, 20
    s_add_u32 s84, s44, s58
    s_addc_u32 s85, s45, 0
    s_mov_b32 s86, 1048576
    s_mov_b32 s87, 0x00020000
    s_lshl_b32 s59, s46, 3
    s_lshl_b32 s51, s47, 3
    s_add_u32 s51, s51, s34
    s_lshl_b32 s51, s51, 5
    s_add_u32 s51, s51, s59
    s_lshl_b32 s51, s51, 15
    s_add_u32 s20, s52, s51
    s_addc_u32 s21, s53, 0
    s_mov_b32 s22, 262144
    s_mov_b32 s23, 0x00020000
    s_lshl_b32 s58, s50, 10
    s_add_u32 s58, s58, 100663296
    s_add_u32 s24, s52, s58
    s_addc_u32 s25, s53, 0
    s_mov_b32 s26, 1024
    s_mov_b32 s27, 0x00020000
    s_lshl_b32 s58, s47, 3
    s_add_u32 s58, s58, s34
    s_lshl_b32 s58, s58, 2
    s_add_u32 s58, s58, s35
    s_lshl_b32 s58, s58, 18
    s_add_u32 s58, s58, 33554432
    s_add_u32 s68, s52, s58
    s_addc_u32 s69, s53, 0
    s_mov_b32 s70, 262144
    s_mov_b32 s71, 0x00020000
    s_mov_b32 s76, s74
    s_mov_b32 s77, s75
    s_mov_b32 s78, 1835008
    s_mov_b32 s79, 0x00020000
    s_lshl_b32 s58, s47, 3
    s_add_u32 s58, s58, s34
    s_lshl_b32 s58, s58, 7
    s_add_u32 s58, s58, 101711872
    s_add_u32 s92, s52, s58
    s_addc_u32 s93, s53, 0
    s_load_dword s90, s[92:93], 0
    s_waitcnt lgkmcnt(0)
    s_xor_b32 s89, s90, 0x9e3779b9
    s_barrier
    ds_read_b128 v[96:99], v12 offset:0
    ds_read_b64_tr_b16 v[224:225], v8 offset:16384
    ds_read_b64_tr_b16 v[226:227], v8 offset:17408
    ds_read_b64_tr_b16 v[228:229], v9 offset:16384
    ds_read_b64_tr_b16 v[230:231], v9 offset:17408
    ds_read_b64_tr_b16 v[232:233], v10 offset:16384
    ds_read_b64_tr_b16 v[234:235], v10 offset:17408
    ds_read_b64_tr_b16 v[236:237], v11 offset:16384
    ds_read_b64_tr_b16 v[238:239], v11 offset:17408
    ds_read_b128 v[100:103], v13 offset:0
    ds_read_b64_tr_b16 v[240:241], v8 offset:20480
    ds_read_b64_tr_b16 v[242:243], v8 offset:21504
    s_waitcnt lgkmcnt(9)
    v_mfma_f32_32x32x16_bf16 v[32:47], v[224:227], v[96:99], 0
    ds_read_b64_tr_b16 v[244:245], v9 offset:20480
    ds_read_b64_tr_b16 v[246:247], v9 offset:21504
    s_waitcnt lgkmcnt(9)
    v_mfma_f32_32x32x16_bf16 v[48:63], v[228:231], v[96:99], 0
    ds_read_b64_tr_b16 v[248:249], v10 offset:20480
    ds_read_b64_tr_b16 v[250:251], v10 offset:21504
    s_waitcnt lgkmcnt(9)
    v_mfma_f32_32x32x16_bf16 v[64:79], v[232:235], v[96:99], 0
    ds_read_b64_tr_b16 v[252:253], v11 offset:20480
    ds_read_b64_tr_b16 v[254:255], v11 offset:21504
    s_waitcnt lgkmcnt(9)
    v_mfma_f32_32x32x16_bf16 v[80:95], v[236:239], v[96:99], 0
    ds_read_b128 v[104:107], v14 offset:0
    ds_read_b64_tr_b16 v[224:225], v8 offset:24576
    ds_read_b64_tr_b16 v[226:227], v8 offset:25600
    s_waitcnt lgkmcnt(9)
    v_mfma_f32_32x32x16_bf16 v[32:47], v[240:243], v[100:103], v[32:47]
    ds_read_b64_tr_b16 v[228:229], v9 offset:24576
    ds_read_b64_tr_b16 v[230:231], v9 offset:25600
    s_waitcnt lgkmcnt(9)
    v_mfma_f32_32x32x16_bf16 v[48:63], v[244:247], v[100:103], v[48:63]
    ds_read_b64_tr_b16 v[232:233], v10 offset:24576
    ds_read_b64_tr_b16 v[234:235], v10 offset:25600
    s_waitcnt lgkmcnt(9)
    v_mfma_f32_32x32x16_bf16 v[64:79], v[248:251], v[100:103], v[64:79]
    ds_read_b64_tr_b16 v[236:237], v11 offset:24576
    ds_read_b64_tr_b16 v[238:239], v11 offset:25600
    s_waitcnt lgkmcnt(9)
    v_mfma_f32_32x32x16_bf16 v[80:95], v[252:255], v[100:103], v[80:95]
    ds_read_b128 v[108:111], v15 offset:0
    ds_read_b64_tr_b16 v[240:241], v8 offset:28672
    ds_read_b64_tr_b16 v[242:243], v8 offset:29696
    s_waitcnt lgkmcnt(9)
    v_mfma_f32_32x32x16_bf16 v[32:47], v[224:227], v[104:107], v[32:47]
    ds_read_b64_tr_b16 v[244:245], v9 offset:28672
    ds_read_b64_tr_b16 v[246:247], v9 offset:29696
    s_waitcnt lgkmcnt(9)
    v_mfma_f32_32x32x16_bf16 v[48:63], v[228:231], v[104:107], v[48:63]
    ds_read_b64_tr_b16 v[248:249], v10 offset:28672
    ds_read_b64_tr_b16 v[250:251], v10 offset:29696
    s_waitcnt lgkmcnt(9)
    v_mfma_f32_32x32x16_bf16 v[64:79], v[232:235], v[104:107], v[64:79]
    ds_read_b64_tr_b16 v[252:253], v11 offset:28672
    ds_read_b64_tr_b16 v[254:255], v11 offset:29696
    s_waitcnt lgkmcnt(9)
    v_mfma_f32_32x32x16_bf16 v[80:95], v[236:239], v[104:107], v[80:95]
    s_barrier
    ds_read_b128 v[112:115], v28 offset:0
    ds_read_b64_tr_b16 v[224:225], v8 offset:32768
    ds_read_b64_tr_b16 v[226:227], v8 offset:33792
    s_waitcnt lgkmcnt(9)
    v_mfma_f32_32x32x16_bf16 v[32:47], v[240:243], v[108:111], v[32:47]
    ds_read_b64_tr_b16 v[228:229], v9 offset:32768
    ds_read_b64_tr_b16 v[230:231], v9 offset:33792
    s_waitcnt lgkmcnt(9)
    v_mfma_f32_32x32x16_bf16 v[48:63], v[244:247], v[108:111], v[48:63]
    ds_read_b64_tr_b16 v[232:233], v10 offset:32768
    ds_read_b64_tr_b16 v[234:235], v10 offset:33792
    s_waitcnt lgkmcnt(9)
    v_mfma_f32_32x32x16_bf16 v[64:79], v[248:251], v[108:111], v[64:79]
    ds_read_b64_tr_b16 v[236:237], v11 offset:32768
    ds_read_b64_tr_b16 v[238:239], v11 offset:33792
    s_waitcnt lgkmcnt(9)
    v_mfma_f32_32x32x16_bf16 v[80:95], v[252:255], v[108:111], v[80:95]
    ds_read_b128 v[116:119], v29 offset:0
    ds_read_b64_tr_b16 v[240:241], v8 offset:36864
    ds_read_b64_tr_b16 v[242:243], v8 offset:37888
    s_waitcnt lgkmcnt(9)
    v_mfma_f32_32x32x16_bf16 v[32:47], v[224:227], v[112:115], v[32:47]
    ds_read_b64_tr_b16 v[244:245], v9 offset:36864
    ds_read_b64_tr_b16 v[246:247], v9 offset:37888
    s_waitcnt lgkmcnt(9)
    v_mfma_f32_32x32x16_bf16 v[48:63], v[228:231], v[112:115], v[48:63]
    ds_read_b64_tr_b16 v[248:249], v10 offset:36864
    ds_read_b64_tr_b16 v[250:251], v10 offset:37888
    s_waitcnt lgkmcnt(9)
    v_mfma_f32_32x32x16_bf16 v[64:79], v[232:235], v[112:115], v[64:79]
    ds_read_b64_tr_b16 v[252:253], v11 offset:36864
    ds_read_b64_tr_b16 v[254:255], v11 offset:37888
    s_waitcnt lgkmcnt(9)
    v_mfma_f32_32x32x16_bf16 v[80:95], v[236:239], v[112:115], v[80:95]
    ds_read_b128 v[120:123], v30 offset:0
    ds_read_b64_tr_b16 v[224:225], v8 offset:40960
    ds_read_b64_tr_b16 v[226:227], v8 offset:41984
    s_waitcnt lgkmcnt(9)
    v_mfma_f32_32x32x16_bf16 v[32:47], v[240:243], v[116:119], v[32:47]
    ds_read_b64_tr_b16 v[228:229], v9 offset:40960
    ds_read_b64_tr_b16 v[230:231], v9 offset:41984
    s_waitcnt lgkmcnt(9)
    v_mfma_f32_32x32x16_bf16 v[48:63], v[244:247], v[116:119], v[48:63]
    ds_read_b64_tr_b16 v[232:233], v10 offset:40960
    ds_read_b64_tr_b16 v[234:235], v10 offset:41984
    s_waitcnt lgkmcnt(9)
    v_mfma_f32_32x32x16_bf16 v[64:79], v[248:251], v[116:119], v[64:79]
    ds_read_b64_tr_b16 v[236:237], v11 offset:40960
    ds_read_b64_tr_b16 v[238:239], v11 offset:41984
    s_waitcnt lgkmcnt(9)
    v_mfma_f32_32x32x16_bf16 v[80:95], v[252:255], v[116:119], v[80:95]
    ds_read_b128 v[124:127], v31 offset:0
    ds_read_b64_tr_b16 v[240:241], v8 offset:45056
    ds_read_b64_tr_b16 v[242:243], v8 offset:46080
    s_waitcnt lgkmcnt(9)
    v_mfma_f32_32x32x16_bf16 v[32:47], v[224:227], v[120:123], v[32:47]
    ds_read_b64_tr_b16 v[244:245], v9 offset:45056
    ds_read_b64_tr_b16 v[246:247], v9 offset:46080
    s_waitcnt lgkmcnt(9)
    v_mfma_f32_32x32x16_bf16 v[48:63], v[228:231], v[120:123], v[48:63]
    ds_read_b64_tr_b16 v[248:249], v10 offset:45056
    ds_read_b64_tr_b16 v[250:251], v10 offset:46080
    s_waitcnt lgkmcnt(9)
    v_mfma_f32_32x32x16_bf16 v[64:79], v[232:235], v[120:123], v[64:79]
    ds_read_b64_tr_b16 v[252:253], v11 offset:45056
    ds_read_b64_tr_b16 v[254:255], v11 offset:46080
    s_waitcnt lgkmcnt(9)
    v_mfma_f32_32x32x16_bf16 v[80:95], v[236:239], v[120:123], v[80:95]
    s_barrier
    ds_read_b128 v[128:131], v28 offset:16384
    ds_read_b64_tr_b16 v[224:225], v4 offset:32768
    ds_read_b64_tr_b16 v[226:227], v4 offset:33792
    s_waitcnt lgkmcnt(9)
    v_mfma_f32_32x32x16_bf16 v[32:47], v[240:243], v[124:127], v[32:47]
    ds_read_b64_tr_b16 v[228:229], v5 offset:32768
    ds_read_b64_tr_b16 v[230:231], v5 offset:33792
    s_waitcnt lgkmcnt(9)
    v_mfma_f32_32x32x16_bf16 v[48:63], v[244:247], v[124:127], v[48:63]
    ds_read_b64_tr_b16 v[232:233], v6 offset:32768
    ds_read_b64_tr_b16 v[234:235], v6 offset:33792
    s_waitcnt lgkmcnt(9)
    v_mfma_f32_32x32x16_bf16 v[64:79], v[248:251], v[124:127], v[64:79]
    ds_read_b64_tr_b16 v[236:237], v7 offset:32768
    ds_read_b64_tr_b16 v[238:239], v7 offset:33792
    s_waitcnt lgkmcnt(9)
    v_mfma_f32_32x32x16_bf16 v[80:95], v[252:255], v[124:127], v[80:95]
    ds_read_b128 v[132:135], v29 offset:16384
    ds_read_b64_tr_b16 v[240:241], v4 offset:36864
    ds_read_b64_tr_b16 v[242:243], v4 offset:37888
    s_waitcnt lgkmcnt(9)
    v_mfma_f32_32x32x16_bf16 v[32:47], v[224:227], v[128:131], v[32:47]
    ds_read_b64_tr_b16 v[244:245], v5 offset:36864
    ds_read_b64_tr_b16 v[246:247], v5 offset:37888
    s_waitcnt lgkmcnt(9)
    v_mfma_f32_32x32x16_bf16 v[48:63], v[228:231], v[128:131], v[48:63]
    ds_read_b64_tr_b16 v[248:249], v6 offset:36864
    ds_read_b64_tr_b16 v[250:251], v6 offset:37888
    s_waitcnt lgkmcnt(9)
    v_mfma_f32_32x32x16_bf16 v[64:79], v[232:235], v[128:131], v[64:79]
    ds_read_b64_tr_b16 v[252:253], v7 offset:36864
    ds_read_b64_tr_b16 v[254:255], v7 offset:37888
    s_waitcnt lgkmcnt(9)
    v_mfma_f32_32x32x16_bf16 v[80:95], v[236:239], v[128:131], v[80:95]
    ds_read_b128 v[136:139], v30 offset:16384
    ds_read_b64_tr_b16 v[224:225], v4 offset:40960
    ds_read_b64_tr_b16 v[226:227], v4 offset:41984
    s_waitcnt lgkmcnt(9)
    v_mfma_f32_32x32x16_bf16 v[32:47], v[240:243], v[132:135], v[32:47]
    ds_read_b64_tr_b16 v[228:229], v5 offset:40960
    ds_read_b64_tr_b16 v[230:231], v5 offset:41984
    s_waitcnt lgkmcnt(9)
    v_mfma_f32_32x32x16_bf16 v[48:63], v[244:247], v[132:135], v[48:63]
    ds_read_b64_tr_b16 v[232:233], v6 offset:40960
    ds_read_b64_tr_b16 v[234:235], v6 offset:41984
    s_waitcnt lgkmcnt(9)
    v_mfma_f32_32x32x16_bf16 v[64:79], v[248:251], v[132:135], v[64:79]
    ds_read_b64_tr_b16 v[236:237], v7 offset:40960
    ds_read_b64_tr_b16 v[238:239], v7 offset:41984
    s_waitcnt lgkmcnt(9)
    v_mfma_f32_32x32x16_bf16 v[80:95], v[252:255], v[132:135], v[80:95]
    ds_read_b128 v[140:143], v31 offset:16384
    ds_read_b64_tr_b16 v[240:241], v4 offset:45056
    ds_read_b64_tr_b16 v[242:243], v4 offset:46080
    s_waitcnt lgkmcnt(9)
    v_mfma_f32_32x32x16_bf16 v[32:47], v[224:227], v[136:139], v[32:47]
    ds_read_b64_tr_b16 v[244:245], v5 offset:45056
    ds_read_b64_tr_b16 v[246:247], v5 offset:46080
    s_waitcnt lgkmcnt(9)
    v_mfma_f32_32x32x16_bf16 v[48:63], v[228:231], v[136:139], v[48:63]
    ds_read_b64_tr_b16 v[248:249], v6 offset:45056
    ds_read_b64_tr_b16 v[250:251], v6 offset:46080
    s_waitcnt lgkmcnt(9)
    v_mfma_f32_32x32x16_bf16 v[64:79], v[232:235], v[136:139], v[64:79]
    ds_read_b64_tr_b16 v[252:253], v7 offset:45056
    ds_read_b64_tr_b16 v[254:255], v7 offset:46080
    s_waitcnt lgkmcnt(9)
    v_mfma_f32_32x32x16_bf16 v[80:95], v[236:239], v[136:139], v[80:95]
    s_barrier
    ds_read_b128 v[144:147], v28 offset:49152
    ds_read_b64_tr_b16 v[224:225], v8 offset:49152
    ds_read_b64_tr_b16 v[226:227], v8 offset:50176
    s_waitcnt lgkmcnt(9)
    v_mfma_f32_32x32x16_bf16 v[32:47], v[240:243], v[140:143], v[32:47]
    ds_read_b64_tr_b16 v[228:229], v9 offset:49152
    ds_read_b64_tr_b16 v[230:231], v9 offset:50176
    s_waitcnt lgkmcnt(9)
    v_mfma_f32_32x32x16_bf16 v[48:63], v[244:247], v[140:143], v[48:63]
    ds_read_b64_tr_b16 v[232:233], v10 offset:49152
    ds_read_b64_tr_b16 v[234:235], v10 offset:50176
    s_waitcnt lgkmcnt(9)
    v_mfma_f32_32x32x16_bf16 v[64:79], v[248:251], v[140:143], v[64:79]
    ds_read_b64_tr_b16 v[236:237], v11 offset:49152
    ds_read_b64_tr_b16 v[238:239], v11 offset:50176
    s_waitcnt lgkmcnt(9)
    v_mfma_f32_32x32x16_bf16 v[80:95], v[252:255], v[140:143], v[80:95]
    ds_read_b128 v[148:151], v29 offset:49152
    ds_read_b64_tr_b16 v[240:241], v8 offset:53248
    ds_read_b64_tr_b16 v[242:243], v8 offset:54272
    s_waitcnt lgkmcnt(9)
    v_mfma_f32_32x32x16_bf16 v[32:47], v[224:227], v[144:147], v[32:47]
    ds_read_b64_tr_b16 v[244:245], v9 offset:53248
    ds_read_b64_tr_b16 v[246:247], v9 offset:54272
    s_waitcnt lgkmcnt(9)
    v_mfma_f32_32x32x16_bf16 v[48:63], v[228:231], v[144:147], v[48:63]
    ds_read_b64_tr_b16 v[248:249], v10 offset:53248
    ds_read_b64_tr_b16 v[250:251], v10 offset:54272
    s_waitcnt lgkmcnt(9)
    v_mfma_f32_32x32x16_bf16 v[64:79], v[232:235], v[144:147], v[64:79]
    ds_read_b64_tr_b16 v[252:253], v11 offset:53248
    ds_read_b64_tr_b16 v[254:255], v11 offset:54272
    s_waitcnt lgkmcnt(9)
    v_mfma_f32_32x32x16_bf16 v[80:95], v[236:239], v[144:147], v[80:95]
    ds_read_b128 v[152:155], v30 offset:49152
    ds_read_b64_tr_b16 v[224:225], v8 offset:57344
    ds_read_b64_tr_b16 v[226:227], v8 offset:58368
    s_waitcnt lgkmcnt(9)
    v_mfma_f32_32x32x16_bf16 v[32:47], v[240:243], v[148:151], v[32:47]
    ds_read_b64_tr_b16 v[228:229], v9 offset:57344
    ds_read_b64_tr_b16 v[230:231], v9 offset:58368
    s_waitcnt lgkmcnt(9)
    v_mfma_f32_32x32x16_bf16 v[48:63], v[244:247], v[148:151], v[48:63]
    ds_read_b64_tr_b16 v[232:233], v10 offset:57344
    ds_read_b64_tr_b16 v[234:235], v10 offset:58368
    s_waitcnt lgkmcnt(9)
    v_mfma_f32_32x32x16_bf16 v[64:79], v[248:251], v[148:151], v[64:79]
    ds_read_b64_tr_b16 v[236:237], v11 offset:57344
    ds_read_b64_tr_b16 v[238:239], v11 offset:58368
    s_waitcnt lgkmcnt(9)
    v_mfma_f32_32x32x16_bf16 v[80:95], v[252:255], v[148:151], v[80:95]
    ds_read_b128 v[156:159], v31 offset:49152
    ds_read_b64_tr_b16 v[240:241], v8 offset:61440
    ds_read_b64_tr_b16 v[242:243], v8 offset:62464
    s_waitcnt lgkmcnt(9)
    v_mfma_f32_32x32x16_bf16 v[32:47], v[224:227], v[152:155], v[32:47]
    ds_read_b64_tr_b16 v[244:245], v9 offset:61440
    ds_read_b64_tr_b16 v[246:247], v9 offset:62464
    s_waitcnt lgkmcnt(9)
    v_mfma_f32_32x32x16_bf16 v[48:63], v[228:231], v[152:155], v[48:63]
    ds_read_b64_tr_b16 v[248:249], v10 offset:61440
    ds_read_b64_tr_b16 v[250:251], v10 offset:62464
    s_waitcnt lgkmcnt(9)
    v_mfma_f32_32x32x16_bf16 v[64:79], v[232:235], v[152:155], v[64:79]
    ds_read_b64_tr_b16 v[252:253], v11 offset:61440
    ds_read_b64_tr_b16 v[254:255], v11 offset:62464
    s_waitcnt lgkmcnt(9)
    v_mfma_f32_32x32x16_bf16 v[80:95], v[236:239], v[152:155], v[80:95]
    s_barrier
    ds_read_b128 v[160:163], v12 offset:0
    ds_read_b64_tr_b16 v[224:225], v8 offset:16384
    ds_read_b64_tr_b16 v[226:227], v8 offset:17408
    s_waitcnt lgkmcnt(9)
    v_mfma_f32_32x32x16_bf16 v[32:47], v[240:243], v[156:159], v[32:47]
    ds_read_b64_tr_b16 v[228:229], v9 offset:16384
    ds_read_b64_tr_b16 v[230:231], v9 offset:17408
    s_waitcnt lgkmcnt(9)
    v_mfma_f32_32x32x16_bf16 v[48:63], v[244:247], v[156:159], v[48:63]
    ds_read_b64_tr_b16 v[232:233], v10 offset:16384
    ds_read_b64_tr_b16 v[234:235], v10 offset:17408
    s_waitcnt lgkmcnt(9)
    v_mfma_f32_32x32x16_bf16 v[64:79], v[248:251], v[156:159], v[64:79]
    ds_read_b64_tr_b16 v[236:237], v11 offset:16384
    ds_read_b64_tr_b16 v[238:239], v11 offset:17408
    s_waitcnt lgkmcnt(9)
    v_mfma_f32_32x32x16_bf16 v[80:95], v[252:255], v[156:159], v[80:95]
    ds_read_b128 v[164:167], v13 offset:0
    ds_read_b64_tr_b16 v[240:241], v8 offset:20480
    ds_read_b64_tr_b16 v[242:243], v8 offset:21504
    s_waitcnt lgkmcnt(9)
    v_mfma_f32_32x32x16_bf16 v[32:47], v[224:227], v[160:163], v[32:47]
    ds_read_b64_tr_b16 v[244:245], v9 offset:20480
    ds_read_b64_tr_b16 v[246:247], v9 offset:21504
    s_waitcnt lgkmcnt(9)
    v_mfma_f32_32x32x16_bf16 v[48:63], v[228:231], v[160:163], v[48:63]
    ds_read_b64_tr_b16 v[248:249], v10 offset:20480
    ds_read_b64_tr_b16 v[250:251], v10 offset:21504
    s_waitcnt lgkmcnt(9)
    v_mfma_f32_32x32x16_bf16 v[64:79], v[232:235], v[160:163], v[64:79]
    ds_read_b64_tr_b16 v[252:253], v11 offset:20480
    ds_read_b64_tr_b16 v[254:255], v11 offset:21504
    s_waitcnt lgkmcnt(9)
    v_mfma_f32_32x32x16_bf16 v[80:95], v[236:239], v[160:163], v[80:95]
    ds_read_b128 v[168:171], v14 offset:0
    ds_read_b64_tr_b16 v[224:225], v8 offset:24576
    ds_read_b64_tr_b16 v[226:227], v8 offset:25600
    s_waitcnt lgkmcnt(9)
    v_mfma_f32_32x32x16_bf16 v[32:47], v[240:243], v[164:167], v[32:47]
    ds_read_b64_tr_b16 v[228:229], v9 offset:24576
    ds_read_b64_tr_b16 v[230:231], v9 offset:25600
    s_waitcnt lgkmcnt(9)
    v_mfma_f32_32x32x16_bf16 v[48:63], v[244:247], v[164:167], v[48:63]
    ds_read_b64_tr_b16 v[232:233], v10 offset:24576
    ds_read_b64_tr_b16 v[234:235], v10 offset:25600
    s_waitcnt lgkmcnt(9)
    v_mfma_f32_32x32x16_bf16 v[64:79], v[248:251], v[164:167], v[64:79]
    ds_read_b64_tr_b16 v[236:237], v11 offset:24576
    ds_read_b64_tr_b16 v[238:239], v11 offset:25600
    s_waitcnt lgkmcnt(9)
    v_mfma_f32_32x32x16_bf16 v[80:95], v[252:255], v[164:167], v[80:95]
    ds_read_b128 v[172:175], v15 offset:0
    ds_read_b64_tr_b16 v[240:241], v8 offset:28672
    ds_read_b64_tr_b16 v[242:243], v8 offset:29696
    s_waitcnt lgkmcnt(9)
    v_mfma_f32_32x32x16_bf16 v[32:47], v[224:227], v[168:171], v[32:47]
    ds_read_b64_tr_b16 v[244:245], v9 offset:28672
    ds_read_b64_tr_b16 v[246:247], v9 offset:29696
    s_waitcnt lgkmcnt(9)
    v_mfma_f32_32x32x16_bf16 v[48:63], v[228:231], v[168:171], v[48:63]
    ds_read_b64_tr_b16 v[248:249], v10 offset:28672
    ds_read_b64_tr_b16 v[250:251], v10 offset:29696
    s_waitcnt lgkmcnt(9)
    v_mfma_f32_32x32x16_bf16 v[64:79], v[232:235], v[168:171], v[64:79]
    ds_read_b64_tr_b16 v[252:253], v11 offset:28672
    ds_read_b64_tr_b16 v[254:255], v11 offset:29696
    s_waitcnt lgkmcnt(9)
    v_mfma_f32_32x32x16_bf16 v[80:95], v[236:239], v[168:171], v[80:95]
    s_barrier
    ds_read_b128 v[176:179], v28 offset:0
    ds_read_b64_tr_b16 v[224:225], v8 offset:32768
    ds_read_b64_tr_b16 v[226:227], v8 offset:33792
    s_waitcnt lgkmcnt(9)
    v_mfma_f32_32x32x16_bf16 v[32:47], v[240:243], v[172:175], v[32:47]
    ds_read_b64_tr_b16 v[228:229], v9 offset:32768
    ds_read_b64_tr_b16 v[230:231], v9 offset:33792
    s_waitcnt lgkmcnt(9)
    v_mfma_f32_32x32x16_bf16 v[48:63], v[244:247], v[172:175], v[48:63]
    ds_read_b64_tr_b16 v[232:233], v10 offset:32768
    ds_read_b64_tr_b16 v[234:235], v10 offset:33792
    s_waitcnt lgkmcnt(9)
    v_mfma_f32_32x32x16_bf16 v[64:79], v[248:251], v[172:175], v[64:79]
    ds_read_b64_tr_b16 v[236:237], v11 offset:32768
    ds_read_b64_tr_b16 v[238:239], v11 offset:33792
    s_waitcnt lgkmcnt(9)
    v_mfma_f32_32x32x16_bf16 v[80:95], v[252:255], v[172:175], v[80:95]
    ds_read_b128 v[180:183], v29 offset:0
    ds_read_b64_tr_b16 v[240:241], v8 offset:36864
    ds_read_b64_tr_b16 v[242:243], v8 offset:37888
    s_waitcnt lgkmcnt(9)
    v_mfma_f32_32x32x16_bf16 v[32:47], v[224:227], v[176:179], v[32:47]
    ds_read_b64_tr_b16 v[244:245], v9 offset:36864
    ds_read_b64_tr_b16 v[246:247], v9 offset:37888
    s_waitcnt lgkmcnt(9)
    v_mfma_f32_32x32x16_bf16 v[48:63], v[228:231], v[176:179], v[48:63]
    ds_read_b64_tr_b16 v[248:249], v10 offset:36864
    ds_read_b64_tr_b16 v[250:251], v10 offset:37888
    s_waitcnt lgkmcnt(9)
    v_mfma_f32_32x32x16_bf16 v[64:79], v[232:235], v[176:179], v[64:79]
    ds_read_b64_tr_b16 v[252:253], v11 offset:36864
    ds_read_b64_tr_b16 v[254:255], v11 offset:37888
    s_waitcnt lgkmcnt(9)
    v_mfma_f32_32x32x16_bf16 v[80:95], v[236:239], v[176:179], v[80:95]
    ds_read_b128 v[184:187], v30 offset:0
    ds_read_b64_tr_b16 v[224:225], v8 offset:40960
    ds_read_b64_tr_b16 v[226:227], v8 offset:41984
    s_waitcnt lgkmcnt(9)
    v_mfma_f32_32x32x16_bf16 v[32:47], v[240:243], v[180:183], v[32:47]
    ds_read_b64_tr_b16 v[228:229], v9 offset:40960
    ds_read_b64_tr_b16 v[230:231], v9 offset:41984
    s_waitcnt lgkmcnt(9)
    v_mfma_f32_32x32x16_bf16 v[48:63], v[244:247], v[180:183], v[48:63]
    ds_read_b64_tr_b16 v[232:233], v10 offset:40960
    ds_read_b64_tr_b16 v[234:235], v10 offset:41984
    s_waitcnt lgkmcnt(9)
    v_mfma_f32_32x32x16_bf16 v[64:79], v[248:251], v[180:183], v[64:79]
    ds_read_b64_tr_b16 v[236:237], v11 offset:40960
    ds_read_b64_tr_b16 v[238:239], v11 offset:41984
    s_waitcnt lgkmcnt(9)
    v_mfma_f32_32x32x16_bf16 v[80:95], v[252:255], v[180:183], v[80:95]
    ds_read_b128 v[188:191], v31 offset:0
    ds_read_b64_tr_b16 v[240:241], v8 offset:45056
    ds_read_b64_tr_b16 v[242:243], v8 offset:46080
    s_waitcnt lgkmcnt(9)
    v_mfma_f32_32x32x16_bf16 v[32:47], v[224:227], v[184:187], v[32:47]
    ds_read_b64_tr_b16 v[244:245], v9 offset:45056
    ds_read_b64_tr_b16 v[246:247], v9 offset:46080
    s_waitcnt lgkmcnt(9)
    v_mfma_f32_32x32x16_bf16 v[48:63], v[228:231], v[184:187], v[48:63]
    ds_read_b64_tr_b16 v[248:249], v10 offset:45056
    ds_read_b64_tr_b16 v[250:251], v10 offset:46080
    s_waitcnt lgkmcnt(9)
    v_mfma_f32_32x32x16_bf16 v[64:79], v[232:235], v[184:187], v[64:79]
    ds_read_b64_tr_b16 v[252:253], v11 offset:45056
    ds_read_b64_tr_b16 v[254:255], v11 offset:46080
    s_waitcnt lgkmcnt(9)
    v_mfma_f32_32x32x16_bf16 v[80:95], v[236:239], v[184:187], v[80:95]
    s_barrier
    ds_read_b128 v[192:195], v28 offset:16384
    ds_read_b64_tr_b16 v[224:225], v4 offset:32768
    ds_read_b64_tr_b16 v[226:227], v4 offset:33792
    s_waitcnt lgkmcnt(9)
    v_mfma_f32_32x32x16_bf16 v[32:47], v[240:243], v[188:191], v[32:47]
    ds_read_b64_tr_b16 v[228:229], v5 offset:32768
    ds_read_b64_tr_b16 v[230:231], v5 offset:33792
    s_waitcnt lgkmcnt(9)
    v_mfma_f32_32x32x16_bf16 v[48:63], v[244:247], v[188:191], v[48:63]
    ds_read_b64_tr_b16 v[232:233], v6 offset:32768
    ds_read_b64_tr_b16 v[234:235], v6 offset:33792
    s_waitcnt lgkmcnt(9)
    v_mfma_f32_32x32x16_bf16 v[64:79], v[248:251], v[188:191], v[64:79]
    ds_read_b64_tr_b16 v[236:237], v7 offset:32768
    ds_read_b64_tr_b16 v[238:239], v7 offset:33792
    s_waitcnt lgkmcnt(9)
    v_mfma_f32_32x32x16_bf16 v[80:95], v[252:255], v[188:191], v[80:95]
    ds_read_b128 v[196:199], v29 offset:16384
    ds_read_b64_tr_b16 v[240:241], v4 offset:36864
    ds_read_b64_tr_b16 v[242:243], v4 offset:37888
    s_waitcnt lgkmcnt(9)
    v_mfma_f32_32x32x16_bf16 v[32:47], v[224:227], v[192:195], v[32:47]
    ds_read_b64_tr_b16 v[244:245], v5 offset:36864
    ds_read_b64_tr_b16 v[246:247], v5 offset:37888
    s_waitcnt lgkmcnt(9)
    v_mfma_f32_32x32x16_bf16 v[48:63], v[228:231], v[192:195], v[48:63]
    ds_read_b64_tr_b16 v[248:249], v6 offset:36864
    ds_read_b64_tr_b16 v[250:251], v6 offset:37888
    s_waitcnt lgkmcnt(9)
    v_mfma_f32_32x32x16_bf16 v[64:79], v[232:235], v[192:195], v[64:79]
    ds_read_b64_tr_b16 v[252:253], v7 offset:36864
    ds_read_b64_tr_b16 v[254:255], v7 offset:37888
    s_waitcnt lgkmcnt(9)
    v_mfma_f32_32x32x16_bf16 v[80:95], v[236:239], v[192:195], v[80:95]
    ds_read_b128 v[200:203], v30 offset:16384
    ds_read_b64_tr_b16 v[224:225], v4 offset:40960
    ds_read_b64_tr_b16 v[226:227], v4 offset:41984
    s_waitcnt lgkmcnt(9)
    v_mfma_f32_32x32x16_bf16 v[32:47], v[240:243], v[196:199], v[32:47]
    ds_read_b64_tr_b16 v[228:229], v5 offset:40960
    ds_read_b64_tr_b16 v[230:231], v5 offset:41984
    s_waitcnt lgkmcnt(9)
    v_mfma_f32_32x32x16_bf16 v[48:63], v[244:247], v[196:199], v[48:63]
    ds_read_b64_tr_b16 v[232:233], v6 offset:40960
    ds_read_b64_tr_b16 v[234:235], v6 offset:41984
    s_waitcnt lgkmcnt(9)
    v_mfma_f32_32x32x16_bf16 v[64:79], v[248:251], v[196:199], v[64:79]
    ds_read_b64_tr_b16 v[236:237], v7 offset:40960
    ds_read_b64_tr_b16 v[238:239], v7 offset:41984
    s_waitcnt lgkmcnt(9)
    v_mfma_f32_32x32x16_bf16 v[80:95], v[252:255], v[196:199], v[80:95]
    ds_read_b128 v[204:207], v31 offset:16384
    ds_read_b64_tr_b16 v[240:241], v4 offset:45056
    ds_read_b64_tr_b16 v[242:243], v4 offset:46080
    s_waitcnt lgkmcnt(9)
    v_mfma_f32_32x32x16_bf16 v[32:47], v[224:227], v[200:203], v[32:47]
    ds_read_b64_tr_b16 v[244:245], v5 offset:45056
    ds_read_b64_tr_b16 v[246:247], v5 offset:46080
    s_waitcnt lgkmcnt(9)
    v_mfma_f32_32x32x16_bf16 v[48:63], v[228:231], v[200:203], v[48:63]
    ds_read_b64_tr_b16 v[248:249], v6 offset:45056
    ds_read_b64_tr_b16 v[250:251], v6 offset:46080
    s_waitcnt lgkmcnt(9)
    v_mfma_f32_32x32x16_bf16 v[64:79], v[232:235], v[200:203], v[64:79]
    ds_read_b64_tr_b16 v[252:253], v7 offset:45056
    ds_read_b64_tr_b16 v[254:255], v7 offset:46080
    s_waitcnt lgkmcnt(9)
    v_mfma_f32_32x32x16_bf16 v[80:95], v[236:239], v[200:203], v[80:95]
    s_waitcnt lgkmcnt(0)
    s_barrier
    ds_read_b128 v[208:211], v28 offset:49152
    ds_read_b64_tr_b16 v[224:225], v8 offset:49152
    ds_read_b64_tr_b16 v[226:227], v8 offset:50176
    v_mfma_f32_32x32x16_bf16 v[32:47], v[240:243], v[204:207], v[32:47]
    ds_read_b64_tr_b16 v[228:229], v9 offset:49152
    ds_read_b64_tr_b16 v[230:231], v9 offset:50176
    v_mfma_f32_32x32x16_bf16 v[48:63], v[244:247], v[204:207], v[48:63]
    ds_read_b64_tr_b16 v[232:233], v10 offset:49152
    ds_read_b64_tr_b16 v[234:235], v10 offset:50176
    v_mfma_f32_32x32x16_bf16 v[64:79], v[248:251], v[204:207], v[64:79]
    ds_read_b64_tr_b16 v[236:237], v11 offset:49152
    ds_read_b64_tr_b16 v[238:239], v11 offset:50176
    v_mfma_f32_32x32x16_bf16 v[80:95], v[252:255], v[204:207], v[80:95]
    ds_read_b128 v[212:215], v29 offset:49152
    ds_read_b64_tr_b16 v[240:241], v8 offset:53248
    ds_read_b64_tr_b16 v[242:243], v8 offset:54272
    s_waitcnt lgkmcnt(9)
    v_mfma_f32_32x32x16_bf16 v[32:47], v[224:227], v[208:211], v[32:47]
    ds_read_b64_tr_b16 v[244:245], v9 offset:53248
    ds_read_b64_tr_b16 v[246:247], v9 offset:54272
    s_waitcnt lgkmcnt(9)
    v_mfma_f32_32x32x16_bf16 v[48:63], v[228:231], v[208:211], v[48:63]
    ds_read_b64_tr_b16 v[248:249], v10 offset:53248
    ds_read_b64_tr_b16 v[250:251], v10 offset:54272
    s_waitcnt lgkmcnt(9)
    v_mfma_f32_32x32x16_bf16 v[64:79], v[232:235], v[208:211], v[64:79]
    ds_read_b64_tr_b16 v[252:253], v11 offset:53248
    ds_read_b64_tr_b16 v[254:255], v11 offset:54272
    s_waitcnt lgkmcnt(9)
    v_mfma_f32_32x32x16_bf16 v[80:95], v[236:239], v[208:211], v[80:95]
    ds_read_b128 v[216:219], v30 offset:49152
    ds_read_b64_tr_b16 v[224:225], v8 offset:57344
    ds_read_b64_tr_b16 v[226:227], v8 offset:58368
    s_waitcnt lgkmcnt(9)
    v_mfma_f32_32x32x16_bf16 v[32:47], v[240:243], v[212:215], v[32:47]
    ds_read_b64_tr_b16 v[228:229], v9 offset:57344
    ds_read_b64_tr_b16 v[230:231], v9 offset:58368
    s_waitcnt lgkmcnt(9)
    v_mfma_f32_32x32x16_bf16 v[48:63], v[244:247], v[212:215], v[48:63]
    ds_read_b64_tr_b16 v[232:233], v10 offset:57344
    ds_read_b64_tr_b16 v[234:235], v10 offset:58368
    s_waitcnt lgkmcnt(9)
    v_mfma_f32_32x32x16_bf16 v[64:79], v[248:251], v[212:215], v[64:79]
    ds_read_b64_tr_b16 v[236:237], v11 offset:57344
    ds_read_b64_tr_b16 v[238:239], v11 offset:58368
    s_waitcnt lgkmcnt(9)
    v_mfma_f32_32x32x16_bf16 v[80:95], v[252:255], v[212:215], v[80:95]
    ds_read_b128 v[220:223], v31 offset:49152
    ds_read_b64_tr_b16 v[240:241], v8 offset:61440
    ds_read_b64_tr_b16 v[242:243], v8 offset:62464
    s_waitcnt lgkmcnt(9)
    v_mfma_f32_32x32x16_bf16 v[32:47], v[224:227], v[216:219], v[32:47]
    ds_read_b64_tr_b16 v[244:245], v9 offset:61440
    ds_read_b64_tr_b16 v[246:247], v9 offset:62464
    s_waitcnt lgkmcnt(9)
    v_mfma_f32_32x32x16_bf16 v[48:63], v[228:231], v[216:219], v[48:63]
    ds_read_b64_tr_b16 v[248:249], v10 offset:61440
    ds_read_b64_tr_b16 v[250:251], v10 offset:62464
    s_waitcnt lgkmcnt(9)
    v_mfma_f32_32x32x16_bf16 v[64:79], v[232:235], v[216:219], v[64:79]
    ds_read_b64_tr_b16 v[252:253], v11 offset:61440
    ds_read_b64_tr_b16 v[254:255], v11 offset:62464
    s_waitcnt lgkmcnt(9)
    v_mfma_f32_32x32x16_bf16 v[80:95], v[236:239], v[216:219], v[80:95]
    s_waitcnt lgkmcnt(6)
    v_mfma_f32_32x32x16_bf16 v[32:47], v[240:243], v[220:223], v[32:47]
    s_waitcnt lgkmcnt(4)
    v_mfma_f32_32x32x16_bf16 v[48:63], v[244:247], v[220:223], v[48:63]
    s_waitcnt lgkmcnt(2)
    v_mfma_f32_32x32x16_bf16 v[64:79], v[248:251], v[220:223], v[64:79]
    s_waitcnt lgkmcnt(0)
    v_mfma_f32_32x32x16_bf16 v[80:95], v[252:255], v[220:223], v[80:95]
    v_lshrrev_b32 v23, 4, v0
    v_and_b32 v24, 15, v0
    v_lshlrev_b32 v25, 2, v23
    v_xor_b32 v25, v24, v25
    v_lshlrev_b32 v25, 4, v25
    v_lshl_add_u32 v26, v23, 8, v25
    v_add_u32 v12, s29, v26
    v_xor_b32 v25, v24, v23
    v_lshlrev_b32 v25, 4, v25
    v_lshl_add_u32 v25, v23, 8, v25
    v_add_u32 v8, s29, v25
    v_xor_b32 v9, 64, v8
    v_xor_b32 v10, 128, v8
    v_xor_b32 v11, 192, v8
    v_mul_f32 v32, s33, v32
    v_mul_f32 v33, s33, v33
    v_mul_f32 v34, s33, v34
    v_mul_f32 v35, s33, v35
    v_mul_f32 v36, s33, v36
    v_mul_f32 v37, s33, v37
    v_mul_f32 v38, s33, v38
    v_mul_f32 v39, s33, v39
    v_mul_f32 v40, s33, v40
    v_mul_f32 v41, s33, v41
    v_mul_f32 v42, s33, v42
    v_mul_f32 v43, s33, v43
    v_mul_f32 v44, s33, v44
    v_mul_f32 v45, s33, v45
    v_mul_f32 v46, s33, v46
    v_mul_f32 v47, s33, v47
    v_cvt_pk_bf16_f32 v224, v32, v33
    v_cvt_pk_bf16_f32 v225, v34, v35
    v_cvt_pk_bf16_f32 v226, v36, v37
    v_cvt_pk_bf16_f32 v227, v38, v39
    v_cvt_pk_bf16_f32 v228, v40, v41
    v_cvt_pk_bf16_f32 v229, v42, v43
    v_cvt_pk_bf16_f32 v230, v44, v45
    v_cvt_pk_bf16_f32 v231, v46, v47
    ds_write_b128 v22, v[224:227] offset:0
    ds_write_b128 v22, v[228:231] offset:1024
    v_mul_f32 v48, s33, v48
    v_mul_f32 v49, s33, v49
    v_mul_f32 v50, s33, v50
    v_mul_f32 v51, s33, v51
    v_mul_f32 v52, s33, v52
    v_mul_f32 v53, s33, v53
    v_mul_f32 v54, s33, v54
    v_mul_f32 v55, s33, v55
    v_mul_f32 v56, s33, v56
    v_mul_f32 v57, s33, v57
    v_mul_f32 v58, s33, v58
    v_mul_f32 v59, s33, v59
    v_mul_f32 v60, s33, v60
    v_mul_f32 v61, s33, v61
    v_mul_f32 v62, s33, v62
    v_mul_f32 v63, s33, v63
    v_cvt_pk_bf16_f32 v232, v48, v49
    v_cvt_pk_bf16_f32 v233, v50, v51
    v_cvt_pk_bf16_f32 v234, v52, v53
    v_cvt_pk_bf16_f32 v235, v54, v55
    v_cvt_pk_bf16_f32 v236, v56, v57
    v_cvt_pk_bf16_f32 v237, v58, v59
    v_cvt_pk_bf16_f32 v238, v60, v61
    v_cvt_pk_bf16_f32 v239, v62, v63
    ds_write_b128 v22, v[232:235] offset:2048
    ds_write_b128 v22, v[236:239] offset:3072
    v_mul_f32 v64, s33, v64
    v_mul_f32 v65, s33, v65
    v_mul_f32 v66, s33, v66
    v_mul_f32 v67, s33, v67
    v_mul_f32 v68, s33, v68
    v_mul_f32 v69, s33, v69
    v_mul_f32 v70, s33, v70
    v_mul_f32 v71, s33, v71
    v_mul_f32 v72, s33, v72
    v_mul_f32 v73, s33, v73
    v_mul_f32 v74, s33, v74
    v_mul_f32 v75, s33, v75
    v_mul_f32 v76, s33, v76
    v_mul_f32 v77, s33, v77
    v_mul_f32 v78, s33, v78
    v_mul_f32 v79, s33, v79
    v_cvt_pk_bf16_f32 v240, v64, v65
    v_cvt_pk_bf16_f32 v241, v66, v67
    v_cvt_pk_bf16_f32 v242, v68, v69
    v_cvt_pk_bf16_f32 v243, v70, v71
    v_cvt_pk_bf16_f32 v244, v72, v73
    v_cvt_pk_bf16_f32 v245, v74, v75
    v_cvt_pk_bf16_f32 v246, v76, v77
    v_cvt_pk_bf16_f32 v247, v78, v79
    ds_write_b128 v22, v[240:243] offset:16384
    ds_write_b128 v22, v[244:247] offset:17408
    v_mul_f32 v80, s33, v80
    v_mul_f32 v81, s33, v81
    v_mul_f32 v82, s33, v82
    v_mul_f32 v83, s33, v83
    v_mul_f32 v84, s33, v84
    v_mul_f32 v85, s33, v85
    v_mul_f32 v86, s33, v86
    v_mul_f32 v87, s33, v87
    v_mul_f32 v88, s33, v88
    v_mul_f32 v89, s33, v89
    v_mul_f32 v90, s33, v90
    v_mul_f32 v91, s33, v91
    v_mul_f32 v92, s33, v92
    v_mul_f32 v93, s33, v93
    v_mul_f32 v94, s33, v94
    v_mul_f32 v95, s33, v95
    v_cvt_pk_bf16_f32 v248, v80, v81
    v_cvt_pk_bf16_f32 v249, v82, v83
    v_cvt_pk_bf16_f32 v250, v84, v85
    v_cvt_pk_bf16_f32 v251, v86, v87
    v_cvt_pk_bf16_f32 v252, v88, v89
    v_cvt_pk_bf16_f32 v253, v90, v91
    v_cvt_pk_bf16_f32 v254, v92, v93
    v_cvt_pk_bf16_f32 v255, v94, v95
    ds_write_b128 v22, v[248:251] offset:18432
    ds_write_b128 v22, v[252:255] offset:19456
    s_waitcnt lgkmcnt(0)
    s_barrier
    s_add_u32 m0, s29, 147456
    s_add_u32 s31, s3, 0
    s_and_b32 s31, s31, 7
    s_lshl_b32 s31, s31, 19
    s_add_u32 s30, s31, 0
    buffer_load_dwordx4 v2, s[12:15], s30 offen offset:0 lds
    s_add_u32 s30, s31, 31744
    buffer_load_dwordx4 v2, s[12:15], s30 offen offset:1024 lds
    s_add_u32 s30, s31, 63488
    buffer_load_dwordx4 v2, s[12:15], s30 offen offset:2048 lds
    s_add_u32 s30, s31, 95232
    buffer_load_dwordx4 v2, s[12:15], s30 offen offset:3072 lds
    s_add_u32 m0, s29, 81920
    s_add_u32 s30, s49, 32768
    s_and_b32 s30, s30, 114688
    s_add_u32 s30, s30, 131072
    buffer_load_dwordx4 v12, s[8:11], s30 offen offset:0 nt lds
    buffer_load_dwordx4 v12, s[8:11], s30 offen offset:1024 nt lds
    buffer_load_dwordx4 v12, s[8:11], s30 offen offset:2048 nt lds
    buffer_load_dwordx4 v12, s[8:11], s30 offen offset:3072 nt lds
    s_waitcnt vmcnt(4)
    s_barrier
    ds_read_b64_tr_b16 v[224:225], v4 offset:49152
    ds_read_b64_tr_b16 v[226:227], v4 offset:50176
    ds_read_b64_tr_b16 v[228:229], v5 offset:49152
    ds_read_b64_tr_b16 v[230:231], v5 offset:50176
    ds_read_b64_tr_b16 v[232:233], v6 offset:49152
    ds_read_b64_tr_b16 v[234:235], v6 offset:50176
    ds_read_b64_tr_b16 v[236:237], v7 offset:49152
    ds_read_b64_tr_b16 v[238:239], v7 offset:50176
    ds_read_b64_tr_b16 v[240:241], v4 offset:53248
    ds_read_b64_tr_b16 v[242:243], v4 offset:54272
    s_waitcnt lgkmcnt(8)
    v_mfma_f32_32x32x16_bf16 v[32:47], v[224:227], v[96:99], 0
    ds_read_b64_tr_b16 v[244:245], v5 offset:53248
    ds_read_b64_tr_b16 v[246:247], v5 offset:54272
    s_waitcnt lgkmcnt(8)
    v_mfma_f32_32x32x16_bf16 v[48:63], v[228:231], v[96:99], 0
    ds_read_b64_tr_b16 v[248:249], v6 offset:53248
    ds_read_b64_tr_b16 v[250:251], v6 offset:54272
    s_waitcnt lgkmcnt(8)
    v_mfma_f32_32x32x16_bf16 v[64:79], v[232:235], v[96:99], 0
    ds_read_b64_tr_b16 v[252:253], v7 offset:53248
    ds_read_b64_tr_b16 v[254:255], v7 offset:54272
    s_waitcnt lgkmcnt(8)
    v_mfma_f32_32x32x16_bf16 v[80:95], v[236:239], v[96:99], 0
    ds_read_b64_tr_b16 v[224:225], v4 offset:57344
    ds_read_b64_tr_b16 v[226:227], v4 offset:58368
    s_add_u32 m0, s29, 114688
    s_add_u32 s31, s3, 1
    s_and_b32 s31, s31, 7
    s_lshl_b32 s31, s31, 19
    s_add_u32 s30, s31, 0
    buffer_load_dwordx4 v2, s[12:15], s30 offen offset:0 lds
    s_waitcnt lgkmcnt(8)
    v_mfma_f32_32x32x16_bf16 v[32:47], v[240:243], v[100:103], v[32:47]
    ds_read_b64_tr_b16 v[228:229], v5 offset:57344
    ds_read_b64_tr_b16 v[230:231], v5 offset:58368
    s_add_u32 s30, s31, 31744
    buffer_load_dwordx4 v2, s[12:15], s30 offen offset:1024 lds
    s_waitcnt lgkmcnt(8)
    v_mfma_f32_32x32x16_bf16 v[48:63], v[244:247], v[100:103], v[48:63]
    ds_read_b64_tr_b16 v[232:233], v6 offset:57344
    ds_read_b64_tr_b16 v[234:235], v6 offset:58368
    s_add_u32 s30, s31, 63488
    buffer_load_dwordx4 v2, s[12:15], s30 offen offset:2048 lds
    s_waitcnt lgkmcnt(8)
    v_mfma_f32_32x32x16_bf16 v[64:79], v[248:251], v[100:103], v[64:79]
    ds_read_b64_tr_b16 v[236:237], v7 offset:57344
    ds_read_b64_tr_b16 v[238:239], v7 offset:58368
    s_add_u32 s30, s31, 95232
    buffer_load_dwordx4 v2, s[12:15], s30 offen offset:3072 lds
    s_waitcnt lgkmcnt(8)
    v_mfma_f32_32x32x16_bf16 v[80:95], v[252:255], v[100:103], v[80:95]
    ds_read_b64_tr_b16 v[240:241], v4 offset:61440
    ds_read_b64_tr_b16 v[242:243], v4 offset:62464
    s_add_u32 m0, s29, 0
    s_add_u32 s30, s49, 65536
    s_and_b32 s30, s30, 114688
    s_add_u32 s30, s30, 131072
    buffer_load_dwordx4 v8, s[4:7], s30 offen offset:0 nt lds
    s_waitcnt lgkmcnt(8)
    v_mfma_f32_32x32x16_bf16 v[32:47], v[224:227], v[104:107], v[32:47]
    ds_read_b64_tr_b16 v[244:245], v5 offset:61440
    ds_read_b64_tr_b16 v[246:247], v5 offset:62464
    buffer_load_dwordx4 v9, s[4:7], s30 offen offset:1024 nt lds
    s_waitcnt lgkmcnt(8)
    v_mfma_f32_32x32x16_bf16 v[48:63], v[228:231], v[104:107], v[48:63]
    ds_read_b64_tr_b16 v[248:249], v6 offset:61440
    ds_read_b64_tr_b16 v[250:251], v6 offset:62464
    buffer_load_dwordx4 v10, s[4:7], s30 offen offset:2048 nt lds
    s_waitcnt lgkmcnt(8)
    v_mfma_f32_32x32x16_bf16 v[64:79], v[232:235], v[104:107], v[64:79]
    ds_read_b64_tr_b16 v[252:253], v7 offset:61440
    ds_read_b64_tr_b16 v[254:255], v7 offset:62464
    buffer_load_dwordx4 v11, s[4:7], s30 offen offset:3072 nt lds
    s_waitcnt lgkmcnt(8)
    v_mfma_f32_32x32x16_bf16 v[80:95], v[236:239], v[104:107], v[80:95]
    s_add_u32 m0, s29, 131072
    s_add_u32 s31, s3, 2
    s_and_b32 s31, s31, 7
    s_lshl_b32 s31, s31, 19
    s_add_u32 s30, s31, 0
    buffer_load_dwordx4 v2, s[12:15], s30 offen offset:0 lds
    s_waitcnt lgkmcnt(6)
    v_mfma_f32_32x32x16_bf16 v[32:47], v[240:243], v[108:111], v[32:47]
    s_add_u32 s30, s31, 31744
    buffer_load_dwordx4 v2, s[12:15], s30 offen offset:1024 lds
    s_waitcnt lgkmcnt(4)
    v_mfma_f32_32x32x16_bf16 v[48:63], v[244:247], v[108:111], v[48:63]
    s_add_u32 s30, s31, 63488
    buffer_load_dwordx4 v2, s[12:15], s30 offen offset:2048 lds
    s_waitcnt lgkmcnt(2)
    v_mfma_f32_32x32x16_bf16 v[64:79], v[248:251], v[108:111], v[64:79]
    s_add_u32 s30, s31, 95232
    buffer_load_dwordx4 v2, s[12:15], s30 offen offset:3072 lds
    s_waitcnt lgkmcnt(0)
    v_mfma_f32_32x32x16_bf16 v[80:95], v[252:255], v[108:111], v[80:95]
    s_waitcnt vmcnt(8)
    s_barrier
    ds_read_b64_tr_b16 v[224:225], v4 offset:16384
    ds_read_b64_tr_b16 v[226:227], v4 offset:17408
    ds_read_b64_tr_b16 v[228:229], v5 offset:16384
    ds_read_b64_tr_b16 v[230:231], v5 offset:17408
    ds_read_b64_tr_b16 v[232:233], v6 offset:16384
    ds_read_b64_tr_b16 v[234:235], v6 offset:17408
    ds_read_b64_tr_b16 v[236:237], v7 offset:16384
    ds_read_b64_tr_b16 v[238:239], v7 offset:17408
    ds_read_b64_tr_b16 v[240:241], v4 offset:20480
    ds_read_b64_tr_b16 v[242:243], v4 offset:21504
    s_waitcnt lgkmcnt(8)
    v_mfma_f32_32x32x16_bf16 v[32:47], v[224:227], v[112:115], v[32:47]
    ds_read_b64_tr_b16 v[244:245], v5 offset:20480
    ds_read_b64_tr_b16 v[246:247], v5 offset:21504
    s_waitcnt lgkmcnt(8)
    v_mfma_f32_32x32x16_bf16 v[48:63], v[228:231], v[112:115], v[48:63]
    ds_read_b64_tr_b16 v[248:249], v6 offset:20480
    ds_read_b64_tr_b16 v[250:251], v6 offset:21504
    s_waitcnt lgkmcnt(8)
    v_mfma_f32_32x32x16_bf16 v[64:79], v[232:235], v[112:115], v[64:79]
    ds_read_b64_tr_b16 v[252:253], v7 offset:20480
    ds_read_b64_tr_b16 v[254:255], v7 offset:21504
    s_waitcnt lgkmcnt(8)
    v_mfma_f32_32x32x16_bf16 v[80:95], v[236:239], v[112:115], v[80:95]
    ds_read_b64_tr_b16 v[224:225], v4 offset:24576
    ds_read_b64_tr_b16 v[226:227], v4 offset:25600
    s_add_u32 m0, s29, 16384
    s_add_u32 s30, s49, 49152
    s_and_b32 s30, s30, 114688
    s_add_u32 s30, s30, 131072
    buffer_load_dwordx4 v12, s[8:11], s30 offen offset:0 nt lds
    s_waitcnt lgkmcnt(8)
    v_mfma_f32_32x32x16_bf16 v[32:47], v[240:243], v[116:119], v[32:47]
    ds_read_b64_tr_b16 v[228:229], v5 offset:24576
    ds_read_b64_tr_b16 v[230:231], v5 offset:25600
    buffer_load_dwordx4 v12, s[8:11], s30 offen offset:1024 nt lds
    s_waitcnt lgkmcnt(8)
    v_mfma_f32_32x32x16_bf16 v[48:63], v[244:247], v[116:119], v[48:63]
    ds_read_b64_tr_b16 v[232:233], v6 offset:24576
    ds_read_b64_tr_b16 v[234:235], v6 offset:25600
    buffer_load_dwordx4 v12, s[8:11], s30 offen offset:2048 nt lds
    s_waitcnt lgkmcnt(8)
    v_mfma_f32_32x32x16_bf16 v[64:79], v[248:251], v[116:119], v[64:79]
    ds_read_b64_tr_b16 v[236:237], v7 offset:24576
    ds_read_b64_tr_b16 v[238:239], v7 offset:25600
    buffer_load_dwordx4 v12, s[8:11], s30 offen offset:3072 nt lds
    s_waitcnt lgkmcnt(8)
    v_mfma_f32_32x32x16_bf16 v[80:95], v[252:255], v[116:119], v[80:95]
    ds_read_b64_tr_b16 v[240:241], v4 offset:28672
    ds_read_b64_tr_b16 v[242:243], v4 offset:29696
    s_add_u32 m0, s29, 32768
    s_add_u32 s30, s49, 81920
    s_and_b32 s30, s30, 114688
    s_add_u32 s30, s30, 131072
    buffer_load_dwordx4 v8, s[4:7], s30 offen offset:0 nt lds
    s_waitcnt lgkmcnt(8)
    v_mfma_f32_32x32x16_bf16 v[32:47], v[224:227], v[120:123], v[32:47]
    ds_read_b64_tr_b16 v[244:245], v5 offset:28672
    ds_read_b64_tr_b16 v[246:247], v5 offset:29696
    buffer_load_dwordx4 v9, s[4:7], s30 offen offset:1024 nt lds
    s_waitcnt lgkmcnt(8)
    v_mfma_f32_32x32x16_bf16 v[48:63], v[228:231], v[120:123], v[48:63]
    ds_read_b64_tr_b16 v[248:249], v6 offset:28672
    ds_read_b64_tr_b16 v[250:251], v6 offset:29696
    buffer_load_dwordx4 v10, s[4:7], s30 offen offset:2048 nt lds
    s_waitcnt lgkmcnt(8)
    v_mfma_f32_32x32x16_bf16 v[64:79], v[232:235], v[120:123], v[64:79]
    ds_read_b64_tr_b16 v[252:253], v7 offset:28672
    ds_read_b64_tr_b16 v[254:255], v7 offset:29696
    buffer_load_dwordx4 v11, s[4:7], s30 offen offset:3072 nt lds
    s_waitcnt lgkmcnt(8)
    v_mfma_f32_32x32x16_bf16 v[80:95], v[236:239], v[120:123], v[80:95]
    s_add_u32 m0, s29, 147456
    s_add_u32 s31, s3, 3
    s_and_b32 s31, s31, 7
    s_lshl_b32 s31, s31, 19
    s_add_u32 s30, s31, 0
    buffer_load_dwordx4 v2, s[12:15], s30 offen offset:0 lds
    s_waitcnt lgkmcnt(6)
    v_mfma_f32_32x32x16_bf16 v[32:47], v[240:243], v[124:127], v[32:47]
    s_add_u32 s30, s31, 31744
    buffer_load_dwordx4 v2, s[12:15], s30 offen offset:1024 lds
    s_waitcnt lgkmcnt(4)
    v_mfma_f32_32x32x16_bf16 v[48:63], v[244:247], v[124:127], v[48:63]
    s_add_u32 s30, s31, 63488
    buffer_load_dwordx4 v2, s[12:15], s30 offen offset:2048 lds
    s_waitcnt lgkmcnt(2)
    v_mfma_f32_32x32x16_bf16 v[64:79], v[248:251], v[124:127], v[64:79]
    s_add_u32 s30, s31, 95232
    buffer_load_dwordx4 v2, s[12:15], s30 offen offset:3072 lds
    s_waitcnt lgkmcnt(0)
    v_mfma_f32_32x32x16_bf16 v[80:95], v[252:255], v[124:127], v[80:95]
    s_waitcnt vmcnt(12)
    s_barrier
    ds_read_b64_tr_b16 v[224:225], v4 offset:32768
    ds_read_b64_tr_b16 v[226:227], v4 offset:33792
    ds_read_b64_tr_b16 v[228:229], v5 offset:32768
    ds_read_b64_tr_b16 v[230:231], v5 offset:33792
    ds_read_b64_tr_b16 v[232:233], v6 offset:32768
    ds_read_b64_tr_b16 v[234:235], v6 offset:33792
    ds_read_b64_tr_b16 v[236:237], v7 offset:32768
    ds_read_b64_tr_b16 v[238:239], v7 offset:33792
    ds_read_b64_tr_b16 v[240:241], v4 offset:36864
    ds_read_b64_tr_b16 v[242:243], v4 offset:37888
    s_waitcnt lgkmcnt(8)
    v_mfma_f32_32x32x16_bf16 v[32:47], v[224:227], v[128:131], v[32:47]
    ds_read_b64_tr_b16 v[244:245], v5 offset:36864
    ds_read_b64_tr_b16 v[246:247], v5 offset:37888
    s_waitcnt lgkmcnt(8)
    v_mfma_f32_32x32x16_bf16 v[48:63], v[228:231], v[128:131], v[48:63]
    ds_read_b64_tr_b16 v[248:249], v6 offset:36864
    ds_read_b64_tr_b16 v[250:251], v6 offset:37888
    s_waitcnt lgkmcnt(8)
    v_mfma_f32_32x32x16_bf16 v[64:79], v[232:235], v[128:131], v[64:79]
    ds_read_b64_tr_b16 v[252:253], v7 offset:36864
    ds_read_b64_tr_b16 v[254:255], v7 offset:37888
    s_waitcnt lgkmcnt(8)
    v_mfma_f32_32x32x16_bf16 v[80:95], v[236:239], v[128:131], v[80:95]
    ds_read_b64_tr_b16 v[224:225], v4 offset:40960
    ds_read_b64_tr_b16 v[226:227], v4 offset:41984
    s_add_u32 m0, s29, 49152
    s_add_u32 s30, s49, 65536
    s_and_b32 s30, s30, 114688
    s_add_u32 s30, s30, 131072
    buffer_load_dwordx4 v12, s[8:11], s30 offen offset:0 nt lds
    s_waitcnt lgkmcnt(8)
    v_mfma_f32_32x32x16_bf16 v[32:47], v[240:243], v[132:135], v[32:47]
    ds_read_b64_tr_b16 v[228:229], v5 offset:40960
    ds_read_b64_tr_b16 v[230:231], v5 offset:41984
    buffer_load_dwordx4 v12, s[8:11], s30 offen offset:1024 nt lds
    s_waitcnt lgkmcnt(8)
    v_mfma_f32_32x32x16_bf16 v[48:63], v[244:247], v[132:135], v[48:63]
    ds_read_b64_tr_b16 v[232:233], v6 offset:40960
    ds_read_b64_tr_b16 v[234:235], v6 offset:41984
    buffer_load_dwordx4 v12, s[8:11], s30 offen offset:2048 nt lds
    s_waitcnt lgkmcnt(8)
    v_mfma_f32_32x32x16_bf16 v[64:79], v[248:251], v[132:135], v[64:79]
    ds_read_b64_tr_b16 v[236:237], v7 offset:40960
    ds_read_b64_tr_b16 v[238:239], v7 offset:41984
    buffer_load_dwordx4 v12, s[8:11], s30 offen offset:3072 nt lds
    s_waitcnt lgkmcnt(8)
    v_mfma_f32_32x32x16_bf16 v[80:95], v[252:255], v[132:135], v[80:95]
    ds_read_b64_tr_b16 v[240:241], v4 offset:45056
    ds_read_b64_tr_b16 v[242:243], v4 offset:46080
    s_add_u32 m0, s29, 98304
    s_add_u32 s30, s49, 98304
    s_and_b32 s30, s30, 114688
    s_add_u32 s30, s30, 131072
    buffer_load_dwordx4 v8, s[4:7], s30 offen offset:0 nt lds
    s_waitcnt lgkmcnt(8)
    v_mfma_f32_32x32x16_bf16 v[32:47], v[224:227], v[136:139], v[32:47]
    ds_read_b64_tr_b16 v[244:245], v5 offset:45056
    ds_read_b64_tr_b16 v[246:247], v5 offset:46080
    buffer_load_dwordx4 v9, s[4:7], s30 offen offset:1024 nt lds
    s_waitcnt lgkmcnt(8)
    v_mfma_f32_32x32x16_bf16 v[48:63], v[228:231], v[136:139], v[48:63]
    ds_read_b64_tr_b16 v[248:249], v6 offset:45056
    ds_read_b64_tr_b16 v[250:251], v6 offset:46080
    buffer_load_dwordx4 v10, s[4:7], s30 offen offset:2048 nt lds
    s_waitcnt lgkmcnt(8)
    v_mfma_f32_32x32x16_bf16 v[64:79], v[232:235], v[136:139], v[64:79]
    ds_read_b64_tr_b16 v[252:253], v7 offset:45056
    ds_read_b64_tr_b16 v[254:255], v7 offset:46080
    buffer_load_dwordx4 v11, s[4:7], s30 offen offset:3072 nt lds
    s_waitcnt lgkmcnt(8)
    v_mfma_f32_32x32x16_bf16 v[80:95], v[236:239], v[136:139], v[80:95]
    s_add_u32 m0, s29, 114688
    s_add_u32 s31, s3, 4
    s_and_b32 s31, s31, 7
    s_lshl_b32 s31, s31, 19
    s_add_u32 s30, s31, 0
    buffer_load_dwordx4 v2, s[12:15], s30 offen offset:0 lds
    s_waitcnt lgkmcnt(6)
    v_mfma_f32_32x32x16_bf16 v[32:47], v[240:243], v[140:143], v[32:47]
    s_add_u32 s30, s31, 31744
    buffer_load_dwordx4 v2, s[12:15], s30 offen offset:1024 lds
    s_waitcnt lgkmcnt(4)
    v_mfma_f32_32x32x16_bf16 v[48:63], v[244:247], v[140:143], v[48:63]
    s_add_u32 s30, s31, 63488
    buffer_load_dwordx4 v2, s[12:15], s30 offen offset:2048 lds
    s_waitcnt lgkmcnt(2)
    v_mfma_f32_32x32x16_bf16 v[64:79], v[248:251], v[140:143], v[64:79]
    s_add_u32 s30, s31, 95232
    buffer_load_dwordx4 v2, s[12:15], s30 offen offset:3072 lds
    s_waitcnt lgkmcnt(0)
    v_mfma_f32_32x32x16_bf16 v[80:95], v[252:255], v[140:143], v[80:95]
    s_waitcnt vmcnt(12)
    s_barrier
    ds_read_b64_tr_b16 v[224:225], v4 offset:49152
    ds_read_b64_tr_b16 v[226:227], v4 offset:50176
    ds_read_b64_tr_b16 v[228:229], v5 offset:49152
    ds_read_b64_tr_b16 v[230:231], v5 offset:50176
    ds_read_b64_tr_b16 v[232:233], v6 offset:49152
    ds_read_b64_tr_b16 v[234:235], v6 offset:50176
    ds_read_b64_tr_b16 v[236:237], v7 offset:49152
    ds_read_b64_tr_b16 v[238:239], v7 offset:50176
    ds_read_b64_tr_b16 v[240:241], v4 offset:53248
    ds_read_b64_tr_b16 v[242:243], v4 offset:54272
    s_waitcnt lgkmcnt(8)
    v_mfma_f32_32x32x16_bf16 v[32:47], v[224:227], v[144:147], v[32:47]
    ds_read_b64_tr_b16 v[244:245], v5 offset:53248
    ds_read_b64_tr_b16 v[246:247], v5 offset:54272
    s_waitcnt lgkmcnt(8)
    v_mfma_f32_32x32x16_bf16 v[48:63], v[228:231], v[144:147], v[48:63]
    ds_read_b64_tr_b16 v[248:249], v6 offset:53248
    ds_read_b64_tr_b16 v[250:251], v6 offset:54272
    s_waitcnt lgkmcnt(8)
    v_mfma_f32_32x32x16_bf16 v[64:79], v[232:235], v[144:147], v[64:79]
    ds_read_b64_tr_b16 v[252:253], v7 offset:53248
    ds_read_b64_tr_b16 v[254:255], v7 offset:54272
    s_waitcnt lgkmcnt(8)
    v_mfma_f32_32x32x16_bf16 v[80:95], v[236:239], v[144:147], v[80:95]
    ds_read_b64_tr_b16 v[224:225], v4 offset:57344
    ds_read_b64_tr_b16 v[226:227], v4 offset:58368
    s_add_u32 m0, s29, 65536
    s_add_u32 s30, s49, 81920
    s_and_b32 s30, s30, 114688
    s_add_u32 s30, s30, 131072
    buffer_load_dwordx4 v12, s[8:11], s30 offen offset:0 nt lds
    s_waitcnt lgkmcnt(8)
    v_mfma_f32_32x32x16_bf16 v[32:47], v[240:243], v[148:151], v[32:47]
    ds_read_b64_tr_b16 v[228:229], v5 offset:57344
    ds_read_b64_tr_b16 v[230:231], v5 offset:58368
    buffer_load_dwordx4 v12, s[8:11], s30 offen offset:1024 nt lds
    s_waitcnt lgkmcnt(8)
    v_mfma_f32_32x32x16_bf16 v[48:63], v[244:247], v[148:151], v[48:63]
    ds_read_b64_tr_b16 v[232:233], v6 offset:57344
    ds_read_b64_tr_b16 v[234:235], v6 offset:58368
    buffer_load_dwordx4 v12, s[8:11], s30 offen offset:2048 nt lds
    s_waitcnt lgkmcnt(8)
    v_mfma_f32_32x32x16_bf16 v[64:79], v[248:251], v[148:151], v[64:79]
    ds_read_b64_tr_b16 v[236:237], v7 offset:57344
    ds_read_b64_tr_b16 v[238:239], v7 offset:58368
    buffer_load_dwordx4 v12, s[8:11], s30 offen offset:3072 nt lds
    s_waitcnt lgkmcnt(8)
    v_mfma_f32_32x32x16_bf16 v[80:95], v[252:255], v[148:151], v[80:95]
    ds_read_b64_tr_b16 v[240:241], v4 offset:61440
    ds_read_b64_tr_b16 v[242:243], v4 offset:62464
    s_add_u32 m0, s29, 81920
    s_add_u32 s30, s49, 114688
    s_and_b32 s30, s30, 114688
    s_add_u32 s30, s30, 131072
    buffer_load_dwordx4 v8, s[4:7], s30 offen offset:0 nt lds
    s_waitcnt lgkmcnt(8)
    v_mfma_f32_32x32x16_bf16 v[32:47], v[224:227], v[152:155], v[32:47]
    ds_read_b64_tr_b16 v[244:245], v5 offset:61440
    ds_read_b64_tr_b16 v[246:247], v5 offset:62464
    buffer_load_dwordx4 v9, s[4:7], s30 offen offset:1024 nt lds
    s_waitcnt lgkmcnt(8)
    v_mfma_f32_32x32x16_bf16 v[48:63], v[228:231], v[152:155], v[48:63]
    ds_read_b64_tr_b16 v[248:249], v6 offset:61440
    ds_read_b64_tr_b16 v[250:251], v6 offset:62464
    buffer_load_dwordx4 v10, s[4:7], s30 offen offset:2048 nt lds
    s_waitcnt lgkmcnt(8)
    v_mfma_f32_32x32x16_bf16 v[64:79], v[232:235], v[152:155], v[64:79]
    ds_read_b64_tr_b16 v[252:253], v7 offset:61440
    ds_read_b64_tr_b16 v[254:255], v7 offset:62464
    buffer_load_dwordx4 v11, s[4:7], s30 offen offset:3072 nt lds
    s_waitcnt lgkmcnt(8)
    v_mfma_f32_32x32x16_bf16 v[80:95], v[236:239], v[152:155], v[80:95]
    s_add_u32 m0, s29, 131072
    s_add_u32 s31, s3, 5
    s_and_b32 s31, s31, 7
    s_lshl_b32 s31, s31, 19
    s_add_u32 s30, s31, 0
    buffer_load_dwordx4 v2, s[12:15], s30 offen offset:0 lds
    s_waitcnt lgkmcnt(6)
    v_mfma_f32_32x32x16_bf16 v[32:47], v[240:243], v[156:159], v[32:47]
    s_add_u32 s30, s31, 31744
    buffer_load_dwordx4 v2, s[12:15], s30 offen offset:1024 lds
    s_waitcnt lgkmcnt(4)
    v_mfma_f32_32x32x16_bf16 v[48:63], v[244:247], v[156:159], v[48:63]
    s_add_u32 s30, s31, 63488
    buffer_load_dwordx4 v2, s[12:15], s30 offen offset:2048 lds
    s_waitcnt lgkmcnt(2)
    v_mfma_f32_32x32x16_bf16 v[64:79], v[248:251], v[156:159], v[64:79]
    s_add_u32 s30, s31, 95232
    buffer_load_dwordx4 v2, s[12:15], s30 offen offset:3072 lds
    s_waitcnt lgkmcnt(0)
    v_mfma_f32_32x32x16_bf16 v[80:95], v[252:255], v[156:159], v[80:95]
    s_waitcnt vmcnt(12)
    s_barrier
    ds_read_b64_tr_b16 v[224:225], v4 offset:16384
    ds_read_b64_tr_b16 v[226:227], v4 offset:17408
    ds_read_b64_tr_b16 v[228:229], v5 offset:16384
    ds_read_b64_tr_b16 v[230:231], v5 offset:17408
    ds_read_b64_tr_b16 v[232:233], v6 offset:16384
    ds_read_b64_tr_b16 v[234:235], v6 offset:17408
    ds_read_b64_tr_b16 v[236:237], v7 offset:16384
    ds_read_b64_tr_b16 v[238:239], v7 offset:17408
    ds_read_b64_tr_b16 v[240:241], v4 offset:20480
    ds_read_b64_tr_b16 v[242:243], v4 offset:21504
    s_waitcnt lgkmcnt(8)
    v_mfma_f32_32x32x16_bf16 v[32:47], v[224:227], v[160:163], v[32:47]
    ds_read_b64_tr_b16 v[244:245], v5 offset:20480
    ds_read_b64_tr_b16 v[246:247], v5 offset:21504
    s_waitcnt lgkmcnt(8)
    v_mfma_f32_32x32x16_bf16 v[48:63], v[228:231], v[160:163], v[48:63]
    ds_read_b64_tr_b16 v[248:249], v6 offset:20480
    ds_read_b64_tr_b16 v[250:251], v6 offset:21504
    s_waitcnt lgkmcnt(8)
    v_mfma_f32_32x32x16_bf16 v[64:79], v[232:235], v[160:163], v[64:79]
    ds_read_b64_tr_b16 v[252:253], v7 offset:20480
    ds_read_b64_tr_b16 v[254:255], v7 offset:21504
    s_waitcnt lgkmcnt(8)
    v_mfma_f32_32x32x16_bf16 v[80:95], v[236:239], v[160:163], v[80:95]
    ds_read_b64_tr_b16 v[224:225], v4 offset:24576
    ds_read_b64_tr_b16 v[226:227], v4 offset:25600
    s_add_u32 m0, s29, 0
    s_add_u32 s30, s49, 98304
    s_and_b32 s30, s30, 114688
    s_add_u32 s30, s30, 131072
    buffer_load_dwordx4 v12, s[8:11], s30 offen offset:0 nt lds
    s_waitcnt lgkmcnt(8)
    v_mfma_f32_32x32x16_bf16 v[32:47], v[240:243], v[164:167], v[32:47]
    ds_read_b64_tr_b16 v[228:229], v5 offset:24576
    ds_read_b64_tr_b16 v[230:231], v5 offset:25600
    buffer_load_dwordx4 v12, s[8:11], s30 offen offset:1024 nt lds
    s_waitcnt lgkmcnt(8)
    v_mfma_f32_32x32x16_bf16 v[48:63], v[244:247], v[164:167], v[48:63]
    ds_read_b64_tr_b16 v[232:233], v6 offset:24576
    ds_read_b64_tr_b16 v[234:235], v6 offset:25600
    buffer_load_dwordx4 v12, s[8:11], s30 offen offset:2048 nt lds
    s_waitcnt lgkmcnt(8)
    v_mfma_f32_32x32x16_bf16 v[64:79], v[248:251], v[164:167], v[64:79]
    ds_read_b64_tr_b16 v[236:237], v7 offset:24576
    ds_read_b64_tr_b16 v[238:239], v7 offset:25600
    buffer_load_dwordx4 v12, s[8:11], s30 offen offset:3072 nt lds
    s_waitcnt lgkmcnt(8)
    v_mfma_f32_32x32x16_bf16 v[80:95], v[252:255], v[164:167], v[80:95]
    ds_read_b64_tr_b16 v[240:241], v4 offset:28672
    ds_read_b64_tr_b16 v[242:243], v4 offset:29696
    s_add_u32 m0, s29, 16384
    s_add_u32 s30, s49, 114688
    s_and_b32 s30, s30, 114688
    s_add_u32 s30, s30, 131072
    buffer_load_dwordx4 v12, s[8:11], s30 offen offset:0 nt lds
    s_waitcnt lgkmcnt(8)
    v_mfma_f32_32x32x16_bf16 v[32:47], v[224:227], v[168:171], v[32:47]
    ds_read_b64_tr_b16 v[244:245], v5 offset:28672
    ds_read_b64_tr_b16 v[246:247], v5 offset:29696
    buffer_load_dwordx4 v12, s[8:11], s30 offen offset:1024 nt lds
    s_waitcnt lgkmcnt(8)
    v_mfma_f32_32x32x16_bf16 v[48:63], v[228:231], v[168:171], v[48:63]
    ds_read_b64_tr_b16 v[248:249], v6 offset:28672
    ds_read_b64_tr_b16 v[250:251], v6 offset:29696
    buffer_load_dwordx4 v12, s[8:11], s30 offen offset:2048 nt lds
    s_waitcnt lgkmcnt(8)
    v_mfma_f32_32x32x16_bf16 v[64:79], v[232:235], v[168:171], v[64:79]
    ds_read_b64_tr_b16 v[252:253], v7 offset:28672
    ds_read_b64_tr_b16 v[254:255], v7 offset:29696
    buffer_load_dwordx4 v12, s[8:11], s30 offen offset:3072 nt lds
    s_waitcnt lgkmcnt(8)
    v_mfma_f32_32x32x16_bf16 v[80:95], v[236:239], v[168:171], v[80:95]
    s_add_u32 m0, s29, 147456
    s_add_u32 s31, s3, 6
    s_and_b32 s31, s31, 7
    s_lshl_b32 s31, s31, 19
    s_add_u32 s30, s31, 0
    buffer_load_dwordx4 v2, s[12:15], s30 offen offset:0 lds
    s_waitcnt lgkmcnt(6)
    v_mfma_f32_32x32x16_bf16 v[32:47], v[240:243], v[172:175], v[32:47]
    s_add_u32 s30, s31, 31744
    buffer_load_dwordx4 v2, s[12:15], s30 offen offset:1024 lds
    s_waitcnt lgkmcnt(4)
    v_mfma_f32_32x32x16_bf16 v[48:63], v[244:247], v[172:175], v[48:63]
    s_add_u32 s30, s31, 63488
    buffer_load_dwordx4 v2, s[12:15], s30 offen offset:2048 lds
    s_waitcnt lgkmcnt(2)
    v_mfma_f32_32x32x16_bf16 v[64:79], v[248:251], v[172:175], v[64:79]
    s_add_u32 s30, s31, 95232
    buffer_load_dwordx4 v2, s[12:15], s30 offen offset:3072 lds
    s_waitcnt lgkmcnt(0)
    v_mfma_f32_32x32x16_bf16 v[80:95], v[252:255], v[172:175], v[80:95]
    s_waitcnt vmcnt(12)
    s_barrier
    ds_read_b64_tr_b16 v[224:225], v4 offset:32768
    ds_read_b64_tr_b16 v[226:227], v4 offset:33792
    ds_read_b64_tr_b16 v[228:229], v5 offset:32768
    ds_read_b64_tr_b16 v[230:231], v5 offset:33792
    ds_read_b64_tr_b16 v[232:233], v6 offset:32768
    ds_read_b64_tr_b16 v[234:235], v6 offset:33792
    ds_read_b64_tr_b16 v[236:237], v7 offset:32768
    ds_read_b64_tr_b16 v[238:239], v7 offset:33792
    ds_read_b64_tr_b16 v[240:241], v4 offset:36864
    ds_read_b64_tr_b16 v[242:243], v4 offset:37888
    s_waitcnt lgkmcnt(8)
    v_mfma_f32_32x32x16_bf16 v[32:47], v[224:227], v[176:179], v[32:47]
    ds_read_b64_tr_b16 v[244:245], v5 offset:36864
    ds_read_b64_tr_b16 v[246:247], v5 offset:37888
    s_waitcnt lgkmcnt(8)
    v_mfma_f32_32x32x16_bf16 v[48:63], v[228:231], v[176:179], v[48:63]
    ds_read_b64_tr_b16 v[248:249], v6 offset:36864
    ds_read_b64_tr_b16 v[250:251], v6 offset:37888
    s_waitcnt lgkmcnt(8)
    v_mfma_f32_32x32x16_bf16 v[64:79], v[232:235], v[176:179], v[64:79]
    ds_read_b64_tr_b16 v[252:253], v7 offset:36864
    ds_read_b64_tr_b16 v[254:255], v7 offset:37888
    s_waitcnt lgkmcnt(8)
    v_mfma_f32_32x32x16_bf16 v[80:95], v[236:239], v[176:179], v[80:95]
    ds_read_b64_tr_b16 v[224:225], v4 offset:40960
    ds_read_b64_tr_b16 v[226:227], v4 offset:41984
    s_add_u32 m0, s29, 32768
    s_add_u32 s30, s49, 0
    s_and_b32 s30, s30, 114688
    buffer_load_dwordx4 v8, s[4:7], s30 offen offset:0 nt lds
    s_waitcnt lgkmcnt(8)
    v_mfma_f32_32x32x16_bf16 v[32:47], v[240:243], v[180:183], v[32:47]
    ds_read_b64_tr_b16 v[228:229], v5 offset:40960
    ds_read_b64_tr_b16 v[230:231], v5 offset:41984
    buffer_load_dwordx4 v9, s[4:7], s30 offen offset:1024 nt lds
    s_waitcnt lgkmcnt(8)
    v_mfma_f32_32x32x16_bf16 v[48:63], v[244:247], v[180:183], v[48:63]
    ds_read_b64_tr_b16 v[232:233], v6 offset:40960
    ds_read_b64_tr_b16 v[234:235], v6 offset:41984
    buffer_load_dwordx4 v10, s[4:7], s30 offen offset:2048 nt lds
    s_waitcnt lgkmcnt(8)
    v_mfma_f32_32x32x16_bf16 v[64:79], v[248:251], v[180:183], v[64:79]
    ds_read_b64_tr_b16 v[236:237], v7 offset:40960
    ds_read_b64_tr_b16 v[238:239], v7 offset:41984
    buffer_load_dwordx4 v11, s[4:7], s30 offen offset:3072 nt lds
    s_waitcnt lgkmcnt(8)
    v_mfma_f32_32x32x16_bf16 v[80:95], v[252:255], v[180:183], v[80:95]
    ds_read_b64_tr_b16 v[240:241], v4 offset:45056
    ds_read_b64_tr_b16 v[242:243], v4 offset:46080
    s_add_u32 m0, s29, 49152
    s_add_u32 s30, s49, 16384
    s_and_b32 s30, s30, 114688
    buffer_load_dwordx4 v8, s[4:7], s30 offen offset:0 nt lds
    s_waitcnt lgkmcnt(8)
    v_mfma_f32_32x32x16_bf16 v[32:47], v[224:227], v[184:187], v[32:47]
    ds_read_b64_tr_b16 v[244:245], v5 offset:45056
    ds_read_b64_tr_b16 v[246:247], v5 offset:46080
    buffer_load_dwordx4 v9, s[4:7], s30 offen offset:1024 nt lds
    s_waitcnt lgkmcnt(8)
    v_mfma_f32_32x32x16_bf16 v[48:63], v[228:231], v[184:187], v[48:63]
    ds_read_b64_tr_b16 v[248:249], v6 offset:45056
    ds_read_b64_tr_b16 v[250:251], v6 offset:46080
    buffer_load_dwordx4 v10, s[4:7], s30 offen offset:2048 nt lds
    s_waitcnt lgkmcnt(8)
    v_mfma_f32_32x32x16_bf16 v[64:79], v[232:235], v[184:187], v[64:79]
    ds_read_b64_tr_b16 v[252:253], v7 offset:45056
    ds_read_b64_tr_b16 v[254:255], v7 offset:46080
    buffer_load_dwordx4 v11, s[4:7], s30 offen offset:3072 nt lds
    s_waitcnt lgkmcnt(8)
    v_mfma_f32_32x32x16_bf16 v[80:95], v[236:239], v[184:187], v[80:95]
    s_add_u32 m0, s29, 114688
    s_add_u32 s31, s3, 7
    s_and_b32 s31, s31, 7
    s_lshl_b32 s31, s31, 19
    s_add_u32 s30, s31, 0
    buffer_load_dwordx4 v2, s[12:15], s30 offen offset:0 lds
    s_waitcnt lgkmcnt(6)
    v_mfma_f32_32x32x16_bf16 v[32:47], v[240:243], v[188:191], v[32:47]
    s_add_u32 s30, s31, 31744
    buffer_load_dwordx4 v2, s[12:15], s30 offen offset:1024 lds
    s_waitcnt lgkmcnt(4)
    v_mfma_f32_32x32x16_bf16 v[48:63], v[244:247], v[188:191], v[48:63]
    s_add_u32 s30, s31, 63488
    buffer_load_dwordx4 v2, s[12:15], s30 offen offset:2048 lds
    s_waitcnt lgkmcnt(2)
    v_mfma_f32_32x32x16_bf16 v[64:79], v[248:251], v[188:191], v[64:79]
    s_add_u32 s30, s31, 95232
    buffer_load_dwordx4 v2, s[12:15], s30 offen offset:3072 lds
    s_waitcnt lgkmcnt(0)
    v_mfma_f32_32x32x16_bf16 v[80:95], v[252:255], v[188:191], v[80:95]
    s_waitcnt vmcnt(12)
    s_barrier
    ds_read_b64_tr_b16 v[224:225], v4 offset:49152
    ds_read_b64_tr_b16 v[226:227], v4 offset:50176
    ds_read_b64_tr_b16 v[228:229], v5 offset:49152
    ds_read_b64_tr_b16 v[230:231], v5 offset:50176
    ds_read_b64_tr_b16 v[232:233], v6 offset:49152
    ds_read_b64_tr_b16 v[234:235], v6 offset:50176
    ds_read_b64_tr_b16 v[236:237], v7 offset:49152
    ds_read_b64_tr_b16 v[238:239], v7 offset:50176
    ds_read_b64_tr_b16 v[240:241], v4 offset:53248
    ds_read_b64_tr_b16 v[242:243], v4 offset:54272
    s_waitcnt lgkmcnt(8)
    v_mfma_f32_32x32x16_bf16 v[32:47], v[224:227], v[192:195], v[32:47]
    ds_read_b64_tr_b16 v[244:245], v5 offset:53248
    ds_read_b64_tr_b16 v[246:247], v5 offset:54272
    s_waitcnt lgkmcnt(8)
    v_mfma_f32_32x32x16_bf16 v[48:63], v[228:231], v[192:195], v[48:63]
    ds_read_b64_tr_b16 v[248:249], v6 offset:53248
    ds_read_b64_tr_b16 v[250:251], v6 offset:54272
    s_waitcnt lgkmcnt(8)
    v_mfma_f32_32x32x16_bf16 v[64:79], v[232:235], v[192:195], v[64:79]
    ds_read_b64_tr_b16 v[252:253], v7 offset:53248
    ds_read_b64_tr_b16 v[254:255], v7 offset:54272
    s_waitcnt lgkmcnt(8)
    v_mfma_f32_32x32x16_bf16 v[80:95], v[236:239], v[192:195], v[80:95]
    ds_read_b64_tr_b16 v[224:225], v4 offset:57344
    ds_read_b64_tr_b16 v[226:227], v4 offset:58368
    s_add_u32 m0, s29, 98304
    s_add_u32 s30, s49, 0
    s_and_b32 s30, s30, 114688
    buffer_load_dwordx4 v12, s[8:11], s30 offen offset:0 nt lds
    s_waitcnt lgkmcnt(8)
    v_mfma_f32_32x32x16_bf16 v[32:47], v[240:243], v[196:199], v[32:47]
    ds_read_b64_tr_b16 v[228:229], v5 offset:57344
    ds_read_b64_tr_b16 v[230:231], v5 offset:58368
    buffer_load_dwordx4 v12, s[8:11], s30 offen offset:1024 nt lds
    s_waitcnt lgkmcnt(8)
    v_mfma_f32_32x32x16_bf16 v[48:63], v[244:247], v[196:199], v[48:63]
    ds_read_b64_tr_b16 v[232:233], v6 offset:57344
    ds_read_b64_tr_b16 v[234:235], v6 offset:58368
    buffer_load_dwordx4 v12, s[8:11], s30 offen offset:2048 nt lds
    s_waitcnt lgkmcnt(8)
    v_mfma_f32_32x32x16_bf16 v[64:79], v[248:251], v[196:199], v[64:79]
    ds_read_b64_tr_b16 v[236:237], v7 offset:57344
    ds_read_b64_tr_b16 v[238:239], v7 offset:58368
    buffer_load_dwordx4 v12, s[8:11], s30 offen offset:3072 nt lds
    s_waitcnt lgkmcnt(8)
    v_mfma_f32_32x32x16_bf16 v[80:95], v[252:255], v[196:199], v[80:95]
    ds_read_b64_tr_b16 v[240:241], v4 offset:61440
    ds_read_b64_tr_b16 v[242:243], v4 offset:62464
    s_add_u32 m0, s29, 65536
    s_add_u32 s30, s49, 32768
    s_and_b32 s30, s30, 114688
    buffer_load_dwordx4 v8, s[4:7], s30 offen offset:0 nt lds
    s_waitcnt lgkmcnt(8)
    v_mfma_f32_32x32x16_bf16 v[32:47], v[224:227], v[200:203], v[32:47]
    ds_read_b64_tr_b16 v[244:245], v5 offset:61440
    ds_read_b64_tr_b16 v[246:247], v5 offset:62464
    buffer_load_dwordx4 v9, s[4:7], s30 offen offset:1024 nt lds
    s_waitcnt lgkmcnt(8)
    v_mfma_f32_32x32x16_bf16 v[48:63], v[228:231], v[200:203], v[48:63]
    ds_read_b64_tr_b16 v[248:249], v6 offset:61440
    ds_read_b64_tr_b16 v[250:251], v6 offset:62464
    buffer_load_dwordx4 v10, s[4:7], s30 offen offset:2048 nt lds
    s_waitcnt lgkmcnt(8)
    v_mfma_f32_32x32x16_bf16 v[64:79], v[232:235], v[200:203], v[64:79]
    ds_read_b64_tr_b16 v[252:253], v7 offset:61440
    ds_read_b64_tr_b16 v[254:255], v7 offset:62464
    buffer_load_dwordx4 v11, s[4:7], s30 offen offset:3072 nt lds
    s_waitcnt lgkmcnt(8)
    v_mfma_f32_32x32x16_bf16 v[80:95], v[236:239], v[200:203], v[80:95]
    s_waitcnt lgkmcnt(6)
    v_mfma_f32_32x32x16_bf16 v[32:47], v[240:243], v[204:207], v[32:47]
    s_waitcnt lgkmcnt(4)
    v_mfma_f32_32x32x16_bf16 v[48:63], v[244:247], v[204:207], v[48:63]
    s_waitcnt lgkmcnt(2)
    v_mfma_f32_32x32x16_bf16 v[64:79], v[248:251], v[204:207], v[64:79]
    s_waitcnt lgkmcnt(0)
    v_mfma_f32_32x32x16_bf16 v[80:95], v[252:255], v[204:207], v[80:95]
    s_waitcnt vmcnt(8)
    s_barrier
    ds_read_b64_tr_b16 v[224:225], v4 offset:16384
    ds_read_b64_tr_b16 v[226:227], v4 offset:17408
    ds_read_b64_tr_b16 v[228:229], v5 offset:16384
    ds_read_b64_tr_b16 v[230:231], v5 offset:17408
    ds_read_b64_tr_b16 v[232:233], v6 offset:16384
    ds_read_b64_tr_b16 v[234:235], v6 offset:17408
    ds_read_b64_tr_b16 v[236:237], v7 offset:16384
    ds_read_b64_tr_b16 v[238:239], v7 offset:17408
    ds_read_b64_tr_b16 v[240:241], v4 offset:20480
    ds_read_b64_tr_b16 v[242:243], v4 offset:21504
    s_waitcnt lgkmcnt(8)
    v_mfma_f32_32x32x16_bf16 v[32:47], v[224:227], v[208:211], v[32:47]
    ds_read_b64_tr_b16 v[244:245], v5 offset:20480
    ds_read_b64_tr_b16 v[246:247], v5 offset:21504
    s_waitcnt lgkmcnt(8)
    v_mfma_f32_32x32x16_bf16 v[48:63], v[228:231], v[208:211], v[48:63]
    ds_read_b64_tr_b16 v[248:249], v6 offset:20480
    ds_read_b64_tr_b16 v[250:251], v6 offset:21504
    s_waitcnt lgkmcnt(8)
    v_mfma_f32_32x32x16_bf16 v[64:79], v[232:235], v[208:211], v[64:79]
    ds_read_b64_tr_b16 v[252:253], v7 offset:20480
    ds_read_b64_tr_b16 v[254:255], v7 offset:21504
    s_waitcnt lgkmcnt(8)
    v_mfma_f32_32x32x16_bf16 v[80:95], v[236:239], v[208:211], v[80:95]
    ds_read_b64_tr_b16 v[224:225], v4 offset:24576
    ds_read_b64_tr_b16 v[226:227], v4 offset:25600
    s_add_u32 m0, s29, 81920
    s_add_u32 s30, s49, 16384
    s_and_b32 s30, s30, 114688
    buffer_load_dwordx4 v12, s[8:11], s30 offen offset:0 nt lds
    s_waitcnt lgkmcnt(8)
    v_mfma_f32_32x32x16_bf16 v[32:47], v[240:243], v[212:215], v[32:47]
    ds_read_b64_tr_b16 v[228:229], v5 offset:24576
    ds_read_b64_tr_b16 v[230:231], v5 offset:25600
    buffer_load_dwordx4 v12, s[8:11], s30 offen offset:1024 nt lds
    s_waitcnt lgkmcnt(8)
    v_mfma_f32_32x32x16_bf16 v[48:63], v[244:247], v[212:215], v[48:63]
    ds_read_b64_tr_b16 v[232:233], v6 offset:24576
    ds_read_b64_tr_b16 v[234:235], v6 offset:25600
    buffer_load_dwordx4 v12, s[8:11], s30 offen offset:2048 nt lds
    s_waitcnt lgkmcnt(8)
    v_mfma_f32_32x32x16_bf16 v[64:79], v[248:251], v[212:215], v[64:79]
    ds_read_b64_tr_b16 v[236:237], v7 offset:24576
    ds_read_b64_tr_b16 v[238:239], v7 offset:25600
    buffer_load_dwordx4 v12, s[8:11], s30 offen offset:3072 nt lds
    s_waitcnt lgkmcnt(8)
    v_mfma_f32_32x32x16_bf16 v[80:95], v[252:255], v[212:215], v[80:95]
    ds_read_b64_tr_b16 v[240:241], v4 offset:28672
    ds_read_b64_tr_b16 v[242:243], v4 offset:29696
    s_add_u32 m0, s29, 0
    s_add_u32 s30, s49, 49152
    s_and_b32 s30, s30, 114688
    buffer_load_dwordx4 v8, s[4:7], s30 offen offset:0 nt lds
    s_waitcnt lgkmcnt(8)
    v_mfma_f32_32x32x16_bf16 v[32:47], v[224:227], v[216:219], v[32:47]
    ds_read_b64_tr_b16 v[244:245], v5 offset:28672
    ds_read_b64_tr_b16 v[246:247], v5 offset:29696
    buffer_load_dwordx4 v9, s[4:7], s30 offen offset:1024 nt lds
    s_waitcnt lgkmcnt(8)
    v_mfma_f32_32x32x16_bf16 v[48:63], v[228:231], v[216:219], v[48:63]
    ds_read_b64_tr_b16 v[248:249], v6 offset:28672
    ds_read_b64_tr_b16 v[250:251], v6 offset:29696
    buffer_load_dwordx4 v10, s[4:7], s30 offen offset:2048 nt lds
    s_waitcnt lgkmcnt(8)
    v_mfma_f32_32x32x16_bf16 v[64:79], v[232:235], v[216:219], v[64:79]
    ds_read_b64_tr_b16 v[252:253], v7 offset:28672
    ds_read_b64_tr_b16 v[254:255], v7 offset:29696
    buffer_load_dwordx4 v11, s[4:7], s30 offen offset:3072 nt lds
    s_waitcnt lgkmcnt(8)
    v_mfma_f32_32x32x16_bf16 v[80:95], v[236:239], v[216:219], v[80:95]
    s_lshl_b32 s30, s34, 2
    s_add_u32 s30, s30, s35
    s_lshl_b32 s30, s30, 2
    s_add_u32 s30, s30, s28
    s_lshl_b32 s30, s30, 13
    v_lshlrev_b32 v26, 10, v0
    s_mov_b64 exec, 0xff
    buffer_load_dword v27, v26, s[84:87], s30 offen offset:256
    s_mov_b64 exec, -1
    s_waitcnt lgkmcnt(6)
    v_mfma_f32_32x32x16_bf16 v[32:47], v[240:243], v[220:223], v[32:47]
    s_mov_b64 exec, 0xff
    buffer_load_dword v27, v26, s[84:87], s30 offen offset:384
    s_mov_b64 exec, -1
    s_waitcnt lgkmcnt(4)
    v_mfma_f32_32x32x16_bf16 v[48:63], v[244:247], v[220:223], v[48:63]
    v_lshlrev_b32 v26, 7, v0
    s_lshr_b32 s30, s34, 1
    s_lshl_b32 s30, s30, 17
    v_add_u32 v26, s30, v26
    s_lshl_b32 s30, s34, 2
    s_add_u32 s30, s30, s35
    s_lshl_b32 s30, s30, 2
    s_add_u32 s30, s30, s28
    s_lshl_b32 s30, s30, 12
    s_mov_b32 exec_hi, 0
    buffer_load_dword v27, v26, s[84:87], s30 offen
    s_mov_b64 exec, -1
    s_waitcnt lgkmcnt(2)
    v_mfma_f32_32x32x16_bf16 v[64:79], v[248:251], v[220:223], v[64:79]
    s_waitcnt lgkmcnt(0)
    v_mfma_f32_32x32x16_bf16 v[80:95], v[252:255], v[220:223], v[80:95]
    v_mul_f32 v32, s33, v32
    v_mul_f32 v33, s33, v33
    v_mul_f32 v34, s33, v34
    v_mul_f32 v35, s33, v35
    v_mul_f32 v36, s33, v36
    v_mul_f32 v37, s33, v37
    v_mul_f32 v38, s33, v38
    v_mul_f32 v39, s33, v39
    v_mul_f32 v40, s33, v40
    v_mul_f32 v41, s33, v41
    v_mul_f32 v42, s33, v42
    v_mul_f32 v43, s33, v43
    v_mul_f32 v44, s33, v44
    v_mul_f32 v45, s33, v45
    v_mul_f32 v46, s33, v46
    v_mul_f32 v47, s33, v47
    v_cvt_pk_bf16_f32 v224, v32, v33
    v_cvt_pk_bf16_f32 v225, v34, v35
    v_cvt_pk_bf16_f32 v226, v36, v37
    v_cvt_pk_bf16_f32 v227, v38, v39
    v_cvt_pk_bf16_f32 v228, v40, v41
    v_cvt_pk_bf16_f32 v229, v42, v43
    v_cvt_pk_bf16_f32 v230, v44, v45
    v_cvt_pk_bf16_f32 v231, v46, v47
    ds_write_b128 v22, v[224:227] offset:16384
    ds_write_b128 v22, v[228:231] offset:17408
    v_mul_f32 v48, s33, v48
    v_mul_f32 v49, s33, v49
    v_mul_f32 v50, s33, v50
    v_mul_f32 v51, s33, v51
    v_mul_f32 v52, s33, v52
    v_mul_f32 v53, s33, v53
    v_mul_f32 v54, s33, v54
    v_mul_f32 v55, s33, v55
    v_mul_f32 v56, s33, v56
    v_mul_f32 v57, s33, v57
    v_mul_f32 v58, s33, v58
    v_mul_f32 v59, s33, v59
    v_mul_f32 v60, s33, v60
    v_mul_f32 v61, s33, v61
    v_mul_f32 v62, s33, v62
    v_mul_f32 v63, s33, v63
    v_cvt_pk_bf16_f32 v232, v48, v49
    v_cvt_pk_bf16_f32 v233, v50, v51
    v_cvt_pk_bf16_f32 v234, v52, v53
    v_cvt_pk_bf16_f32 v235, v54, v55
    v_cvt_pk_bf16_f32 v236, v56, v57
    v_cvt_pk_bf16_f32 v237, v58, v59
    v_cvt_pk_bf16_f32 v238, v60, v61
    v_cvt_pk_bf16_f32 v239, v62, v63
    ds_write_b128 v22, v[232:235] offset:18432
    ds_write_b128 v22, v[236:239] offset:19456
    v_mul_f32 v64, s33, v64
    v_mul_f32 v65, s33, v65
    v_mul_f32 v66, s33, v66
    v_mul_f32 v67, s33, v67
    v_mul_f32 v68, s33, v68
    v_mul_f32 v69, s33, v69
    v_mul_f32 v70, s33, v70
    v_mul_f32 v71, s33, v71
    v_mul_f32 v72, s33, v72
    v_mul_f32 v73, s33, v73
    v_mul_f32 v74, s33, v74
    v_mul_f32 v75, s33, v75
    v_mul_f32 v76, s33, v76
    v_mul_f32 v77, s33, v77
    v_mul_f32 v78, s33, v78
    v_mul_f32 v79, s33, v79
    v_cvt_pk_bf16_f32 v240, v64, v65
    v_cvt_pk_bf16_f32 v241, v66, v67
    v_cvt_pk_bf16_f32 v242, v68, v69
    v_cvt_pk_bf16_f32 v243, v70, v71
    v_cvt_pk_bf16_f32 v244, v72, v73
    v_cvt_pk_bf16_f32 v245, v74, v75
    v_cvt_pk_bf16_f32 v246, v76, v77
    v_cvt_pk_bf16_f32 v247, v78, v79
    ds_write_b128 v22, v[240:243] offset:32768
    ds_write_b128 v22, v[244:247] offset:33792
    v_mul_f32 v80, s33, v80
    v_mul_f32 v81, s33, v81
    v_mul_f32 v82, s33, v82
    v_mul_f32 v83, s33, v83
    v_mul_f32 v84, s33, v84
    v_mul_f32 v85, s33, v85
    v_mul_f32 v86, s33, v86
    v_mul_f32 v87, s33, v87
    v_mul_f32 v88, s33, v88
    v_mul_f32 v89, s33, v89
    v_mul_f32 v90, s33, v90
    v_mul_f32 v91, s33, v91
    v_mul_f32 v92, s33, v92
    v_mul_f32 v93, s33, v93
    v_mul_f32 v94, s33, v94
    v_mul_f32 v95, s33, v95
    v_cvt_pk_bf16_f32 v248, v80, v81
    v_cvt_pk_bf16_f32 v249, v82, v83
    v_cvt_pk_bf16_f32 v250, v84, v85
    v_cvt_pk_bf16_f32 v251, v86, v87
    v_cvt_pk_bf16_f32 v252, v88, v89
    v_cvt_pk_bf16_f32 v253, v90, v91
    v_cvt_pk_bf16_f32 v254, v92, v93
    v_cvt_pk_bf16_f32 v255, v94, v95
    ds_write_b128 v22, v[248:251] offset:34816
    ds_write_b128 v22, v[252:255] offset:35840
    s_waitcnt lgkmcnt(0)
    s_barrier
    s_add_u32 m0, s29, 114688
    s_add_u32 s30, s35, 0
    s_and_b32 s30, s30, 3
    s_lshl_b32 s30, s30, 18
    s_add_u32 s30, s30, 131072
    buffer_load_dwordx4 v3, s[16:19], s30 offen offset:0 nt lds
    s_add_u32 s30, s30, 3072
    buffer_load_dwordx4 v3, s[16:19], s30 offen offset:1024 nt lds
    s_add_u32 s30, s30, 3072
    buffer_load_dwordx4 v3, s[16:19], s30 offen offset:2048 nt lds
    s_add_u32 s30, s30, 3072
    buffer_load_dwordx4 v3, s[16:19], s30 offen offset:3072 nt lds
    s_add_u32 m0, s29, 16384
    s_add_u32 s30, s49, 32768
    s_and_b32 s30, s30, 114688
    buffer_load_dwordx4 v12, s[8:11], s30 offen offset:0 nt lds
    buffer_load_dwordx4 v12, s[8:11], s30 offen offset:1024 nt lds
    buffer_load_dwordx4 v12, s[8:11], s30 offen offset:2048 nt lds
    buffer_load_dwordx4 v12, s[8:11], s30 offen offset:3072 nt lds
    s_waitcnt vmcnt(4)
    s_barrier
    ds_read_b128 v[96:99], v22 offset:16384
    ds_read_b128 v[100:103], v22 offset:17408
    ds_read_b128 v[104:107], v22 offset:18432
    ds_read_b128 v[108:111], v22 offset:19456
    ds_read_b128 v[112:115], v22 offset:32768
    ds_read_b128 v[116:119], v22 offset:33792
    ds_read_b128 v[120:123], v22 offset:34816
    ds_read_b128 v[124:127], v22 offset:35840
    s_waitcnt lgkmcnt(0)
    ds_read_b64_tr_b16 v[224:225], v16 offset:16384
    ds_read_b64_tr_b16 v[226:227], v16 offset:18432
    ds_read_b64_tr_b16 v[228:229], v17 offset:16384
    ds_read_b64_tr_b16 v[230:231], v17 offset:18432
    ds_read_b64_tr_b16 v[232:233], v18 offset:16384
    ds_read_b64_tr_b16 v[234:235], v18 offset:18432
    ds_read_b64_tr_b16 v[236:237], v19 offset:16384
    ds_read_b64_tr_b16 v[238:239], v19 offset:18432
    ds_read_b64_tr_b16 v[240:241], v16 offset:20480
    ds_read_b64_tr_b16 v[242:243], v16 offset:22528
    s_waitcnt lgkmcnt(8)
    v_mfma_f32_32x32x16_bf16 v[32:47], v[224:227], v[96:99], 0
    ds_read_b64_tr_b16 v[244:245], v17 offset:20480
    ds_read_b64_tr_b16 v[246:247], v17 offset:22528
    s_waitcnt lgkmcnt(8)
    v_mfma_f32_32x32x16_bf16 v[48:63], v[228:231], v[96:99], 0
    ds_read_b64_tr_b16 v[248:249], v18 offset:20480
    ds_read_b64_tr_b16 v[250:251], v18 offset:22528
    s_waitcnt lgkmcnt(8)
    v_mfma_f32_32x32x16_bf16 v[64:79], v[232:235], v[96:99], 0
    ds_read_b64_tr_b16 v[252:253], v19 offset:20480
    ds_read_b64_tr_b16 v[254:255], v19 offset:22528
    s_waitcnt lgkmcnt(8)
    v_mfma_f32_32x32x16_bf16 v[80:95], v[236:239], v[96:99], 0
    ds_read_b64_tr_b16 v[224:225], v16 offset:24576
    ds_read_b64_tr_b16 v[226:227], v16 offset:26624
    s_add_u32 m0, s29, 32768
    s_add_u32 s30, s49, 65536
    s_and_b32 s30, s30, 114688
    buffer_load_dwordx4 v8, s[4:7], s30 offen offset:0 nt lds
    s_waitcnt lgkmcnt(8)
    v_mfma_f32_32x32x16_bf16 v[32:47], v[240:243], v[100:103], v[32:47]
    ds_read_b64_tr_b16 v[228:229], v17 offset:24576
    ds_read_b64_tr_b16 v[230:231], v17 offset:26624
    buffer_load_dwordx4 v9, s[4:7], s30 offen offset:1024 nt lds
    s_waitcnt lgkmcnt(8)
    v_mfma_f32_32x32x16_bf16 v[48:63], v[244:247], v[100:103], v[48:63]
    ds_read_b64_tr_b16 v[232:233], v18 offset:24576
    ds_read_b64_tr_b16 v[234:235], v18 offset:26624
    buffer_load_dwordx4 v10, s[4:7], s30 offen offset:2048 nt lds
    s_waitcnt lgkmcnt(8)
    v_mfma_f32_32x32x16_bf16 v[64:79], v[248:251], v[100:103], v[64:79]
    ds_read_b64_tr_b16 v[236:237], v19 offset:24576
    ds_read_b64_tr_b16 v[238:239], v19 offset:26624
    buffer_load_dwordx4 v11, s[4:7], s30 offen offset:3072 nt lds
    s_waitcnt lgkmcnt(8)
    v_mfma_f32_32x32x16_bf16 v[80:95], v[252:255], v[100:103], v[80:95]
    ds_read_b64_tr_b16 v[240:241], v16 offset:28672
    ds_read_b64_tr_b16 v[242:243], v16 offset:30720
    s_waitcnt lgkmcnt(8)
    v_mfma_f32_32x32x16_bf16 v[32:47], v[224:227], v[104:107], v[32:47]
    ds_read_b64_tr_b16 v[244:245], v17 offset:28672
    ds_read_b64_tr_b16 v[246:247], v17 offset:30720
    s_waitcnt lgkmcnt(8)
    v_mfma_f32_32x32x16_bf16 v[48:63], v[228:231], v[104:107], v[48:63]
    ds_read_b64_tr_b16 v[248:249], v18 offset:28672
    ds_read_b64_tr_b16 v[250:251], v18 offset:30720
    s_waitcnt lgkmcnt(8)
    v_mfma_f32_32x32x16_bf16 v[64:79], v[232:235], v[104:107], v[64:79]
    ds_read_b64_tr_b16 v[252:253], v19 offset:28672
    ds_read_b64_tr_b16 v[254:255], v19 offset:30720
    s_waitcnt lgkmcnt(8)
    v_mfma_f32_32x32x16_bf16 v[80:95], v[236:239], v[104:107], v[80:95]
    s_waitcnt lgkmcnt(6)
    v_mfma_f32_32x32x16_bf16 v[32:47], v[240:243], v[108:111], v[32:47]
    s_waitcnt lgkmcnt(4)
    v_mfma_f32_32x32x16_bf16 v[48:63], v[244:247], v[108:111], v[48:63]
    s_waitcnt lgkmcnt(2)
    v_mfma_f32_32x32x16_bf16 v[64:79], v[248:251], v[108:111], v[64:79]
    s_waitcnt lgkmcnt(0)
    v_mfma_f32_32x32x16_bf16 v[80:95], v[252:255], v[108:111], v[80:95]
    s_barrier
    s_add_u32 m0, s29, 131072
    s_add_u32 s30, s35, 0
    s_and_b32 s30, s30, 3
    s_lshl_b32 s30, s30, 18
    s_add_u32 s30, s30, 196608
    buffer_load_dwordx4 v3, s[16:19], s30 offen offset:0 nt lds
    s_add_u32 s30, s30, 3072
    buffer_load_dwordx4 v3, s[16:19], s30 offen offset:1024 nt lds
    s_add_u32 s30, s30, 3072
    buffer_load_dwordx4 v3, s[16:19], s30 offen offset:2048 nt lds
    s_add_u32 s30, s30, 3072
    buffer_load_dwordx4 v3, s[16:19], s30 offen offset:3072 nt lds
    s_add_u32 m0, s29, 49152
    s_add_u32 s30, s49, 49152
    s_and_b32 s30, s30, 114688
    buffer_load_dwordx4 v12, s[8:11], s30 offen offset:0 nt lds
    buffer_load_dwordx4 v12, s[8:11], s30 offen offset:1024 nt lds
    buffer_load_dwordx4 v12, s[8:11], s30 offen offset:2048 nt lds
    buffer_load_dwordx4 v12, s[8:11], s30 offen offset:3072 nt lds
    s_add_u32 m0, s29, 98304
    s_add_u32 s30, s49, 81920
    s_and_b32 s30, s30, 114688
    buffer_load_dwordx4 v8, s[4:7], s30 offen offset:0 nt lds
    buffer_load_dwordx4 v9, s[4:7], s30 offen offset:1024 nt lds
    buffer_load_dwordx4 v10, s[4:7], s30 offen offset:2048 nt lds
    buffer_load_dwordx4 v11, s[4:7], s30 offen offset:3072 nt lds
    s_add_u32 m0, s29, 147456
    s_add_u32 s30, s35, 1
    s_and_b32 s30, s30, 3
    s_lshl_b32 s30, s30, 18
    s_add_u32 s30, s30, 131072
    buffer_load_dwordx4 v3, s[16:19], s30 offen offset:0 nt lds
    s_add_u32 s30, s30, 3072
    buffer_load_dwordx4 v3, s[16:19], s30 offen offset:1024 nt lds
    s_add_u32 s30, s30, 3072
    buffer_load_dwordx4 v3, s[16:19], s30 offen offset:2048 nt lds
    s_add_u32 s30, s30, 3072
    buffer_load_dwordx4 v3, s[16:19], s30 offen offset:3072 nt lds
    s_waitcnt vmcnt(12)
    s_barrier
    ds_read_b64_tr_b16 v[224:225], v16 offset:32768
    ds_read_b64_tr_b16 v[226:227], v16 offset:34816
    ds_read_b64_tr_b16 v[228:229], v17 offset:32768
    ds_read_b64_tr_b16 v[230:231], v17 offset:34816
    ds_read_b64_tr_b16 v[232:233], v18 offset:32768
    ds_read_b64_tr_b16 v[234:235], v18 offset:34816
    ds_read_b64_tr_b16 v[236:237], v19 offset:32768
    ds_read_b64_tr_b16 v[238:239], v19 offset:34816
    ds_read_b64_tr_b16 v[240:241], v16 offset:36864
    ds_read_b64_tr_b16 v[242:243], v16 offset:38912
    s_waitcnt lgkmcnt(8)
    v_mfma_f32_32x32x16_bf16 v[32:47], v[224:227], v[112:115], v[32:47]
    ds_read_b64_tr_b16 v[244:245], v17 offset:36864
    ds_read_b64_tr_b16 v[246:247], v17 offset:38912
    s_waitcnt lgkmcnt(8)
    v_mfma_f32_32x32x16_bf16 v[48:63], v[228:231], v[112:115], v[48:63]
    ds_read_b64_tr_b16 v[248:249], v18 offset:36864
    ds_read_b64_tr_b16 v[250:251], v18 offset:38912
    s_waitcnt lgkmcnt(8)
    v_mfma_f32_32x32x16_bf16 v[64:79], v[232:235], v[112:115], v[64:79]
    ds_read_b64_tr_b16 v[252:253], v19 offset:36864
    ds_read_b64_tr_b16 v[254:255], v19 offset:38912
    s_waitcnt lgkmcnt(8)
    v_mfma_f32_32x32x16_bf16 v[80:95], v[236:239], v[112:115], v[80:95]
    ds_read_b64_tr_b16 v[224:225], v16 offset:40960
    ds_read_b64_tr_b16 v[226:227], v16 offset:43008
    s_add_u32 m0, s29, 65536
    s_add_u32 s30, s49, 65536
    s_and_b32 s30, s30, 114688
    buffer_load_dwordx4 v12, s[8:11], s30 offen offset:0 nt lds
    s_waitcnt lgkmcnt(8)
    v_mfma_f32_32x32x16_bf16 v[32:47], v[240:243], v[116:119], v[32:47]
    ds_read_b64_tr_b16 v[228:229], v17 offset:40960
    ds_read_b64_tr_b16 v[230:231], v17 offset:43008
    buffer_load_dwordx4 v12, s[8:11], s30 offen offset:1024 nt lds
    s_waitcnt lgkmcnt(8)
    v_mfma_f32_32x32x16_bf16 v[48:63], v[244:247], v[116:119], v[48:63]
    ds_read_b64_tr_b16 v[232:233], v18 offset:40960
    ds_read_b64_tr_b16 v[234:235], v18 offset:43008
    buffer_load_dwordx4 v12, s[8:11], s30 offen offset:2048 nt lds
    s_waitcnt lgkmcnt(8)
    v_mfma_f32_32x32x16_bf16 v[64:79], v[248:251], v[116:119], v[64:79]
    ds_read_b64_tr_b16 v[236:237], v19 offset:40960
    ds_read_b64_tr_b16 v[238:239], v19 offset:43008
    buffer_load_dwordx4 v12, s[8:11], s30 offen offset:3072 nt lds
    s_waitcnt lgkmcnt(8)
    v_mfma_f32_32x32x16_bf16 v[80:95], v[252:255], v[116:119], v[80:95]
    ds_read_b64_tr_b16 v[240:241], v16 offset:45056
    ds_read_b64_tr_b16 v[242:243], v16 offset:47104
    s_add_u32 m0, s29, 81920
    s_add_u32 s30, s49, 98304
    s_and_b32 s30, s30, 114688
    buffer_load_dwordx4 v8, s[4:7], s30 offen offset:0 nt lds
    s_waitcnt lgkmcnt(8)
    v_mfma_f32_32x32x16_bf16 v[32:47], v[224:227], v[120:123], v[32:47]
    ds_read_b64_tr_b16 v[244:245], v17 offset:45056
    ds_read_b64_tr_b16 v[246:247], v17 offset:47104
    buffer_load_dwordx4 v9, s[4:7], s30 offen offset:1024 nt lds
    s_waitcnt lgkmcnt(8)
    v_mfma_f32_32x32x16_bf16 v[48:63], v[228:231], v[120:123], v[48:63]
    ds_read_b64_tr_b16 v[248:249], v18 offset:45056
    ds_read_b64_tr_b16 v[250:251], v18 offset:47104
    buffer_load_dwordx4 v10, s[4:7], s30 offen offset:2048 nt lds
    s_waitcnt lgkmcnt(8)
    v_mfma_f32_32x32x16_bf16 v[64:79], v[232:235], v[120:123], v[64:79]
    ds_read_b64_tr_b16 v[252:253], v19 offset:45056
    ds_read_b64_tr_b16 v[254:255], v19 offset:47104
    buffer_load_dwordx4 v11, s[4:7], s30 offen offset:3072 nt lds
    s_waitcnt lgkmcnt(8)
    v_mfma_f32_32x32x16_bf16 v[80:95], v[236:239], v[120:123], v[80:95]
    s_add_u32 m0, s29, 114688
    s_add_u32 s30, s35, 1
    s_and_b32 s30, s30, 3
    s_lshl_b32 s30, s30, 18
    s_add_u32 s30, s30, 196608
    buffer_load_dwordx4 v3, s[16:19], s30 offen offset:0 nt lds
    s_waitcnt lgkmcnt(6)
    v_mfma_f32_32x32x16_bf16 v[32:47], v[240:243], v[124:127], v[32:47]
    s_add_u32 s30, s30, 3072
    buffer_load_dwordx4 v3, s[16:19], s30 offen offset:1024 nt lds
    s_waitcnt lgkmcnt(4)
    v_mfma_f32_32x32x16_bf16 v[48:63], v[244:247], v[124:127], v[48:63]
    s_add_u32 s30, s30, 3072
    buffer_load_dwordx4 v3, s[16:19], s30 offen offset:2048 nt lds
    s_waitcnt lgkmcnt(2)
    v_mfma_f32_32x32x16_bf16 v[64:79], v[248:251], v[124:127], v[64:79]
    s_add_u32 s30, s30, 3072
    buffer_load_dwordx4 v3, s[16:19], s30 offen offset:3072 nt lds
    s_waitcnt lgkmcnt(0)
    v_mfma_f32_32x32x16_bf16 v[80:95], v[252:255], v[124:127], v[80:95]
    s_waitcnt vmcnt(16)
    s_barrier
    s_add_u32 m0, s29, 0
    s_add_u32 s30, s49, 81920
    s_and_b32 s30, s30, 114688
    buffer_load_dwordx4 v12, s[8:11], s30 offen offset:0 nt lds
    buffer_load_dwordx4 v12, s[8:11], s30 offen offset:1024 nt lds
    buffer_load_dwordx4 v12, s[8:11], s30 offen offset:2048 nt lds
    buffer_load_dwordx4 v12, s[8:11], s30 offen offset:3072 nt lds
    s_add_u32 m0, s29, 16384
    s_add_u32 s30, s49, 114688
    s_and_b32 s30, s30, 114688
    buffer_load_dwordx4 v8, s[4:7], s30 offen offset:0 nt lds
    buffer_load_dwordx4 v9, s[4:7], s30 offen offset:1024 nt lds
    buffer_load_dwordx4 v10, s[4:7], s30 offen offset:2048 nt lds
    buffer_load_dwordx4 v11, s[4:7], s30 offen offset:3072 nt lds
    s_add_u32 m0, s29, 131072
    s_add_u32 s30, s35, 2
    s_and_b32 s30, s30, 3
    s_lshl_b32 s30, s30, 18
    s_add_u32 s30, s30, 131072
    buffer_load_dwordx4 v3, s[16:19], s30 offen offset:0 nt lds
    s_add_u32 s30, s30, 3072
    buffer_load_dwordx4 v3, s[16:19], s30 offen offset:1024 nt lds
    s_add_u32 s30, s30, 3072
    buffer_load_dwordx4 v3, s[16:19], s30 offen offset:2048 nt lds
    s_add_u32 s30, s30, 3072
    buffer_load_dwordx4 v3, s[16:19], s30 offen offset:3072 nt lds
    s_waitcnt vmcnt(16)
    s_barrier
    s_add_u32 m0, s29, 32768
    s_add_u32 s30, s49, 98304
    s_and_b32 s30, s30, 114688
    buffer_load_dwordx4 v12, s[8:11], s30 offen offset:0 nt lds
    buffer_load_dwordx4 v12, s[8:11], s30 offen offset:1024 nt lds
    buffer_load_dwordx4 v12, s[8:11], s30 offen offset:2048 nt lds
    buffer_load_dwordx4 v12, s[8:11], s30 offen offset:3072 nt lds
    s_add_u32 s30, s35, 1
    s_and_b32 s30, s30, 3
    s_lshl_b32 s30, s30, 16
    s_add_u32 s30, s30, 32768
    buffer_load_dwordx4 v[128:131], v21, s[20:23], s30 offen offset:0
    buffer_load_dwordx4 v[132:135], v21, s[20:23], s30 offen offset:1024
    buffer_load_dwordx4 v[136:139], v21, s[20:23], s30 offen offset:2048
    buffer_load_dwordx4 v[140:143], v21, s[20:23], s30 offen offset:3072
    s_add_u32 s30, s30, 4096
    buffer_load_dwordx4 v[144:147], v21, s[20:23], s30 offen offset:0
    buffer_load_dwordx4 v[148:151], v21, s[20:23], s30 offen offset:1024
    buffer_load_dwordx4 v[152:155], v21, s[20:23], s30 offen offset:2048
    buffer_load_dwordx4 v[156:159], v21, s[20:23], s30 offen offset:3072
    s_add_u32 m0, s29, 49152
    s_add_u32 s30, s49, 114688
    s_and_b32 s30, s30, 114688
    buffer_load_dwordx4 v12, s[8:11], s30 offen offset:0 nt lds
    buffer_load_dwordx4 v12, s[8:11], s30 offen offset:1024 nt lds
    buffer_load_dwordx4 v12, s[8:11], s30 offen offset:2048 nt lds
    buffer_load_dwordx4 v12, s[8:11], s30 offen offset:3072 nt lds
    v_subrev_u32 v8, 98304, v16
    v_subrev_u32 v12, 32768, v16
    v_subrev_u32 v9, 98304, v17
    v_subrev_u32 v13, 32768, v17
    v_subrev_u32 v10, 98304, v18
    v_subrev_u32 v14, 32768, v18
    v_subrev_u32 v11, 98304, v19
    v_subrev_u32 v15, 32768, v19
    s_waitcnt vmcnt(20)
    s_barrier
    ds_read_b64_tr_b16 v[224:225], v16 offset:49152
    ds_read_b64_tr_b16 v[226:227], v16 offset:51200
    ds_read_b64_tr_b16 v[228:229], v17 offset:49152
    ds_read_b64_tr_b16 v[230:231], v17 offset:51200
    ds_read_b64_tr_b16 v[232:233], v18 offset:49152
    ds_read_b64_tr_b16 v[234:235], v18 offset:51200
    ds_read_b64_tr_b16 v[236:237], v19 offset:49152
    ds_read_b64_tr_b16 v[238:239], v19 offset:51200
    ds_read_b64_tr_b16 v[240:241], v16 offset:53248
    ds_read_b64_tr_b16 v[242:243], v16 offset:55296
    s_waitcnt vmcnt(8)
    s_waitcnt lgkmcnt(8)
    v_mfma_f32_32x32x16_bf16 v[32:47], v[224:227], v[128:131], v[32:47]
    ds_read_b64_tr_b16 v[244:245], v17 offset:53248
    ds_read_b64_tr_b16 v[246:247], v17 offset:55296
    s_waitcnt lgkmcnt(8)
    v_mfma_f32_32x32x16_bf16 v[48:63], v[228:231], v[128:131], v[48:63]
    ds_read_b64_tr_b16 v[248:249], v18 offset:53248
    ds_read_b64_tr_b16 v[250:251], v18 offset:55296
    s_waitcnt lgkmcnt(8)
    v_mfma_f32_32x32x16_bf16 v[64:79], v[232:235], v[128:131], v[64:79]
    ds_read_b64_tr_b16 v[252:253], v19 offset:53248
    ds_read_b64_tr_b16 v[254:255], v19 offset:55296
    s_waitcnt lgkmcnt(8)
    v_mfma_f32_32x32x16_bf16 v[80:95], v[236:239], v[128:131], v[80:95]
    ds_read_b64_tr_b16 v[224:225], v16 offset:57344
    ds_read_b64_tr_b16 v[226:227], v16 offset:59392
    s_add_u32 m0, s29, 98304
    s_add_u32 s30, s35, 2
    s_and_b32 s30, s30, 3
    s_lshl_b32 s30, s30, 18
    s_add_u32 s30, s30, 196608
    buffer_load_dwordx4 v3, s[16:19], s30 offen offset:0 nt lds
    s_waitcnt lgkmcnt(8)
    v_mfma_f32_32x32x16_bf16 v[32:47], v[240:243], v[132:135], v[32:47]
    ds_read_b64_tr_b16 v[228:229], v17 offset:57344
    ds_read_b64_tr_b16 v[230:231], v17 offset:59392
    s_add_u32 s30, s30, 3072
    buffer_load_dwordx4 v3, s[16:19], s30 offen offset:1024 nt lds
    s_waitcnt lgkmcnt(8)
    v_mfma_f32_32x32x16_bf16 v[48:63], v[244:247], v[132:135], v[48:63]
    ds_read_b64_tr_b16 v[232:233], v18 offset:57344
    ds_read_b64_tr_b16 v[234:235], v18 offset:59392
    s_add_u32 s30, s30, 3072
    buffer_load_dwordx4 v3, s[16:19], s30 offen offset:2048 nt lds
    s_waitcnt lgkmcnt(8)
    v_mfma_f32_32x32x16_bf16 v[64:79], v[248:251], v[132:135], v[64:79]
    ds_read_b64_tr_b16 v[236:237], v19 offset:57344
    ds_read_b64_tr_b16 v[238:239], v19 offset:59392
    s_add_u32 s30, s30, 3072
    buffer_load_dwordx4 v3, s[16:19], s30 offen offset:3072 nt lds
    s_waitcnt lgkmcnt(8)
    v_mfma_f32_32x32x16_bf16 v[80:95], v[252:255], v[132:135], v[80:95]
    ds_read_b64_tr_b16 v[240:241], v16 offset:61440
    ds_read_b64_tr_b16 v[242:243], v16 offset:63488
    s_add_u32 m0, s29, 65536
    s_add_u32 s30, s35, 3
    s_and_b32 s30, s30, 3
    s_lshl_b32 s30, s30, 18
    s_add_u32 s30, s30, 131072
    buffer_load_dwordx4 v3, s[16:19], s30 offen offset:0 nt lds
    s_waitcnt lgkmcnt(8)
    v_mfma_f32_32x32x16_bf16 v[32:47], v[224:227], v[136:139], v[32:47]
    ds_read_b64_tr_b16 v[244:245], v17 offset:61440
    ds_read_b64_tr_b16 v[246:247], v17 offset:63488
    s_add_u32 s30, s30, 3072
    buffer_load_dwordx4 v3, s[16:19], s30 offen offset:1024 nt lds
    s_waitcnt lgkmcnt(8)
    v_mfma_f32_32x32x16_bf16 v[48:63], v[228:231], v[136:139], v[48:63]
    ds_read_b64_tr_b16 v[248:249], v18 offset:61440
    ds_read_b64_tr_b16 v[250:251], v18 offset:63488
    s_add_u32 s30, s30, 3072
    buffer_load_dwordx4 v3, s[16:19], s30 offen offset:2048 nt lds
    s_waitcnt lgkmcnt(8)
    v_mfma_f32_32x32x16_bf16 v[64:79], v[232:235], v[136:139], v[64:79]
    ds_read_b64_tr_b16 v[252:253], v19 offset:61440
    ds_read_b64_tr_b16 v[254:255], v19 offset:63488
    s_add_u32 s30, s30, 3072
    buffer_load_dwordx4 v3, s[16:19], s30 offen offset:3072 nt lds
    s_waitcnt lgkmcnt(8)
    v_mfma_f32_32x32x16_bf16 v[80:95], v[236:239], v[136:139], v[80:95]
    ds_read_b64_tr_b16 v[224:225], v16 offset:16384
    ds_read_b64_tr_b16 v[226:227], v16 offset:18432
    s_add_u32 s30, s35, 2
    s_and_b32 s30, s30, 3
    s_lshl_b32 s30, s30, 16
    s_add_u32 s30, s30, 32768
    buffer_load_dwordx4 v[160:163], v21, s[20:23], s30 offen offset:0
    s_waitcnt lgkmcnt(8)
    v_mfma_f32_32x32x16_bf16 v[32:47], v[240:243], v[140:143], v[32:47]
    ds_read_b64_tr_b16 v[228:229], v17 offset:16384
    ds_read_b64_tr_b16 v[230:231], v17 offset:18432
    buffer_load_dwordx4 v[164:167], v21, s[20:23], s30 offen offset:1024
    s_waitcnt lgkmcnt(8)
    v_mfma_f32_32x32x16_bf16 v[48:63], v[244:247], v[140:143], v[48:63]
    ds_read_b64_tr_b16 v[232:233], v18 offset:16384
    ds_read_b64_tr_b16 v[234:235], v18 offset:18432
    buffer_load_dwordx4 v[168:171], v21, s[20:23], s30 offen offset:2048
    s_waitcnt lgkmcnt(8)
    v_mfma_f32_32x32x16_bf16 v[64:79], v[248:251], v[140:143], v[64:79]
    ds_read_b64_tr_b16 v[236:237], v19 offset:16384
    ds_read_b64_tr_b16 v[238:239], v19 offset:18432
    buffer_load_dwordx4 v[172:175], v21, s[20:23], s30 offen offset:3072
    s_waitcnt lgkmcnt(8)
    v_mfma_f32_32x32x16_bf16 v[80:95], v[252:255], v[140:143], v[80:95]
    ds_read_b64_tr_b16 v[240:241], v16 offset:20480
    ds_read_b64_tr_b16 v[242:243], v16 offset:22528
    s_add_u32 s30, s30, 4096
    buffer_load_dwordx4 v[176:179], v21, s[20:23], s30 offen offset:0
    s_waitcnt vmcnt(17)
    s_waitcnt lgkmcnt(8)
    v_mfma_f32_32x32x16_bf16 v[32:47], v[224:227], v[144:147], v[32:47]
    ds_read_b64_tr_b16 v[244:245], v17 offset:20480
    ds_read_b64_tr_b16 v[246:247], v17 offset:22528
    buffer_load_dwordx4 v[180:183], v21, s[20:23], s30 offen offset:1024
    s_waitcnt lgkmcnt(8)
    v_mfma_f32_32x32x16_bf16 v[48:63], v[228:231], v[144:147], v[48:63]
    ds_read_b64_tr_b16 v[248:249], v18 offset:20480
    ds_read_b64_tr_b16 v[250:251], v18 offset:22528
    buffer_load_dwordx4 v[184:187], v21, s[20:23], s30 offen offset:2048
    s_waitcnt lgkmcnt(8)
    v_mfma_f32_32x32x16_bf16 v[64:79], v[232:235], v[144:147], v[64:79]
    ds_read_b64_tr_b16 v[252:253], v19 offset:20480
    ds_read_b64_tr_b16 v[254:255], v19 offset:22528
    buffer_load_dwordx4 v[188:191], v21, s[20:23], s30 offen offset:3072
    s_waitcnt lgkmcnt(8)
    v_mfma_f32_32x32x16_bf16 v[80:95], v[236:239], v[144:147], v[80:95]
    ds_read_b64_tr_b16 v[224:225], v16 offset:24576
    ds_read_b64_tr_b16 v[226:227], v16 offset:26624
    s_waitcnt lgkmcnt(8)
    v_mfma_f32_32x32x16_bf16 v[32:47], v[240:243], v[148:151], v[32:47]
    ds_read_b64_tr_b16 v[228:229], v17 offset:24576
    ds_read_b64_tr_b16 v[230:231], v17 offset:26624
    s_waitcnt lgkmcnt(8)
    v_mfma_f32_32x32x16_bf16 v[48:63], v[244:247], v[148:151], v[48:63]
    ds_read_b64_tr_b16 v[232:233], v18 offset:24576
    ds_read_b64_tr_b16 v[234:235], v18 offset:26624
    s_waitcnt lgkmcnt(8)
    v_mfma_f32_32x32x16_bf16 v[64:79], v[248:251], v[148:151], v[64:79]
    ds_read_b64_tr_b16 v[236:237], v19 offset:24576
    ds_read_b64_tr_b16 v[238:239], v19 offset:26624
    s_waitcnt lgkmcnt(8)
    v_mfma_f32_32x32x16_bf16 v[80:95], v[252:255], v[148:151], v[80:95]
    ds_read_b64_tr_b16 v[240:241], v16 offset:28672
    ds_read_b64_tr_b16 v[242:243], v16 offset:30720
    s_waitcnt lgkmcnt(8)
    v_mfma_f32_32x32x16_bf16 v[32:47], v[224:227], v[152:155], v[32:47]
    ds_read_b64_tr_b16 v[244:245], v17 offset:28672
    ds_read_b64_tr_b16 v[246:247], v17 offset:30720
    s_waitcnt lgkmcnt(8)
    v_mfma_f32_32x32x16_bf16 v[48:63], v[228:231], v[152:155], v[48:63]
    ds_read_b64_tr_b16 v[248:249], v18 offset:28672
    ds_read_b64_tr_b16 v[250:251], v18 offset:30720
    s_waitcnt lgkmcnt(8)
    v_mfma_f32_32x32x16_bf16 v[64:79], v[232:235], v[152:155], v[64:79]
    ds_read_b64_tr_b16 v[252:253], v19 offset:28672
    ds_read_b64_tr_b16 v[254:255], v19 offset:30720
    s_waitcnt lgkmcnt(8)
    v_mfma_f32_32x32x16_bf16 v[80:95], v[236:239], v[152:155], v[80:95]
    s_waitcnt lgkmcnt(6)
    v_mfma_f32_32x32x16_bf16 v[32:47], v[240:243], v[156:159], v[32:47]
    s_waitcnt lgkmcnt(4)
    v_mfma_f32_32x32x16_bf16 v[48:63], v[244:247], v[156:159], v[48:63]
    s_waitcnt lgkmcnt(2)
    v_mfma_f32_32x32x16_bf16 v[64:79], v[248:251], v[156:159], v[64:79]
    s_waitcnt lgkmcnt(0)
    v_mfma_f32_32x32x16_bf16 v[80:95], v[252:255], v[156:159], v[80:95]
    s_waitcnt vmcnt(12)
    s_barrier
    ds_read_b64_tr_b16 v[224:225], v16 offset:32768
    ds_read_b64_tr_b16 v[226:227], v16 offset:34816
    ds_read_b64_tr_b16 v[228:229], v17 offset:32768
    ds_read_b64_tr_b16 v[230:231], v17 offset:34816
    ds_read_b64_tr_b16 v[232:233], v18 offset:32768
    ds_read_b64_tr_b16 v[234:235], v18 offset:34816
    ds_read_b64_tr_b16 v[236:237], v19 offset:32768
    ds_read_b64_tr_b16 v[238:239], v19 offset:34816
    ds_read_b64_tr_b16 v[240:241], v16 offset:36864
    ds_read_b64_tr_b16 v[242:243], v16 offset:38912
    s_waitcnt vmcnt(4)
    s_waitcnt lgkmcnt(8)
    v_mfma_f32_32x32x16_bf16 v[32:47], v[224:227], v[160:163], v[32:47]
    ds_read_b64_tr_b16 v[244:245], v17 offset:36864
    ds_read_b64_tr_b16 v[246:247], v17 offset:38912
    s_waitcnt lgkmcnt(8)
    v_mfma_f32_32x32x16_bf16 v[48:63], v[228:231], v[160:163], v[48:63]
    ds_read_b64_tr_b16 v[248:249], v18 offset:36864
    ds_read_b64_tr_b16 v[250:251], v18 offset:38912
    s_waitcnt lgkmcnt(8)
    v_mfma_f32_32x32x16_bf16 v[64:79], v[232:235], v[160:163], v[64:79]
    ds_read_b64_tr_b16 v[252:253], v19 offset:36864
    ds_read_b64_tr_b16 v[254:255], v19 offset:38912
    s_waitcnt lgkmcnt(8)
    v_mfma_f32_32x32x16_bf16 v[80:95], v[236:239], v[160:163], v[80:95]
    ds_read_b64_tr_b16 v[224:225], v16 offset:40960
    ds_read_b64_tr_b16 v[226:227], v16 offset:43008
    s_add_u32 s30, s35, 3
    s_and_b32 s30, s30, 3
    s_lshl_b32 s30, s30, 16
    s_add_u32 s30, s30, 32768
    buffer_load_dwordx4 v[192:195], v21, s[20:23], s30 offen offset:0
    s_waitcnt lgkmcnt(8)
    v_mfma_f32_32x32x16_bf16 v[32:47], v[240:243], v[164:167], v[32:47]
    ds_read_b64_tr_b16 v[228:229], v17 offset:40960
    ds_read_b64_tr_b16 v[230:231], v17 offset:43008
    buffer_load_dwordx4 v[196:199], v21, s[20:23], s30 offen offset:1024
    s_waitcnt lgkmcnt(8)
    v_mfma_f32_32x32x16_bf16 v[48:63], v[244:247], v[164:167], v[48:63]
    ds_read_b64_tr_b16 v[232:233], v18 offset:40960
    ds_read_b64_tr_b16 v[234:235], v18 offset:43008
    buffer_load_dwordx4 v[200:203], v21, s[20:23], s30 offen offset:2048
    s_waitcnt lgkmcnt(8)
    v_mfma_f32_32x32x16_bf16 v[64:79], v[248:251], v[164:167], v[64:79]
    ds_read_b64_tr_b16 v[236:237], v19 offset:40960
    ds_read_b64_tr_b16 v[238:239], v19 offset:43008
    buffer_load_dwordx4 v[204:207], v21, s[20:23], s30 offen offset:3072
    s_waitcnt lgkmcnt(8)
    v_mfma_f32_32x32x16_bf16 v[80:95], v[252:255], v[164:167], v[80:95]
    ds_read_b64_tr_b16 v[240:241], v16 offset:45056
    ds_read_b64_tr_b16 v[242:243], v16 offset:47104
    s_add_u32 s30, s30, 4096
    buffer_load_dwordx4 v[208:211], v21, s[20:23], s30 offen offset:0
    s_waitcnt lgkmcnt(8)
    v_mfma_f32_32x32x16_bf16 v[32:47], v[224:227], v[168:171], v[32:47]
    ds_read_b64_tr_b16 v[244:245], v17 offset:45056
    ds_read_b64_tr_b16 v[246:247], v17 offset:47104
    buffer_load_dwordx4 v[212:215], v21, s[20:23], s30 offen offset:1024
    s_waitcnt lgkmcnt(8)
    v_mfma_f32_32x32x16_bf16 v[48:63], v[228:231], v[168:171], v[48:63]
    ds_read_b64_tr_b16 v[248:249], v18 offset:45056
    ds_read_b64_tr_b16 v[250:251], v18 offset:47104
    buffer_load_dwordx4 v[216:219], v21, s[20:23], s30 offen offset:2048
    s_waitcnt lgkmcnt(8)
    v_mfma_f32_32x32x16_bf16 v[64:79], v[232:235], v[168:171], v[64:79]
    ds_read_b64_tr_b16 v[252:253], v19 offset:45056
    ds_read_b64_tr_b16 v[254:255], v19 offset:47104
    buffer_load_dwordx4 v[220:223], v21, s[20:23], s30 offen offset:3072
    s_waitcnt lgkmcnt(8)
    v_mfma_f32_32x32x16_bf16 v[80:95], v[236:239], v[168:171], v[80:95]
    ds_read_b64_tr_b16 v[224:225], v16 offset:0
    ds_read_b64_tr_b16 v[226:227], v16 offset:2048
    s_add_u32 m0, s29, 147456
    s_add_u32 s30, s35, 3
    s_and_b32 s30, s30, 3
    s_lshl_b32 s30, s30, 18
    s_add_u32 s30, s30, 196608
    buffer_load_dwordx4 v3, s[16:19], s30 offen offset:0 nt lds
    s_waitcnt lgkmcnt(8)
    v_mfma_f32_32x32x16_bf16 v[32:47], v[240:243], v[172:175], v[32:47]
    ds_read_b64_tr_b16 v[228:229], v17 offset:0
    ds_read_b64_tr_b16 v[230:231], v17 offset:2048
    s_add_u32 s30, s30, 3072
    buffer_load_dwordx4 v3, s[16:19], s30 offen offset:1024 nt lds
    s_waitcnt lgkmcnt(8)
    v_mfma_f32_32x32x16_bf16 v[48:63], v[244:247], v[172:175], v[48:63]
    ds_read_b64_tr_b16 v[232:233], v18 offset:0
    ds_read_b64_tr_b16 v[234:235], v18 offset:2048
    s_add_u32 s30, s30, 3072
    buffer_load_dwordx4 v3, s[16:19], s30 offen offset:2048 nt lds
    s_waitcnt lgkmcnt(8)
    v_mfma_f32_32x32x16_bf16 v[64:79], v[248:251], v[172:175], v[64:79]
    ds_read_b64_tr_b16 v[236:237], v19 offset:0
    ds_read_b64_tr_b16 v[238:239], v19 offset:2048
    s_add_u32 s30, s30, 3072
    buffer_load_dwordx4 v3, s[16:19], s30 offen offset:3072 nt lds
    s_waitcnt lgkmcnt(8)
    v_mfma_f32_32x32x16_bf16 v[80:95], v[252:255], v[172:175], v[80:95]
    ds_read_b64_tr_b16 v[240:241], v16 offset:4096
    ds_read_b64_tr_b16 v[242:243], v16 offset:6144
    s_add_u32 m0, s29, 114688
    s_add_u32 s30, s35, 0
    s_and_b32 s30, s30, 3
    s_lshl_b32 s30, s30, 18
    s_add_u32 s30, s30, 0
    buffer_load_dwordx4 v3, s[16:19], s30 offen offset:0 nt lds
    s_waitcnt vmcnt(13)
    s_waitcnt lgkmcnt(8)
    v_mfma_f32_32x32x16_bf16 v[32:47], v[224:227], v[176:179], v[32:47]
    ds_read_b64_tr_b16 v[244:245], v17 offset:4096
    ds_read_b64_tr_b16 v[246:247], v17 offset:6144
    s_add_u32 s30, s30, 3072
    buffer_load_dwordx4 v3, s[16:19], s30 offen offset:1024 nt lds
    s_waitcnt lgkmcnt(8)
    v_mfma_f32_32x32x16_bf16 v[48:63], v[228:231], v[176:179], v[48:63]
    ds_read_b64_tr_b16 v[248:249], v18 offset:4096
    ds_read_b64_tr_b16 v[250:251], v18 offset:6144
    s_add_u32 s30, s30, 3072
    buffer_load_dwordx4 v3, s[16:19], s30 offen offset:2048 nt lds
    s_waitcnt lgkmcnt(8)
    v_mfma_f32_32x32x16_bf16 v[64:79], v[232:235], v[176:179], v[64:79]
    ds_read_b64_tr_b16 v[252:253], v19 offset:4096
    ds_read_b64_tr_b16 v[254:255], v19 offset:6144
    s_add_u32 s30, s30, 3072
    buffer_load_dwordx4 v3, s[16:19], s30 offen offset:3072 nt lds
    s_waitcnt lgkmcnt(8)
    v_mfma_f32_32x32x16_bf16 v[80:95], v[236:239], v[176:179], v[80:95]
    ds_read_b64_tr_b16 v[224:225], v16 offset:8192
    ds_read_b64_tr_b16 v[226:227], v16 offset:10240
    s_add_u32 m0, s29, 81920
    s_add_u32 s30, s35, 0
    s_and_b32 s30, s30, 3
    s_lshl_b32 s30, s30, 18
    s_add_u32 s30, s30, 65536
    buffer_load_dwordx4 v3, s[16:19], s30 offen offset:0 nt lds
    s_waitcnt lgkmcnt(8)
    v_mfma_f32_32x32x16_bf16 v[32:47], v[240:243], v[180:183], v[32:47]
    ds_read_b64_tr_b16 v[228:229], v17 offset:8192
    ds_read_b64_tr_b16 v[230:231], v17 offset:10240
    s_add_u32 s30, s30, 3072
    buffer_load_dwordx4 v3, s[16:19], s30 offen offset:1024 nt lds
    s_waitcnt lgkmcnt(8)
    v_mfma_f32_32x32x16_bf16 v[48:63], v[244:247], v[180:183], v[48:63]
    ds_read_b64_tr_b16 v[232:233], v18 offset:8192
    ds_read_b64_tr_b16 v[234:235], v18 offset:10240
    s_add_u32 s30, s30, 3072
    buffer_load_dwordx4 v3, s[16:19], s30 offen offset:2048 nt lds
    s_waitcnt lgkmcnt(8)
    v_mfma_f32_32x32x16_bf16 v[64:79], v[248:251], v[180:183], v[64:79]
    ds_read_b64_tr_b16 v[236:237], v19 offset:8192
    ds_read_b64_tr_b16 v[238:239], v19 offset:10240
    s_add_u32 s30, s30, 3072
    buffer_load_dwordx4 v3, s[16:19], s30 offen offset:3072 nt lds
    s_waitcnt lgkmcnt(8)
    v_mfma_f32_32x32x16_bf16 v[80:95], v[252:255], v[180:183], v[80:95]
    ds_read_b64_tr_b16 v[240:241], v16 offset:12288
    ds_read_b64_tr_b16 v[242:243], v16 offset:14336
    s_add_u32 m0, s29, 0
    s_add_u32 s30, s35, 1
    s_and_b32 s30, s30, 3
    s_lshl_b32 s30, s30, 18
    s_add_u32 s30, s30, 0
    buffer_load_dwordx4 v3, s[16:19], s30 offen offset:0 nt lds
    s_waitcnt lgkmcnt(8)
    v_mfma_f32_32x32x16_bf16 v[32:47], v[224:227], v[184:187], v[32:47]
    ds_read_b64_tr_b16 v[244:245], v17 offset:12288
    ds_read_b64_tr_b16 v[246:247], v17 offset:14336
    s_add_u32 s30, s30, 3072
    buffer_load_dwordx4 v3, s[16:19], s30 offen offset:1024 nt lds
    s_waitcnt lgkmcnt(8)
    v_mfma_f32_32x32x16_bf16 v[48:63], v[228:231], v[184:187], v[48:63]
    ds_read_b64_tr_b16 v[248:249], v18 offset:12288
    ds_read_b64_tr_b16 v[250:251], v18 offset:14336
    s_add_u32 s30, s30, 3072
    buffer_load_dwordx4 v3, s[16:19], s30 offen offset:2048 nt lds
    s_waitcnt lgkmcnt(8)
    v_mfma_f32_32x32x16_bf16 v[64:79], v[232:235], v[184:187], v[64:79]
    ds_read_b64_tr_b16 v[252:253], v19 offset:12288
    ds_read_b64_tr_b16 v[254:255], v19 offset:14336
    s_add_u32 s30, s30, 3072
    buffer_load_dwordx4 v3, s[16:19], s30 offen offset:3072 nt lds
    s_waitcnt lgkmcnt(8)
    v_mfma_f32_32x32x16_bf16 v[80:95], v[236:239], v[184:187], v[80:95]
    s_waitcnt lgkmcnt(6)
    v_mfma_f32_32x32x16_bf16 v[32:47], v[240:243], v[188:191], v[32:47]
    s_waitcnt lgkmcnt(4)
    v_mfma_f32_32x32x16_bf16 v[48:63], v[244:247], v[188:191], v[48:63]
    s_waitcnt lgkmcnt(2)
    v_mfma_f32_32x32x16_bf16 v[64:79], v[248:251], v[188:191], v[64:79]
    s_waitcnt lgkmcnt(0)
    v_mfma_f32_32x32x16_bf16 v[80:95], v[252:255], v[188:191], v[80:95]
    s_waitcnt vmcnt(12)
    s_barrier
    ds_read_b64_tr_b16 v[224:225], v12 offset:0
    ds_read_b64_tr_b16 v[226:227], v12 offset:2048
    ds_read_b64_tr_b16 v[228:229], v13 offset:0
    ds_read_b64_tr_b16 v[230:231], v13 offset:2048
    ds_read_b64_tr_b16 v[232:233], v14 offset:0
    ds_read_b64_tr_b16 v[234:235], v14 offset:2048
    ds_read_b64_tr_b16 v[236:237], v15 offset:0
    ds_read_b64_tr_b16 v[238:239], v15 offset:2048
    ds_read_b64_tr_b16 v[240:241], v12 offset:4096
    ds_read_b64_tr_b16 v[242:243], v12 offset:6144
    s_waitcnt lgkmcnt(8)
    v_mfma_f32_32x32x16_bf16 v[32:47], v[224:227], v[192:195], v[32:47]
    ds_read_b64_tr_b16 v[244:245], v13 offset:4096
    ds_read_b64_tr_b16 v[246:247], v13 offset:6144
    s_waitcnt lgkmcnt(8)
    v_mfma_f32_32x32x16_bf16 v[48:63], v[228:231], v[192:195], v[48:63]
    ds_read_b64_tr_b16 v[248:249], v14 offset:4096
    ds_read_b64_tr_b16 v[250:251], v14 offset:6144
    s_waitcnt lgkmcnt(8)
    v_mfma_f32_32x32x16_bf16 v[64:79], v[232:235], v[192:195], v[64:79]
    ds_read_b64_tr_b16 v[252:253], v15 offset:4096
    ds_read_b64_tr_b16 v[254:255], v15 offset:6144
    s_waitcnt lgkmcnt(8)
    v_mfma_f32_32x32x16_bf16 v[80:95], v[236:239], v[192:195], v[80:95]
    ds_read_b64_tr_b16 v[224:225], v12 offset:8192
    ds_read_b64_tr_b16 v[226:227], v12 offset:10240
    s_add_u32 m0, s29, 131072
    s_add_u32 s30, s35, 1
    s_and_b32 s30, s30, 3
    s_lshl_b32 s30, s30, 18
    s_add_u32 s30, s30, 65536
    buffer_load_dwordx4 v3, s[16:19], s30 offen offset:0 nt lds
    s_waitcnt lgkmcnt(8)
    v_mfma_f32_32x32x16_bf16 v[32:47], v[240:243], v[196:199], v[32:47]
    ds_read_b64_tr_b16 v[228:229], v13 offset:8192
    ds_read_b64_tr_b16 v[230:231], v13 offset:10240
    s_add_u32 s30, s30, 3072
    buffer_load_dwordx4 v3, s[16:19], s30 offen offset:1024 nt lds
    s_waitcnt lgkmcnt(8)
    v_mfma_f32_32x32x16_bf16 v[48:63], v[244:247], v[196:199], v[48:63]
    ds_read_b64_tr_b16 v[232:233], v14 offset:8192
    ds_read_b64_tr_b16 v[234:235], v14 offset:10240
    s_add_u32 s30, s30, 3072
    buffer_load_dwordx4 v3, s[16:19], s30 offen offset:2048 nt lds
    s_waitcnt lgkmcnt(8)
    v_mfma_f32_32x32x16_bf16 v[64:79], v[248:251], v[196:199], v[64:79]
    ds_read_b64_tr_b16 v[236:237], v15 offset:8192
    ds_read_b64_tr_b16 v[238:239], v15 offset:10240
    s_add_u32 s30, s30, 3072
    buffer_load_dwordx4 v3, s[16:19], s30 offen offset:3072 nt lds
    s_waitcnt lgkmcnt(8)
    v_mfma_f32_32x32x16_bf16 v[80:95], v[252:255], v[196:199], v[80:95]
    ds_read_b64_tr_b16 v[240:241], v12 offset:12288
    ds_read_b64_tr_b16 v[242:243], v12 offset:14336
    s_add_u32 m0, s29, 98304
    s_add_u32 s30, s35, 3
    s_and_b32 s30, s30, 3
    s_lshl_b32 s30, s30, 18
    s_add_u32 s30, s30, 0
    buffer_load_dwordx4 v3, s[16:19], s30 offen offset:0 nt lds
    s_waitcnt lgkmcnt(8)
    v_mfma_f32_32x32x16_bf16 v[32:47], v[224:227], v[200:203], v[32:47]
    ds_read_b64_tr_b16 v[244:245], v13 offset:12288
    ds_read_b64_tr_b16 v[246:247], v13 offset:14336
    s_add_u32 s30, s30, 3072
    buffer_load_dwordx4 v3, s[16:19], s30 offen offset:1024 nt lds
    s_waitcnt lgkmcnt(8)
    v_mfma_f32_32x32x16_bf16 v[48:63], v[228:231], v[200:203], v[48:63]
    ds_read_b64_tr_b16 v[248:249], v14 offset:12288
    ds_read_b64_tr_b16 v[250:251], v14 offset:14336
    s_add_u32 s30, s30, 3072
    buffer_load_dwordx4 v3, s[16:19], s30 offen offset:2048 nt lds
    s_waitcnt lgkmcnt(8)
    v_mfma_f32_32x32x16_bf16 v[64:79], v[232:235], v[200:203], v[64:79]
    ds_read_b64_tr_b16 v[252:253], v15 offset:12288
    ds_read_b64_tr_b16 v[254:255], v15 offset:14336
    s_add_u32 s30, s30, 3072
    buffer_load_dwordx4 v3, s[16:19], s30 offen offset:3072 nt lds
    s_waitcnt lgkmcnt(8)
    v_mfma_f32_32x32x16_bf16 v[80:95], v[236:239], v[200:203], v[80:95]
    ds_read_b64_tr_b16 v[224:225], v16 offset:49152
    ds_read_b64_tr_b16 v[226:227], v16 offset:51200
    s_waitcnt lgkmcnt(8)
    v_mfma_f32_32x32x16_bf16 v[32:47], v[240:243], v[204:207], v[32:47]
    ds_read_b64_tr_b16 v[228:229], v17 offset:49152
    ds_read_b64_tr_b16 v[230:231], v17 offset:51200
    s_waitcnt lgkmcnt(8)
    v_mfma_f32_32x32x16_bf16 v[48:63], v[244:247], v[204:207], v[48:63]
    ds_read_b64_tr_b16 v[232:233], v18 offset:49152
    ds_read_b64_tr_b16 v[234:235], v18 offset:51200
    s_waitcnt lgkmcnt(8)
    v_mfma_f32_32x32x16_bf16 v[64:79], v[248:251], v[204:207], v[64:79]
    ds_read_b64_tr_b16 v[236:237], v19 offset:49152
    ds_read_b64_tr_b16 v[238:239], v19 offset:51200
    s_waitcnt lgkmcnt(8)
    v_mfma_f32_32x32x16_bf16 v[80:95], v[252:255], v[204:207], v[80:95]
    ds_read_b64_tr_b16 v[240:241], v16 offset:53248
    ds_read_b64_tr_b16 v[242:243], v16 offset:55296
    s_waitcnt lgkmcnt(8)
    v_mfma_f32_32x32x16_bf16 v[32:47], v[224:227], v[208:211], v[32:47]
    ds_read_b64_tr_b16 v[244:245], v17 offset:53248
    ds_read_b64_tr_b16 v[246:247], v17 offset:55296
    s_waitcnt lgkmcnt(8)
    v_mfma_f32_32x32x16_bf16 v[48:63], v[228:231], v[208:211], v[48:63]
    ds_read_b64_tr_b16 v[248:249], v18 offset:53248
    ds_read_b64_tr_b16 v[250:251], v18 offset:55296
    s_waitcnt lgkmcnt(8)
    v_mfma_f32_32x32x16_bf16 v[64:79], v[232:235], v[208:211], v[64:79]
    ds_read_b64_tr_b16 v[252:253], v19 offset:53248
    ds_read_b64_tr_b16 v[254:255], v19 offset:55296
    s_waitcnt lgkmcnt(8)
    v_mfma_f32_32x32x16_bf16 v[80:95], v[236:239], v[208:211], v[80:95]
    ds_read_b64_tr_b16 v[224:225], v16 offset:57344
    ds_read_b64_tr_b16 v[226:227], v16 offset:59392
    s_waitcnt lgkmcnt(8)
    v_mfma_f32_32x32x16_bf16 v[32:47], v[240:243], v[212:215], v[32:47]
    ds_read_b64_tr_b16 v[228:229], v17 offset:57344
    ds_read_b64_tr_b16 v[230:231], v17 offset:59392
    s_waitcnt lgkmcnt(8)
    v_mfma_f32_32x32x16_bf16 v[48:63], v[244:247], v[212:215], v[48:63]
    ds_read_b64_tr_b16 v[232:233], v18 offset:57344
    ds_read_b64_tr_b16 v[234:235], v18 offset:59392
    s_waitcnt lgkmcnt(8)
    v_mfma_f32_32x32x16_bf16 v[64:79], v[248:251], v[212:215], v[64:79]
    ds_read_b64_tr_b16 v[236:237], v19 offset:57344
    ds_read_b64_tr_b16 v[238:239], v19 offset:59392
    s_waitcnt lgkmcnt(8)
    v_mfma_f32_32x32x16_bf16 v[80:95], v[252:255], v[212:215], v[80:95]
    ds_read_b64_tr_b16 v[240:241], v16 offset:61440
    ds_read_b64_tr_b16 v[242:243], v16 offset:63488
    s_waitcnt lgkmcnt(8)
    v_mfma_f32_32x32x16_bf16 v[32:47], v[224:227], v[216:219], v[32:47]
    ds_read_b64_tr_b16 v[244:245], v17 offset:61440
    ds_read_b64_tr_b16 v[246:247], v17 offset:63488
    s_waitcnt lgkmcnt(8)
    v_mfma_f32_32x32x16_bf16 v[48:63], v[228:231], v[216:219], v[48:63]
    ds_read_b64_tr_b16 v[248:249], v18 offset:61440
    ds_read_b64_tr_b16 v[250:251], v18 offset:63488
    s_waitcnt lgkmcnt(8)
    v_mfma_f32_32x32x16_bf16 v[64:79], v[232:235], v[216:219], v[64:79]
    ds_read_b64_tr_b16 v[252:253], v19 offset:61440
    ds_read_b64_tr_b16 v[254:255], v19 offset:63488
    s_waitcnt lgkmcnt(8)
    v_mfma_f32_32x32x16_bf16 v[80:95], v[236:239], v[216:219], v[80:95]
    s_waitcnt lgkmcnt(6)
    v_mfma_f32_32x32x16_bf16 v[32:47], v[240:243], v[220:223], v[32:47]
    s_waitcnt lgkmcnt(4)
    v_mfma_f32_32x32x16_bf16 v[48:63], v[244:247], v[220:223], v[48:63]
    s_waitcnt lgkmcnt(2)
    v_mfma_f32_32x32x16_bf16 v[64:79], v[248:251], v[220:223], v[64:79]
    s_waitcnt lgkmcnt(0)
    v_mfma_f32_32x32x16_bf16 v[80:95], v[252:255], v[220:223], v[80:95]
    s_waitcnt vmcnt(12)
    s_barrier
    v_subrev_u32 v25, 114688, v22
    ds_read_b128 v[96:99], v25 offset:16384
    ds_read_b128 v[100:103], v25 offset:17408
    ds_read_b128 v[104:107], v25 offset:18432
    ds_read_b128 v[108:111], v25 offset:19456
    ds_read_b128 v[112:115], v25 offset:32768
    ds_read_b128 v[116:119], v25 offset:33792
    ds_read_b128 v[120:123], v25 offset:34816
    ds_read_b128 v[124:127], v25 offset:35840
    ds_read_b64_tr_b16 v[224:225], v16 offset:16384
    ds_read_b64_tr_b16 v[226:227], v16 offset:18432
    ds_read_b64_tr_b16 v[228:229], v17 offset:16384
    ds_read_b64_tr_b16 v[230:231], v17 offset:18432
    ds_read_b64_tr_b16 v[232:233], v18 offset:16384
    ds_read_b64_tr_b16 v[234:235], v18 offset:18432
    ds_read_b64_tr_b16 v[236:237], v19 offset:16384
    ds_read_b64_tr_b16 v[238:239], v19 offset:18432
    ds_read_b64_tr_b16 v[240:241], v16 offset:20480
    ds_read_b64_tr_b16 v[242:243], v16 offset:22528
    s_waitcnt lgkmcnt(8)
    v_mfma_f32_32x32x16_bf16 v[32:47], v[224:227], v[96:99], v[32:47]
    ds_read_b64_tr_b16 v[244:245], v17 offset:20480
    ds_read_b64_tr_b16 v[246:247], v17 offset:22528
    s_waitcnt lgkmcnt(8)
    v_mfma_f32_32x32x16_bf16 v[48:63], v[228:231], v[96:99], v[48:63]
    ds_read_b64_tr_b16 v[248:249], v18 offset:20480
    ds_read_b64_tr_b16 v[250:251], v18 offset:22528
    s_waitcnt lgkmcnt(8)
    v_mfma_f32_32x32x16_bf16 v[64:79], v[232:235], v[96:99], v[64:79]
    ds_read_b64_tr_b16 v[252:253], v19 offset:20480
    ds_read_b64_tr_b16 v[254:255], v19 offset:22528
    s_waitcnt lgkmcnt(8)
    v_mfma_f32_32x32x16_bf16 v[80:95], v[236:239], v[96:99], v[80:95]
    ds_read_b64_tr_b16 v[224:225], v16 offset:24576
    ds_read_b64_tr_b16 v[226:227], v16 offset:26624
    s_add_u32 m0, s29, 147456
    s_add_u32 s30, s35, 2
    s_and_b32 s30, s30, 3
    s_lshl_b32 s30, s30, 18
    s_add_u32 s30, s30, 0
    buffer_load_dwordx4 v3, s[16:19], s30 offen offset:0 nt lds
    s_waitcnt lgkmcnt(8)
    v_mfma_f32_32x32x16_bf16 v[32:47], v[240:243], v[100:103], v[32:47]
    ds_read_b64_tr_b16 v[228:229], v17 offset:24576
    ds_read_b64_tr_b16 v[230:231], v17 offset:26624
    s_add_u32 s30, s30, 3072
    buffer_load_dwordx4 v3, s[16:19], s30 offen offset:1024 nt lds
    s_waitcnt lgkmcnt(8)
    v_mfma_f32_32x32x16_bf16 v[48:63], v[244:247], v[100:103], v[48:63]
    ds_read_b64_tr_b16 v[232:233], v18 offset:24576
    ds_read_b64_tr_b16 v[234:235], v18 offset:26624
    s_add_u32 s30, s30, 3072
    buffer_load_dwordx4 v3, s[16:19], s30 offen offset:2048 nt lds
    s_waitcnt lgkmcnt(8)
    v_mfma_f32_32x32x16_bf16 v[64:79], v[248:251], v[100:103], v[64:79]
    ds_read_b64_tr_b16 v[236:237], v19 offset:24576
    ds_read_b64_tr_b16 v[238:239], v19 offset:26624
    s_add_u32 s30, s30, 3072
    buffer_load_dwordx4 v3, s[16:19], s30 offen offset:3072 nt lds
    s_waitcnt lgkmcnt(8)
    v_mfma_f32_32x32x16_bf16 v[80:95], v[252:255], v[100:103], v[80:95]
    ds_read_b64_tr_b16 v[240:241], v16 offset:28672
    ds_read_b64_tr_b16 v[242:243], v16 offset:30720
    s_add_u32 m0, s29, 49152
    s_add_u32 s30, s35, 2
    s_and_b32 s30, s30, 3
    s_lshl_b32 s30, s30, 18
    s_add_u32 s30, s30, 65536
    buffer_load_dwordx4 v3, s[16:19], s30 offen offset:0 nt lds
    s_waitcnt lgkmcnt(8)
    v_mfma_f32_32x32x16_bf16 v[32:47], v[224:227], v[104:107], v[32:47]
    ds_read_b64_tr_b16 v[244:245], v17 offset:28672
    ds_read_b64_tr_b16 v[246:247], v17 offset:30720
    s_add_u32 s30, s30, 3072
    buffer_load_dwordx4 v3, s[16:19], s30 offen offset:1024 nt lds
    s_waitcnt lgkmcnt(8)
    v_mfma_f32_32x32x16_bf16 v[48:63], v[228:231], v[104:107], v[48:63]
    ds_read_b64_tr_b16 v[248:249], v18 offset:28672
    ds_read_b64_tr_b16 v[250:251], v18 offset:30720
    s_add_u32 s30, s30, 3072
    buffer_load_dwordx4 v3, s[16:19], s30 offen offset:2048 nt lds
    s_waitcnt lgkmcnt(8)
    v_mfma_f32_32x32x16_bf16 v[64:79], v[232:235], v[104:107], v[64:79]
    ds_read_b64_tr_b16 v[252:253], v19 offset:28672
    ds_read_b64_tr_b16 v[254:255], v19 offset:30720
    s_add_u32 s30, s30, 3072
    buffer_load_dwordx4 v3, s[16:19], s30 offen offset:3072 nt lds
    s_waitcnt lgkmcnt(8)
    v_mfma_f32_32x32x16_bf16 v[80:95], v[236:239], v[104:107], v[80:95]
    ds_read_b64_tr_b16 v[224:225], v12 offset:16384
    ds_read_b64_tr_b16 v[226:227], v12 offset:18432
    s_add_u32 m0, s29, 65536
    s_add_u32 s30, s35, 3
    s_and_b32 s30, s30, 3
    s_lshl_b32 s30, s30, 18
    s_add_u32 s30, s30, 65536
    buffer_load_dwordx4 v3, s[16:19], s30 offen offset:0 nt lds
    s_waitcnt lgkmcnt(8)
    v_mfma_f32_32x32x16_bf16 v[32:47], v[240:243], v[108:111], v[32:47]
    ds_read_b64_tr_b16 v[228:229], v13 offset:16384
    ds_read_b64_tr_b16 v[230:231], v13 offset:18432
    s_add_u32 s30, s30, 3072
    buffer_load_dwordx4 v3, s[16:19], s30 offen offset:1024 nt lds
    s_waitcnt lgkmcnt(8)
    v_mfma_f32_32x32x16_bf16 v[48:63], v[244:247], v[108:111], v[48:63]
    ds_read_b64_tr_b16 v[232:233], v14 offset:16384
    ds_read_b64_tr_b16 v[234:235], v14 offset:18432
    s_add_u32 s30, s30, 3072
    buffer_load_dwordx4 v3, s[16:19], s30 offen offset:2048 nt lds
    s_waitcnt lgkmcnt(8)
    v_mfma_f32_32x32x16_bf16 v[64:79], v[248:251], v[108:111], v[64:79]
    ds_read_b64_tr_b16 v[236:237], v15 offset:16384
    ds_read_b64_tr_b16 v[238:239], v15 offset:18432
    s_add_u32 s30, s30, 3072
    buffer_load_dwordx4 v3, s[16:19], s30 offen offset:3072 nt lds
    s_waitcnt lgkmcnt(8)
    v_mfma_f32_32x32x16_bf16 v[80:95], v[252:255], v[108:111], v[80:95]
    ds_read_b64_tr_b16 v[240:241], v12 offset:20480
    ds_read_b64_tr_b16 v[242:243], v12 offset:22528
    s_waitcnt lgkmcnt(8)
    v_mfma_f32_32x32x16_bf16 v[32:47], v[224:227], v[112:115], v[32:47]
    ds_read_b64_tr_b16 v[244:245], v13 offset:20480
    ds_read_b64_tr_b16 v[246:247], v13 offset:22528
    s_waitcnt lgkmcnt(8)
    v_mfma_f32_32x32x16_bf16 v[48:63], v[228:231], v[112:115], v[48:63]
    ds_read_b64_tr_b16 v[248:249], v14 offset:20480
    ds_read_b64_tr_b16 v[250:251], v14 offset:22528
    s_waitcnt lgkmcnt(8)
    v_mfma_f32_32x32x16_bf16 v[64:79], v[232:235], v[112:115], v[64:79]
    ds_read_b64_tr_b16 v[252:253], v15 offset:20480
    ds_read_b64_tr_b16 v[254:255], v15 offset:22528
    s_waitcnt lgkmcnt(8)
    v_mfma_f32_32x32x16_bf16 v[80:95], v[236:239], v[112:115], v[80:95]
    ds_read_b64_tr_b16 v[224:225], v12 offset:24576
    ds_read_b64_tr_b16 v[226:227], v12 offset:26624
    s_waitcnt lgkmcnt(8)
    v_mfma_f32_32x32x16_bf16 v[32:47], v[240:243], v[116:119], v[32:47]
    ds_read_b64_tr_b16 v[228:229], v13 offset:24576
    ds_read_b64_tr_b16 v[230:231], v13 offset:26624
    s_waitcnt lgkmcnt(8)
    v_mfma_f32_32x32x16_bf16 v[48:63], v[244:247], v[116:119], v[48:63]
    ds_read_b64_tr_b16 v[232:233], v14 offset:24576
    ds_read_b64_tr_b16 v[234:235], v14 offset:26624
    s_waitcnt lgkmcnt(8)
    v_mfma_f32_32x32x16_bf16 v[64:79], v[248:251], v[116:119], v[64:79]
    ds_read_b64_tr_b16 v[236:237], v15 offset:24576
    ds_read_b64_tr_b16 v[238:239], v15 offset:26624
    s_waitcnt lgkmcnt(8)
    v_mfma_f32_32x32x16_bf16 v[80:95], v[252:255], v[116:119], v[80:95]
    ds_read_b64_tr_b16 v[240:241], v12 offset:28672
    ds_read_b64_tr_b16 v[242:243], v12 offset:30720
    s_waitcnt lgkmcnt(8)
    v_mfma_f32_32x32x16_bf16 v[32:47], v[224:227], v[120:123], v[32:47]
    ds_read_b64_tr_b16 v[244:245], v13 offset:28672
    ds_read_b64_tr_b16 v[246:247], v13 offset:30720
    s_waitcnt lgkmcnt(8)
    v_mfma_f32_32x32x16_bf16 v[48:63], v[228:231], v[120:123], v[48:63]
    ds_read_b64_tr_b16 v[248:249], v14 offset:28672
    ds_read_b64_tr_b16 v[250:251], v14 offset:30720
    s_waitcnt lgkmcnt(8)
    v_mfma_f32_32x32x16_bf16 v[64:79], v[232:235], v[120:123], v[64:79]
    ds_read_b64_tr_b16 v[252:253], v15 offset:28672
    ds_read_b64_tr_b16 v[254:255], v15 offset:30720
    s_waitcnt lgkmcnt(8)
    v_mfma_f32_32x32x16_bf16 v[80:95], v[236:239], v[120:123], v[80:95]
    s_waitcnt lgkmcnt(6)
    v_mfma_f32_32x32x16_bf16 v[32:47], v[240:243], v[124:127], v[32:47]
    s_waitcnt lgkmcnt(4)
    v_mfma_f32_32x32x16_bf16 v[48:63], v[244:247], v[124:127], v[48:63]
    s_waitcnt lgkmcnt(2)
    v_mfma_f32_32x32x16_bf16 v[64:79], v[248:251], v[124:127], v[64:79]
    s_waitcnt lgkmcnt(0)
    v_mfma_f32_32x32x16_bf16 v[80:95], v[252:255], v[124:127], v[80:95]
    s_waitcnt vmcnt(0)
    s_barrier
    v_mov_b32 v23, 512
    s_mov_b32 s31, 20000
    s_lshl_b32 s30, s28, 7
FB_L:
    buffer_load_dwordx4 v[128:131], v23, s[24:27], s30 offen sc1
    s_waitcnt vmcnt(0)
    v_xor_b32 v128, s89, v128
    v_xor_b32 v129, s89, v129
    v_xor_b32 v130, s89, v130
    v_xor_b32 v131, s89, v131
    v_or3_b32 v128, v128, v129, v130
    v_or_b32 v128, v128, v131
    s_nop 0
    v_readfirstlane_b32 s51, v128
    s_cmp_eq_u32 s51, 0
    s_cbranch_scc1 FB_X
    s_sub_u32 s31, s31, 1
    s_cmp_eq_u32 s31, 0
    s_cbranch_scc0 FB_L
FB_X:
    s_add_u32 s30, s35, 1
    s_and_b32 s30, s30, 3
    s_lshl_b32 s30, s30, 16
    buffer_load_dwordx4 v[128:131], v21, s[20:23], s30 offen offset:0
    buffer_load_dwordx4 v[132:135], v21, s[20:23], s30 offen offset:1024
    buffer_load_dwordx4 v[136:139], v21, s[20:23], s30 offen offset:2048
    buffer_load_dwordx4 v[140:143], v21, s[20:23], s30 offen offset:3072
    s_add_u32 s30, s30, 4096
    buffer_load_dwordx4 v[144:147], v21, s[20:23], s30 offen offset:0
    buffer_load_dwordx4 v[148:151], v21, s[20:23], s30 offen offset:1024
    buffer_load_dwordx4 v[152:155], v21, s[20:23], s30 offen offset:2048
    buffer_load_dwordx4 v[156:159], v21, s[20:23], s30 offen offset:3072
    s_add_u32 s30, s35, 2
    s_and_b32 s30, s30, 3
    s_lshl_b32 s30, s30, 16
    buffer_load_dwordx4 v[160:163], v21, s[20:23], s30 offen offset:0
    buffer_load_dwordx4 v[164:167], v21, s[20:23], s30 offen offset:1024
    buffer_load_dwordx4 v[168:171], v21, s[20:23], s30 offen offset:2048
    buffer_load_dwordx4 v[172:175], v21, s[20:23], s30 offen offset:3072
    s_add_u32 s30, s30, 4096
    buffer_load_dwordx4 v[176:179], v21, s[20:23], s30 offen offset:0
    buffer_load_dwordx4 v[180:183], v21, s[20:23], s30 offen offset:1024
    buffer_load_dwordx4 v[184:187], v21, s[20:23], s30 offen offset:2048
    buffer_load_dwordx4 v[188:191], v21, s[20:23], s30 offen offset:3072
    s_add_u32 s30, s35, 3
    s_and_b32 s30, s30, 3
    s_lshl_b32 s30, s30, 16
    buffer_load_dwordx4 v[192:195], v21, s[20:23], s30 offen offset:0
    buffer_load_dwordx4 v[196:199], v21, s[20:23], s30 offen offset:1024
    buffer_load_dwordx4 v[200:203], v21, s[20:23], s30 offen offset:2048
    buffer_load_dwordx4 v[204:207], v21, s[20:23], s30 offen offset:3072
    s_add_u32 s30, s30, 4096
    buffer_load_dwordx4 v[208:211], v21, s[20:23], s30 offen offset:0
    buffer_load_dwordx4 v[212:215], v21, s[20:23], s30 offen offset:1024
    buffer_load_dwordx4 v[216:219], v21, s[20:23], s30 offen offset:2048
    buffer_load_dwordx4 v[220:223], v21, s[20:23], s30 offen offset:3072
    ds_read_b64_tr_b16 v[224:225], v8 offset:0
    ds_read_b64_tr_b16 v[226:227], v8 offset:2048
    ds_read_b64_tr_b16 v[228:229], v9 offset:0
    ds_read_b64_tr_b16 v[230:231], v9 offset:2048
    ds_read_b64_tr_b16 v[232:233], v10 offset:0
    ds_read_b64_tr_b16 v[234:235], v10 offset:2048
    ds_read_b64_tr_b16 v[236:237], v11 offset:0
    ds_read_b64_tr_b16 v[238:239], v11 offset:2048
    ds_read_b64_tr_b16 v[240:241], v8 offset:4096
    ds_read_b64_tr_b16 v[242:243], v8 offset:6144
    s_waitcnt vmcnt(20)
    s_waitcnt lgkmcnt(8)
    v_mfma_f32_32x32x16_bf16 v[32:47], v[224:227], v[128:131], v[32:47]
    ds_read_b64_tr_b16 v[244:245], v9 offset:4096
    ds_read_b64_tr_b16 v[246:247], v9 offset:6144
    s_waitcnt lgkmcnt(8)
    v_mfma_f32_32x32x16_bf16 v[48:63], v[228:231], v[128:131], v[48:63]
    ds_read_b64_tr_b16 v[248:249], v10 offset:4096
    ds_read_b64_tr_b16 v[250:251], v10 offset:6144
    s_waitcnt lgkmcnt(8)
    v_mfma_f32_32x32x16_bf16 v[64:79], v[232:235], v[128:131], v[64:79]
    ds_read_b64_tr_b16 v[252:253], v11 offset:4096
    ds_read_b64_tr_b16 v[254:255], v11 offset:6144
    s_waitcnt lgkmcnt(8)
    v_mfma_f32_32x32x16_bf16 v[80:95], v[236:239], v[128:131], v[80:95]
    ds_read_b64_tr_b16 v[224:225], v8 offset:8192
    ds_read_b64_tr_b16 v[226:227], v8 offset:10240
    s_waitcnt lgkmcnt(8)
    v_mfma_f32_32x32x16_bf16 v[32:47], v[240:243], v[132:135], v[32:47]
    ds_read_b64_tr_b16 v[228:229], v9 offset:8192
    ds_read_b64_tr_b16 v[230:231], v9 offset:10240
    s_waitcnt lgkmcnt(8)
    v_mfma_f32_32x32x16_bf16 v[48:63], v[244:247], v[132:135], v[48:63]
    ds_read_b64_tr_b16 v[232:233], v10 offset:8192
    ds_read_b64_tr_b16 v[234:235], v10 offset:10240
    s_waitcnt lgkmcnt(8)
    v_mfma_f32_32x32x16_bf16 v[64:79], v[248:251], v[132:135], v[64:79]
    ds_read_b64_tr_b16 v[236:237], v11 offset:8192
    ds_read_b64_tr_b16 v[238:239], v11 offset:10240
    s_waitcnt lgkmcnt(8)
    v_mfma_f32_32x32x16_bf16 v[80:95], v[252:255], v[132:135], v[80:95]
    ds_read_b64_tr_b16 v[240:241], v8 offset:12288
    ds_read_b64_tr_b16 v[242:243], v8 offset:14336
    s_waitcnt lgkmcnt(8)
    v_mfma_f32_32x32x16_bf16 v[32:47], v[224:227], v[136:139], v[32:47]
    ds_read_b64_tr_b16 v[244:245], v9 offset:12288
    ds_read_b64_tr_b16 v[246:247], v9 offset:14336
    s_waitcnt lgkmcnt(8)
    v_mfma_f32_32x32x16_bf16 v[48:63], v[228:231], v[136:139], v[48:63]
    ds_read_b64_tr_b16 v[248:249], v10 offset:12288
    ds_read_b64_tr_b16 v[250:251], v10 offset:14336
    s_waitcnt lgkmcnt(8)
    v_mfma_f32_32x32x16_bf16 v[64:79], v[232:235], v[136:139], v[64:79]
    ds_read_b64_tr_b16 v[252:253], v11 offset:12288
    ds_read_b64_tr_b16 v[254:255], v11 offset:14336
    s_waitcnt lgkmcnt(8)
    v_mfma_f32_32x32x16_bf16 v[80:95], v[236:239], v[136:139], v[80:95]
    ds_read_b64_tr_b16 v[224:225], v16 offset:32768
    ds_read_b64_tr_b16 v[226:227], v16 offset:34816
    s_waitcnt lgkmcnt(8)
    v_mfma_f32_32x32x16_bf16 v[32:47], v[240:243], v[140:143], v[32:47]
    ds_read_b64_tr_b16 v[228:229], v17 offset:32768
    ds_read_b64_tr_b16 v[230:231], v17 offset:34816
    s_waitcnt lgkmcnt(8)
    v_mfma_f32_32x32x16_bf16 v[48:63], v[244:247], v[140:143], v[48:63]
    ds_read_b64_tr_b16 v[232:233], v18 offset:32768
    ds_read_b64_tr_b16 v[234:235], v18 offset:34816
    s_waitcnt lgkmcnt(8)
    v_mfma_f32_32x32x16_bf16 v[64:79], v[248:251], v[140:143], v[64:79]
    ds_read_b64_tr_b16 v[236:237], v19 offset:32768
    ds_read_b64_tr_b16 v[238:239], v19 offset:34816
    s_waitcnt lgkmcnt(8)
    v_mfma_f32_32x32x16_bf16 v[80:95], v[252:255], v[140:143], v[80:95]
    ds_read_b64_tr_b16 v[240:241], v16 offset:36864
    ds_read_b64_tr_b16 v[242:243], v16 offset:38912
    s_waitcnt vmcnt(16)
    s_waitcnt lgkmcnt(8)
    v_mfma_f32_32x32x16_bf16 v[32:47], v[224:227], v[144:147], v[32:47]
    ds_read_b64_tr_b16 v[244:245], v17 offset:36864
    ds_read_b64_tr_b16 v[246:247], v17 offset:38912
    s_waitcnt lgkmcnt(8)
    v_mfma_f32_32x32x16_bf16 v[48:63], v[228:231], v[144:147], v[48:63]
    ds_read_b64_tr_b16 v[248:249], v18 offset:36864
    ds_read_b64_tr_b16 v[250:251], v18 offset:38912
    s_waitcnt lgkmcnt(8)
    v_mfma_f32_32x32x16_bf16 v[64:79], v[232:235], v[144:147], v[64:79]
    ds_read_b64_tr_b16 v[252:253], v19 offset:36864
    ds_read_b64_tr_b16 v[254:255], v19 offset:38912
    s_waitcnt lgkmcnt(8)
    v_mfma_f32_32x32x16_bf16 v[80:95], v[236:239], v[144:147], v[80:95]
    ds_read_b64_tr_b16 v[224:225], v16 offset:40960
    ds_read_b64_tr_b16 v[226:227], v16 offset:43008
    s_waitcnt lgkmcnt(8)
    v_mfma_f32_32x32x16_bf16 v[32:47], v[240:243], v[148:151], v[32:47]
    ds_read_b64_tr_b16 v[228:229], v17 offset:40960
    ds_read_b64_tr_b16 v[230:231], v17 offset:43008
    s_waitcnt lgkmcnt(8)
    v_mfma_f32_32x32x16_bf16 v[48:63], v[244:247], v[148:151], v[48:63]
    ds_read_b64_tr_b16 v[232:233], v18 offset:40960
    ds_read_b64_tr_b16 v[234:235], v18 offset:43008
    s_waitcnt lgkmcnt(8)
    v_mfma_f32_32x32x16_bf16 v[64:79], v[248:251], v[148:151], v[64:79]
    ds_read_b64_tr_b16 v[236:237], v19 offset:40960
    ds_read_b64_tr_b16 v[238:239], v19 offset:43008
    s_waitcnt lgkmcnt(8)
    v_mfma_f32_32x32x16_bf16 v[80:95], v[252:255], v[148:151], v[80:95]
    ds_read_b64_tr_b16 v[240:241], v16 offset:45056
    ds_read_b64_tr_b16 v[242:243], v16 offset:47104
    s_waitcnt lgkmcnt(8)
    v_mfma_f32_32x32x16_bf16 v[32:47], v[224:227], v[152:155], v[32:47]
    ds_read_b64_tr_b16 v[244:245], v17 offset:45056
    ds_read_b64_tr_b16 v[246:247], v17 offset:47104
    s_waitcnt lgkmcnt(8)
    v_mfma_f32_32x32x16_bf16 v[48:63], v[228:231], v[152:155], v[48:63]
    ds_read_b64_tr_b16 v[248:249], v18 offset:45056
    ds_read_b64_tr_b16 v[250:251], v18 offset:47104
    s_waitcnt lgkmcnt(8)
    v_mfma_f32_32x32x16_bf16 v[64:79], v[232:235], v[152:155], v[64:79]
    ds_read_b64_tr_b16 v[252:253], v19 offset:45056
    ds_read_b64_tr_b16 v[254:255], v19 offset:47104
    s_waitcnt lgkmcnt(8)
    v_mfma_f32_32x32x16_bf16 v[80:95], v[236:239], v[152:155], v[80:95]
    ds_read_b64_tr_b16 v[224:225], v17 offset:49152
    ds_read_b64_tr_b16 v[226:227], v17 offset:51200
    s_waitcnt lgkmcnt(8)
    v_mfma_f32_32x32x16_bf16 v[32:47], v[240:243], v[156:159], v[32:47]
    ds_read_b64_tr_b16 v[228:229], v17 offset:53248
    ds_read_b64_tr_b16 v[230:231], v17 offset:55296
    s_waitcnt lgkmcnt(8)
    v_mfma_f32_32x32x16_bf16 v[48:63], v[244:247], v[156:159], v[48:63]
    ds_read_b64_tr_b16 v[232:233], v17 offset:57344
    ds_read_b64_tr_b16 v[234:235], v17 offset:59392
    s_waitcnt lgkmcnt(8)
    v_mfma_f32_32x32x16_bf16 v[64:79], v[248:251], v[156:159], v[64:79]
    ds_read_b64_tr_b16 v[236:237], v17 offset:61440
    ds_read_b64_tr_b16 v[238:239], v17 offset:63488
    s_waitcnt lgkmcnt(8)
    v_mfma_f32_32x32x16_bf16 v[80:95], v[252:255], v[156:159], v[80:95]
    ds_read_b64_tr_b16 v[240:241], v9 offset:49152
    ds_read_b64_tr_b16 v[242:243], v9 offset:51200
    s_waitcnt vmcnt(0)
    s_waitcnt lgkmcnt(8)
    v_mfma_f32_32x32x16_bf16 v[48:63], v[224:227], v[160:163], v[48:63]
    ds_read_b64_tr_b16 v[244:245], v9 offset:53248
    ds_read_b64_tr_b16 v[246:247], v9 offset:55296
    s_waitcnt lgkmcnt(8)
    v_mfma_f32_32x32x16_bf16 v[48:63], v[228:231], v[164:167], v[48:63]
    ds_read_b64_tr_b16 v[248:249], v9 offset:57344
    ds_read_b64_tr_b16 v[250:251], v9 offset:59392
    s_waitcnt lgkmcnt(8)
    v_mfma_f32_32x32x16_bf16 v[48:63], v[232:235], v[168:171], v[48:63]
    ds_read_b64_tr_b16 v[252:253], v9 offset:61440
    ds_read_b64_tr_b16 v[254:255], v9 offset:63488
    s_waitcnt lgkmcnt(8)
    v_mfma_f32_32x32x16_bf16 v[48:63], v[236:239], v[172:175], v[48:63]
    ds_read_b64_tr_b16 v[224:225], v17 offset:0
    ds_read_b64_tr_b16 v[226:227], v17 offset:2048
    s_waitcnt lgkmcnt(8)
    v_mfma_f32_32x32x16_bf16 v[48:63], v[240:243], v[176:179], v[48:63]
    ds_read_b64_tr_b16 v[228:229], v17 offset:4096
    ds_read_b64_tr_b16 v[230:231], v17 offset:6144
    s_waitcnt lgkmcnt(8)
    v_mfma_f32_32x32x16_bf16 v[48:63], v[244:247], v[180:183], v[48:63]
    ds_read_b64_tr_b16 v[232:233], v17 offset:8192
    ds_read_b64_tr_b16 v[234:235], v17 offset:10240
    s_waitcnt lgkmcnt(8)
    v_mfma_f32_32x32x16_bf16 v[48:63], v[248:251], v[184:187], v[48:63]
    ds_read_b64_tr_b16 v[236:237], v17 offset:12288
    ds_read_b64_tr_b16 v[238:239], v17 offset:14336
    s_waitcnt lgkmcnt(8)
    v_mfma_f32_32x32x16_bf16 v[48:63], v[252:255], v[188:191], v[48:63]
    ds_read_b64_tr_b16 v[240:241], v13 offset:0
    ds_read_b64_tr_b16 v[242:243], v13 offset:2048
    s_waitcnt lgkmcnt(8)
    v_mfma_f32_32x32x16_bf16 v[48:63], v[224:227], v[192:195], v[48:63]
    ds_read_b64_tr_b16 v[244:245], v13 offset:4096
    ds_read_b64_tr_b16 v[246:247], v13 offset:6144
    s_waitcnt lgkmcnt(8)
    v_mfma_f32_32x32x16_bf16 v[48:63], v[228:231], v[196:199], v[48:63]
    ds_read_b64_tr_b16 v[248:249], v13 offset:8192
    ds_read_b64_tr_b16 v[250:251], v13 offset:10240
    s_waitcnt lgkmcnt(8)
    v_mfma_f32_32x32x16_bf16 v[48:63], v[232:235], v[200:203], v[48:63]
    ds_read_b64_tr_b16 v[252:253], v13 offset:12288
    ds_read_b64_tr_b16 v[254:255], v13 offset:14336
    s_waitcnt lgkmcnt(8)
    v_mfma_f32_32x32x16_bf16 v[48:63], v[236:239], v[204:207], v[48:63]
    ds_read_b64_tr_b16 v[224:225], v18 offset:49152
    ds_read_b64_tr_b16 v[226:227], v18 offset:51200
    s_waitcnt lgkmcnt(8)
    v_mfma_f32_32x32x16_bf16 v[48:63], v[240:243], v[208:211], v[48:63]
    ds_read_b64_tr_b16 v[228:229], v18 offset:53248
    ds_read_b64_tr_b16 v[230:231], v18 offset:55296
    s_waitcnt lgkmcnt(8)
    v_mfma_f32_32x32x16_bf16 v[48:63], v[244:247], v[212:215], v[48:63]
    ds_read_b64_tr_b16 v[232:233], v18 offset:57344
    ds_read_b64_tr_b16 v[234:235], v18 offset:59392
    s_waitcnt lgkmcnt(8)
    v_mfma_f32_32x32x16_bf16 v[48:63], v[248:251], v[216:219], v[48:63]
    ds_read_b64_tr_b16 v[236:237], v18 offset:61440
    ds_read_b64_tr_b16 v[238:239], v18 offset:63488
    s_waitcnt lgkmcnt(8)
    v_mfma_f32_32x32x16_bf16 v[48:63], v[252:255], v[220:223], v[48:63]
    ds_read_b64_tr_b16 v[240:241], v10 offset:49152
    ds_read_b64_tr_b16 v[242:243], v10 offset:51200
    s_waitcnt lgkmcnt(8)
    v_mfma_f32_32x32x16_bf16 v[64:79], v[224:227], v[160:163], v[64:79]
    ds_read_b64_tr_b16 v[244:245], v10 offset:53248
    ds_read_b64_tr_b16 v[246:247], v10 offset:55296
    s_waitcnt lgkmcnt(8)
    v_mfma_f32_32x32x16_bf16 v[64:79], v[228:231], v[164:167], v[64:79]
    ds_read_b64_tr_b16 v[248:249], v10 offset:57344
    ds_read_b64_tr_b16 v[250:251], v10 offset:59392
    s_add_u32 s30, s46, 1
    s_and_b32 s30, s30, 3
    s_lshl_b32 s30, s30, 16
    s_add_u32 s30, s30, 16384
    v_cvt_pk_bf16_f32 v96, v48, v49
    v_cvt_pk_bf16_f32 v97, v50, v51
    v_cvt_pk_bf16_f32 v98, v52, v53
    v_mov_b32 v99, s89
    buffer_store_dwordx4 v[96:99], v20, s[68:71], s30 offen offset:0 sc1
    v_cvt_pk_bf16_f32 v100, v54, v55
    v_cvt_pk_bf16_f32 v101, v56, v57
    v_cvt_pk_bf16_f32 v102, v58, v59
    v_mov_b32 v103, s89
    buffer_store_dwordx4 v[100:103], v20, s[68:71], s30 offen offset:1024 sc1
    v_cvt_pk_bf16_f32 v104, v60, v61
    v_cvt_pk_bf16_f32 v105, v62, v63
    v_mov_b32 v106, 0
    v_mov_b32 v107, s89
    buffer_store_dwordx4 v[104:107], v20, s[68:71], s30 offen offset:2048 sc1
    s_waitcnt lgkmcnt(8)
    v_mfma_f32_32x32x16_bf16 v[64:79], v[232:235], v[168:171], v[64:79]
    ds_read_b64_tr_b16 v[252:253], v10 offset:61440
    ds_read_b64_tr_b16 v[254:255], v10 offset:63488
    s_waitcnt lgkmcnt(8)
    v_mfma_f32_32x32x16_bf16 v[64:79], v[236:239], v[172:175], v[64:79]
    ds_read_b64_tr_b16 v[224:225], v18 offset:0
    ds_read_b64_tr_b16 v[226:227], v18 offset:2048
    s_waitcnt lgkmcnt(8)
    v_mfma_f32_32x32x16_bf16 v[64:79], v[240:243], v[176:179], v[64:79]
    ds_read_b64_tr_b16 v[228:229], v18 offset:4096
    ds_read_b64_tr_b16 v[230:231], v18 offset:6144
    s_waitcnt lgkmcnt(8)
    v_mfma_f32_32x32x16_bf16 v[64:79], v[244:247], v[180:183], v[64:79]
    ds_read_b64_tr_b16 v[232:233], v18 offset:8192
    ds_read_b64_tr_b16 v[234:235], v18 offset:10240
    s_waitcnt lgkmcnt(8)
    v_mfma_f32_32x32x16_bf16 v[64:79], v[248:251], v[184:187], v[64:79]
    ds_read_b64_tr_b16 v[236:237], v18 offset:12288
    ds_read_b64_tr_b16 v[238:239], v18 offset:14336
    s_waitcnt lgkmcnt(8)
    v_mfma_f32_32x32x16_bf16 v[64:79], v[252:255], v[188:191], v[64:79]
    ds_read_b64_tr_b16 v[240:241], v14 offset:0
    ds_read_b64_tr_b16 v[242:243], v14 offset:2048
    s_waitcnt lgkmcnt(8)
    v_mfma_f32_32x32x16_bf16 v[64:79], v[224:227], v[192:195], v[64:79]
    ds_read_b64_tr_b16 v[244:245], v14 offset:4096
    ds_read_b64_tr_b16 v[246:247], v14 offset:6144
    s_waitcnt lgkmcnt(8)
    v_mfma_f32_32x32x16_bf16 v[64:79], v[228:231], v[196:199], v[64:79]
    ds_read_b64_tr_b16 v[248:249], v14 offset:8192
    ds_read_b64_tr_b16 v[250:251], v14 offset:10240
    s_waitcnt lgkmcnt(8)
    v_mfma_f32_32x32x16_bf16 v[64:79], v[232:235], v[200:203], v[64:79]
    ds_read_b64_tr_b16 v[252:253], v14 offset:12288
    ds_read_b64_tr_b16 v[254:255], v14 offset:14336
    s_waitcnt lgkmcnt(8)
    v_mfma_f32_32x32x16_bf16 v[64:79], v[236:239], v[204:207], v[64:79]
    ds_read_b64_tr_b16 v[224:225], v19 offset:49152
    ds_read_b64_tr_b16 v[226:227], v19 offset:51200
    s_waitcnt lgkmcnt(8)
    v_mfma_f32_32x32x16_bf16 v[64:79], v[240:243], v[208:211], v[64:79]
    ds_read_b64_tr_b16 v[228:229], v19 offset:53248
    ds_read_b64_tr_b16 v[230:231], v19 offset:55296
    s_waitcnt lgkmcnt(8)
    v_mfma_f32_32x32x16_bf16 v[64:79], v[244:247], v[212:215], v[64:79]
    ds_read_b64_tr_b16 v[232:233], v19 offset:57344
    ds_read_b64_tr_b16 v[234:235], v19 offset:59392
    s_waitcnt lgkmcnt(8)
    v_mfma_f32_32x32x16_bf16 v[64:79], v[248:251], v[216:219], v[64:79]
    ds_read_b64_tr_b16 v[236:237], v19 offset:61440
    ds_read_b64_tr_b16 v[238:239], v19 offset:63488
    s_waitcnt lgkmcnt(8)
    v_mfma_f32_32x32x16_bf16 v[64:79], v[252:255], v[220:223], v[64:79]
    ds_read_b64_tr_b16 v[240:241], v11 offset:49152
    ds_read_b64_tr_b16 v[242:243], v11 offset:51200
    s_waitcnt lgkmcnt(8)
    v_mfma_f32_32x32x16_bf16 v[80:95], v[224:227], v[160:163], v[80:95]
    ds_read_b64_tr_b16 v[244:245], v11 offset:53248
    ds_read_b64_tr_b16 v[246:247], v11 offset:55296
    s_waitcnt lgkmcnt(8)
    v_mfma_f32_32x32x16_bf16 v[80:95], v[228:231], v[164:167], v[80:95]
    ds_read_b64_tr_b16 v[248:249], v11 offset:57344
    ds_read_b64_tr_b16 v[250:251], v11 offset:59392
    s_add_u32 s30, s46, 2
    s_and_b32 s30, s30, 3
    s_lshl_b32 s30, s30, 16
    s_add_u32 s30, s30, 32768
    v_cvt_pk_bf16_f32 v108, v64, v65
    v_cvt_pk_bf16_f32 v109, v66, v67
    v_cvt_pk_bf16_f32 v110, v68, v69
    v_mov_b32 v111, s89
    buffer_store_dwordx4 v[108:111], v20, s[68:71], s30 offen offset:0 sc1
    v_cvt_pk_bf16_f32 v112, v70, v71
    v_cvt_pk_bf16_f32 v113, v72, v73
    v_cvt_pk_bf16_f32 v114, v74, v75
    v_mov_b32 v115, s89
    buffer_store_dwordx4 v[112:115], v20, s[68:71], s30 offen offset:1024 sc1
    v_cvt_pk_bf16_f32 v116, v76, v77
    v_cvt_pk_bf16_f32 v117, v78, v79
    v_mov_b32 v118, 0
    v_mov_b32 v119, s89
    buffer_store_dwordx4 v[116:119], v20, s[68:71], s30 offen offset:2048 sc1
    s_waitcnt lgkmcnt(8)
    v_mfma_f32_32x32x16_bf16 v[80:95], v[232:235], v[168:171], v[80:95]
    ds_read_b64_tr_b16 v[252:253], v11 offset:61440
    ds_read_b64_tr_b16 v[254:255], v11 offset:63488
    s_waitcnt lgkmcnt(8)
    v_mfma_f32_32x32x16_bf16 v[80:95], v[236:239], v[172:175], v[80:95]
    ds_read_b64_tr_b16 v[224:225], v19 offset:0
    ds_read_b64_tr_b16 v[226:227], v19 offset:2048
    s_waitcnt lgkmcnt(8)
    v_mfma_f32_32x32x16_bf16 v[80:95], v[240:243], v[176:179], v[80:95]
    ds_read_b64_tr_b16 v[228:229], v19 offset:4096
    ds_read_b64_tr_b16 v[230:231], v19 offset:6144
    s_waitcnt lgkmcnt(8)
    v_mfma_f32_32x32x16_bf16 v[80:95], v[244:247], v[180:183], v[80:95]
    ds_read_b64_tr_b16 v[232:233], v19 offset:8192
    ds_read_b64_tr_b16 v[234:235], v19 offset:10240
    s_waitcnt lgkmcnt(8)
    v_mfma_f32_32x32x16_bf16 v[80:95], v[248:251], v[184:187], v[80:95]
    ds_read_b64_tr_b16 v[236:237], v19 offset:12288
    ds_read_b64_tr_b16 v[238:239], v19 offset:14336
    s_waitcnt lgkmcnt(8)
    v_mfma_f32_32x32x16_bf16 v[80:95], v[252:255], v[188:191], v[80:95]
    ds_read_b64_tr_b16 v[240:241], v15 offset:0
    ds_read_b64_tr_b16 v[242:243], v15 offset:2048
    s_waitcnt lgkmcnt(8)
    v_mfma_f32_32x32x16_bf16 v[80:95], v[224:227], v[192:195], v[80:95]
    ds_read_b64_tr_b16 v[244:245], v15 offset:4096
    ds_read_b64_tr_b16 v[246:247], v15 offset:6144
    s_waitcnt lgkmcnt(8)
    v_mfma_f32_32x32x16_bf16 v[80:95], v[228:231], v[196:199], v[80:95]
    ds_read_b64_tr_b16 v[248:249], v15 offset:8192
    ds_read_b64_tr_b16 v[250:251], v15 offset:10240
    s_waitcnt lgkmcnt(8)
    v_mfma_f32_32x32x16_bf16 v[80:95], v[232:235], v[200:203], v[80:95]
    ds_read_b64_tr_b16 v[252:253], v15 offset:12288
    ds_read_b64_tr_b16 v[254:255], v15 offset:14336
    s_waitcnt lgkmcnt(8)
    v_mfma_f32_32x32x16_bf16 v[80:95], v[236:239], v[204:207], v[80:95]
    ds_read_b64_tr_b16 v[224:225], v16 offset:49152
    ds_read_b64_tr_b16 v[226:227], v16 offset:51200
    s_waitcnt lgkmcnt(8)
    v_mfma_f32_32x32x16_bf16 v[80:95], v[240:243], v[208:211], v[80:95]
    ds_read_b64_tr_b16 v[228:229], v16 offset:53248
    ds_read_b64_tr_b16 v[230:231], v16 offset:55296
    s_waitcnt lgkmcnt(8)
    v_mfma_f32_32x32x16_bf16 v[80:95], v[244:247], v[212:215], v[80:95]
    ds_read_b64_tr_b16 v[232:233], v16 offset:57344
    ds_read_b64_tr_b16 v[234:235], v16 offset:59392
    s_waitcnt lgkmcnt(8)
    v_mfma_f32_32x32x16_bf16 v[80:95], v[248:251], v[216:219], v[80:95]
    ds_read_b64_tr_b16 v[236:237], v16 offset:61440
    ds_read_b64_tr_b16 v[238:239], v16 offset:63488
    s_waitcnt lgkmcnt(8)
    v_mfma_f32_32x32x16_bf16 v[80:95], v[252:255], v[220:223], v[80:95]
    ds_read_b64_tr_b16 v[240:241], v8 offset:49152
    ds_read_b64_tr_b16 v[242:243], v8 offset:51200
    s_waitcnt lgkmcnt(8)
    v_mfma_f32_32x32x16_bf16 v[32:47], v[224:227], v[160:163], v[32:47]
    ds_read_b64_tr_b16 v[244:245], v8 offset:53248
    ds_read_b64_tr_b16 v[246:247], v8 offset:55296
    s_waitcnt lgkmcnt(8)
    v_mfma_f32_32x32x16_bf16 v[32:47], v[228:231], v[164:167], v[32:47]
    ds_read_b64_tr_b16 v[248:249], v8 offset:57344
    ds_read_b64_tr_b16 v[250:251], v8 offset:59392
    s_add_u32 s30, s46, 3
    s_and_b32 s30, s30, 3
    s_lshl_b32 s30, s30, 16
    s_add_u32 s30, s30, 49152
    v_cvt_pk_bf16_f32 v120, v80, v81
    v_cvt_pk_bf16_f32 v121, v82, v83
    v_cvt_pk_bf16_f32 v122, v84, v85
    v_mov_b32 v123, s89
    buffer_store_dwordx4 v[120:123], v20, s[68:71], s30 offen offset:0 sc1
    v_cvt_pk_bf16_f32 v124, v86, v87
    v_cvt_pk_bf16_f32 v125, v88, v89
    v_cvt_pk_bf16_f32 v126, v90, v91
    v_mov_b32 v127, s89
    buffer_store_dwordx4 v[124:127], v20, s[68:71], s30 offen offset:1024 sc1
    v_cvt_pk_bf16_f32 v128, v92, v93
    v_cvt_pk_bf16_f32 v129, v94, v95
    v_mov_b32 v130, 0
    v_mov_b32 v131, s89
    buffer_store_dwordx4 v[128:131], v20, s[68:71], s30 offen offset:2048 sc1
    s_waitcnt lgkmcnt(8)
    v_mfma_f32_32x32x16_bf16 v[32:47], v[232:235], v[168:171], v[32:47]
    ds_read_b64_tr_b16 v[252:253], v8 offset:61440
    ds_read_b64_tr_b16 v[254:255], v8 offset:63488
    s_waitcnt lgkmcnt(8)
    v_mfma_f32_32x32x16_bf16 v[32:47], v[236:239], v[172:175], v[32:47]
    ds_read_b64_tr_b16 v[224:225], v16 offset:0
    ds_read_b64_tr_b16 v[226:227], v16 offset:2048
    s_waitcnt lgkmcnt(8)
    v_mfma_f32_32x32x16_bf16 v[32:47], v[240:243], v[176:179], v[32:47]
    ds_read_b64_tr_b16 v[228:229], v16 offset:4096
    ds_read_b64_tr_b16 v[230:231], v16 offset:6144
    s_waitcnt lgkmcnt(8)
    v_mfma_f32_32x32x16_bf16 v[32:47], v[244:247], v[180:183], v[32:47]
    ds_read_b64_tr_b16 v[232:233], v16 offset:8192
    ds_read_b64_tr_b16 v[234:235], v16 offset:10240
    s_waitcnt lgkmcnt(8)
    v_mfma_f32_32x32x16_bf16 v[32:47], v[248:251], v[184:187], v[32:47]
    ds_read_b64_tr_b16 v[236:237], v16 offset:12288
    ds_read_b64_tr_b16 v[238:239], v16 offset:14336
    s_waitcnt lgkmcnt(8)
    v_mfma_f32_32x32x16_bf16 v[32:47], v[252:255], v[188:191], v[32:47]
    ds_read_b64_tr_b16 v[240:241], v12 offset:0
    ds_read_b64_tr_b16 v[242:243], v12 offset:2048
    s_waitcnt lgkmcnt(8)
    v_mfma_f32_32x32x16_bf16 v[32:47], v[224:227], v[192:195], v[32:47]
    ds_read_b64_tr_b16 v[244:245], v12 offset:4096
    ds_read_b64_tr_b16 v[246:247], v12 offset:6144
    s_waitcnt lgkmcnt(8)
    v_mfma_f32_32x32x16_bf16 v[32:47], v[228:231], v[196:199], v[32:47]
    ds_read_b64_tr_b16 v[248:249], v12 offset:8192
    ds_read_b64_tr_b16 v[250:251], v12 offset:10240
    s_waitcnt lgkmcnt(8)
    v_mfma_f32_32x32x16_bf16 v[32:47], v[232:235], v[200:203], v[32:47]
    ds_read_b64_tr_b16 v[252:253], v12 offset:12288
    ds_read_b64_tr_b16 v[254:255], v12 offset:14336
    s_waitcnt lgkmcnt(8)
    v_mfma_f32_32x32x16_bf16 v[32:47], v[236:239], v[204:207], v[32:47]
    s_waitcnt lgkmcnt(6)
    v_mfma_f32_32x32x16_bf16 v[32:47], v[240:243], v[208:211], v[32:47]
    s_waitcnt lgkmcnt(4)
    v_mfma_f32_32x32x16_bf16 v[32:47], v[244:247], v[212:215], v[32:47]
    s_waitcnt lgkmcnt(2)
    v_mfma_f32_32x32x16_bf16 v[32:47], v[248:251], v[216:219], v[32:47]
    s_waitcnt lgkmcnt(0)
    v_mfma_f32_32x32x16_bf16 v[32:47], v[252:255], v[220:223], v[32:47]
    v_and_b32 v23, 31, v0
    s_lshl_b32 s30, s28, 5
    v_add_u32 v23, s30, v23
    s_mul_i32 s30, s34, 112
    v_add_u32 v24, s30, v23
    v_lshlrev_b32 v24, 11, v24
    v_lshrrev_b32 v25, 5, v0
    v_lshl_add_u32 v24, v25, 4, v24
    s_lshl_b32 s30, s35, 8
    s_lshl_b32 s31, s46, 6
    s_add_u32 s30, s30, s31
    s_add_u32 s30, s30, 0
    s_and_b32 s30, s30, 1023
    s_lshl_b32 s31, s47, 10
    s_add_u32 s30, s30, s31
    v_add_u32 v24, s30, v24
    s_mov_b32 s31, 20000
RD_L:
    s_lshl_b32 s30, s46, 16
    s_add_u32 s30, s30, 16384
    buffer_load_dwordx4 v[136:139], v20, s[68:71], s30 offen offset:0 sc1
    buffer_load_dwordx4 v[140:143], v20, s[68:71], s30 offen offset:1024 sc1
    buffer_load_dwordx4 v[144:147], v20, s[68:71], s30 offen offset:2048 sc1
    s_lshl_b32 s30, s46, 16
    s_add_u32 s30, s30, 32768
    buffer_load_dwordx4 v[148:151], v20, s[68:71], s30 offen offset:0 sc1
    buffer_load_dwordx4 v[152:155], v20, s[68:71], s30 offen offset:1024 sc1
    buffer_load_dwordx4 v[156:159], v20, s[68:71], s30 offen offset:2048 sc1
    s_lshl_b32 s30, s46, 16
    s_add_u32 s30, s30, 49152
    buffer_load_dwordx4 v[160:163], v20, s[68:71], s30 offen offset:0 sc1
    buffer_load_dwordx4 v[164:167], v20, s[68:71], s30 offen offset:1024 sc1
    buffer_load_dwordx4 v[168:171], v20, s[68:71], s30 offen offset:2048 sc1
    s_waitcnt vmcnt(0)
    v_xor_b32 v139, s89, v139
    v_xor_b32 v143, s89, v143
    v_xor_b32 v147, s89, v147
    v_xor_b32 v151, s89, v151
    v_xor_b32 v155, s89, v155
    v_xor_b32 v159, s89, v159
    v_xor_b32 v163, s89, v163
    v_xor_b32 v167, s89, v167
    v_xor_b32 v171, s89, v171
    v_or3_b32 v171, v171, v139, v143
    v_or3_b32 v171, v171, v147, v151
    v_or3_b32 v171, v171, v155, v159
    v_or3_b32 v171, v171, v163, v167
    v_cmp_ne_u32 vcc, 0, v171
    s_sub_u32 s31, s31, 1
    s_cmp_eq_u32 s31, 0
    s_cbranch_scc1 RD_X
    s_cbranch_vccnz RD_L
RD_X:
    v_lshlrev_b32 v25, 16, v136
    v_and_b32 v26, 0xffff0000, v136
    v_add_f32 v32, v32, v25
    v_add_f32 v33, v33, v26
    v_lshlrev_b32 v25, 16, v137
    v_and_b32 v26, 0xffff0000, v137
    v_add_f32 v34, v34, v25
    v_add_f32 v35, v35, v26
    v_lshlrev_b32 v25, 16, v138
    v_and_b32 v26, 0xffff0000, v138
    v_add_f32 v36, v36, v25
    v_add_f32 v37, v37, v26
    v_lshlrev_b32 v25, 16, v140
    v_and_b32 v26, 0xffff0000, v140
    v_add_f32 v38, v38, v25
    v_add_f32 v39, v39, v26
    v_lshlrev_b32 v25, 16, v141
    v_and_b32 v26, 0xffff0000, v141
    v_add_f32 v40, v40, v25
    v_add_f32 v41, v41, v26
    v_lshlrev_b32 v25, 16, v142
    v_and_b32 v26, 0xffff0000, v142
    v_add_f32 v42, v42, v25
    v_add_f32 v43, v43, v26
    v_lshlrev_b32 v25, 16, v144
    v_and_b32 v26, 0xffff0000, v144
    v_add_f32 v44, v44, v25
    v_add_f32 v45, v45, v26
    v_lshlrev_b32 v25, 16, v145
    v_and_b32 v26, 0xffff0000, v145
    v_add_f32 v46, v46, v25
    v_add_f32 v47, v47, v26
    v_lshlrev_b32 v25, 16, v148
    v_and_b32 v26, 0xffff0000, v148
    v_add_f32 v32, v32, v25
    v_add_f32 v33, v33, v26
    v_lshlrev_b32 v25, 16, v149
    v_and_b32 v26, 0xffff0000, v149
    v_add_f32 v34, v34, v25
    v_add_f32 v35, v35, v26
    v_lshlrev_b32 v25, 16, v150
    v_and_b32 v26, 0xffff0000, v150
    v_add_f32 v36, v36, v25
    v_add_f32 v37, v37, v26
    v_lshlrev_b32 v25, 16, v152
    v_and_b32 v26, 0xffff0000, v152
    v_add_f32 v38, v38, v25
    v_add_f32 v39, v39, v26
    v_lshlrev_b32 v25, 16, v153
    v_and_b32 v26, 0xffff0000, v153
    v_add_f32 v40, v40, v25
    v_add_f32 v41, v41, v26
    v_lshlrev_b32 v25, 16, v154
    v_and_b32 v26, 0xffff0000, v154
    v_add_f32 v42, v42, v25
    v_add_f32 v43, v43, v26
    v_lshlrev_b32 v25, 16, v156
    v_and_b32 v26, 0xffff0000, v156
    v_add_f32 v44, v44, v25
    v_add_f32 v45, v45, v26
    v_lshlrev_b32 v25, 16, v157
    v_and_b32 v26, 0xffff0000, v157
    v_add_f32 v46, v46, v25
    v_add_f32 v47, v47, v26
    v_lshlrev_b32 v25, 16, v160
    v_and_b32 v26, 0xffff0000, v160
    v_add_f32 v32, v32, v25
    v_add_f32 v33, v33, v26
    v_lshlrev_b32 v25, 16, v161
    v_and_b32 v26, 0xffff0000, v161
    v_add_f32 v34, v34, v25
    v_add_f32 v35, v35, v26
    v_lshlrev_b32 v25, 16, v162
    v_and_b32 v26, 0xffff0000, v162
    v_add_f32 v36, v36, v25
    v_add_f32 v37, v37, v26
    v_lshlrev_b32 v25, 16, v164
    v_and_b32 v26, 0xffff0000, v164
    v_add_f32 v38, v38, v25
    v_add_f32 v39, v39, v26
    v_lshlrev_b32 v25, 16, v165
    v_and_b32 v26, 0xffff0000, v165
    v_add_f32 v40, v40, v25
    v_add_f32 v41, v41, v26
    v_lshlrev_b32 v25, 16, v166
    v_and_b32 v26, 0xffff0000, v166
    v_add_f32 v42, v42, v25
    v_add_f32 v43, v43, v26
    v_lshlrev_b32 v25, 16, v168
    v_and_b32 v26, 0xffff0000, v168
    v_add_f32 v44, v44, v25
    v_add_f32 v45, v45, v26
    v_lshlrev_b32 v25, 16, v169
    v_and_b32 v26, 0xffff0000, v169
    v_add_f32 v46, v46, v25
    v_add_f32 v47, v47, v26
    v_cvt_pk_bf16_f32 v224, v32, v33
    v_cvt_pk_bf16_f32 v225, v34, v35
    v_cvt_pk_bf16_f32 v226, v36, v37
    v_cvt_pk_bf16_f32 v227, v38, v39
    v_cvt_pk_bf16_f32 v228, v40, v41
    v_cvt_pk_bf16_f32 v229, v42, v43
    v_cvt_pk_bf16_f32 v230, v44, v45
    v_cvt_pk_bf16_f32 v231, v46, v47
    v_permlane32_swap_b32 v224, v226
    v_permlane32_swap_b32 v225, v227
    v_permlane32_swap_b32 v228, v230
    v_permlane32_swap_b32 v229, v231
    v_cmp_gt_u32 vcc, 112, v23
    s_and_saveexec_b64 s[58:59], vcc
    s_cbranch_execz RD_E
    buffer_store_dwordx4 v[224:227], v24, s[76:79], 0 offen offset:0
    buffer_store_dwordx4 v[228:231], v24, s[76:79], 0 offen offset:32
RD_E:
    s_or_b32 s30, s46, s35
    s_or_b32 s30, s30, s28
    s_cmp_eq_u32 s30, 0
    s_cbranch_scc0 EP_X
    s_mov_b32 s94, 4
    s_mov_b32 s95, 0x00020000
    s_add_u32 s30, s90, 1
    v_mov_b32 v25, s30
    v_mov_b32 v26, 0
    s_mov_b64 exec, 1
    buffer_store_dword v25, v26, s[92:95], 0 offen sc1
EP_X:
    s_mov_b64 exec, -1
    s_waitcnt vmcnt(0)
    s_endpgm
K_END:
    s_endpgm
SLOW_0_1:
    s_nop 15
    v_mov_b32 v226, v224
    s_nop 1
    v_permlane32_swap_b32 v224, v226
    v_max_f32 v226, v226, v224
    v_cmp_lt_f32 vcc, s32, v226
    s_nop 1
    v_cndmask_b32 v227, 0, v226, vcc
    v_exp_f32 v228, -v227
    v_sub_f32 v160, v160, v227
    v_sub_f32 v161, v161, v227
    v_sub_f32 v162, v162, v227
    v_sub_f32 v163, v163, v227
    v_sub_f32 v164, v164, v227
    v_sub_f32 v165, v165, v227
    v_sub_f32 v166, v166, v227
    v_sub_f32 v167, v167, v227
    v_sub_f32 v168, v168, v227
    v_sub_f32 v169, v169, v227
    v_sub_f32 v170, v170, v227
    v_sub_f32 v171, v171, v227
    v_sub_f32 v172, v172, v227
    v_sub_f32 v173, v173, v227
    v_sub_f32 v174, v174, v227
    v_sub_f32 v175, v175, v227
    v_sub_f32 v32, v32, v227
    v_sub_f32 v33, v33, v227
    v_sub_f32 v34, v34, v227
    v_sub_f32 v35, v35, v227
    v_sub_f32 v36, v36, v227
    v_sub_f32 v37, v37, v227
    v_sub_f32 v38, v38, v227
    v_sub_f32 v39, v39, v227
    v_sub_f32 v40, v40, v227
    v_sub_f32 v41, v41, v227
    v_sub_f32 v42, v42, v227
    v_sub_f32 v43, v43, v227
    v_sub_f32 v44, v44, v227
    v_sub_f32 v45, v45, v227
    v_sub_f32 v46, v46, v227
    v_sub_f32 v47, v47, v227
    v_mul_f32 v31, v31, v228
    v_mul_f32 v225, v225, v228
    v_lshlrev_b32 v226, 16, v176
    v_and_b32 v227, 0xffff0000, v176
    v_mul_f32 v226, v226, v228
    v_mul_f32 v227, v227, v228
    v_cvt_pk_bf16_f32 v176, v226, v227
    v_lshlrev_b32 v226, 16, v177
    v_and_b32 v227, 0xffff0000, v177
    v_mul_f32 v226, v226, v228
    v_mul_f32 v227, v227, v228
    v_cvt_pk_bf16_f32 v177, v226, v227
    v_lshlrev_b32 v226, 16, v178
    v_and_b32 v227, 0xffff0000, v178
    v_mul_f32 v226, v226, v228
    v_mul_f32 v227, v227, v228
    v_cvt_pk_bf16_f32 v178, v226, v227
    v_lshlrev_b32 v226, 16, v179
    v_and_b32 v227, 0xffff0000, v179
    v_mul_f32 v226, v226, v228
    v_mul_f32 v227, v227, v228
    v_cvt_pk_bf16_f32 v179, v226, v227
    v_lshlrev_b32 v226, 16, v180
    v_and_b32 v227, 0xffff0000, v180
    v_mul_f32 v226, v226, v228
    v_mul_f32 v227, v227, v228
    v_cvt_pk_bf16_f32 v180, v226, v227
    v_lshlrev_b32 v226, 16, v181
    v_and_b32 v227, 0xffff0000, v181
    v_mul_f32 v226, v226, v228
    v_mul_f32 v227, v227, v228
    v_cvt_pk_bf16_f32 v181, v226, v227
    v_lshlrev_b32 v226, 16, v182
    v_and_b32 v227, 0xffff0000, v182
    v_mul_f32 v226, v226, v228
    v_mul_f32 v227, v227, v228
    v_cvt_pk_bf16_f32 v182, v226, v227
    v_lshlrev_b32 v226, 16, v183
    v_and_b32 v227, 0xffff0000, v183
    v_mul_f32 v226, v226, v228
    v_mul_f32 v227, v227, v228
    v_cvt_pk_bf16_f32 v183, v226, v227
    s_nop 3
    s_branch BACK_0_1

SLOW_0_2:
    s_nop 15
    v_mov_b32 v226, v224
    s_nop 1
    v_permlane32_swap_b32 v224, v226
    v_max_f32 v226, v226, v224
    v_cmp_lt_f32 vcc, s32, v226
    s_nop 1
    v_cndmask_b32 v227, 0, v226, vcc
    v_exp_f32 v228, -v227
    v_sub_f32 v144, v144, v227
    v_sub_f32 v145, v145, v227
    v_sub_f32 v146, v146, v227
    v_sub_f32 v147, v147, v227
    v_sub_f32 v148, v148, v227
    v_sub_f32 v149, v149, v227
    v_sub_f32 v150, v150, v227
    v_sub_f32 v151, v151, v227
    v_sub_f32 v152, v152, v227
    v_sub_f32 v153, v153, v227
    v_sub_f32 v154, v154, v227
    v_sub_f32 v155, v155, v227
    v_sub_f32 v156, v156, v227
    v_sub_f32 v157, v157, v227
    v_sub_f32 v158, v158, v227
    v_sub_f32 v159, v159, v227
    v_sub_f32 v32, v32, v227
    v_sub_f32 v33, v33, v227
    v_sub_f32 v34, v34, v227
    v_sub_f32 v35, v35, v227
    v_sub_f32 v36, v36, v227
    v_sub_f32 v37, v37, v227
    v_sub_f32 v38, v38, v227
    v_sub_f32 v39, v39, v227
    v_sub_f32 v40, v40, v227
    v_sub_f32 v41, v41, v227
    v_sub_f32 v42, v42, v227
    v_sub_f32 v43, v43, v227
    v_sub_f32 v44, v44, v227
    v_sub_f32 v45, v45, v227
    v_sub_f32 v46, v46, v227
    v_sub_f32 v47, v47, v227
    v_mul_f32 v31, v31, v228
    v_mul_f32 v225, v225, v228
    v_mul_f32 v48, v48, v228
    v_mul_f32 v49, v49, v228
    v_mul_f32 v50, v50, v228
    v_mul_f32 v51, v51, v228
    v_mul_f32 v52, v52, v228
    v_mul_f32 v53, v53, v228
    v_mul_f32 v54, v54, v228
    v_mul_f32 v55, v55, v228
    v_mul_f32 v56, v56, v228
    v_mul_f32 v57, v57, v228
    v_mul_f32 v58, v58, v228
    v_mul_f32 v59, v59, v228
    v_mul_f32 v60, v60, v228
    v_mul_f32 v61, v61, v228
    v_mul_f32 v62, v62, v228
    v_mul_f32 v63, v63, v228
    v_mul_f32 v64, v64, v228
    v_mul_f32 v65, v65, v228
    v_mul_f32 v66, v66, v228
    v_mul_f32 v67, v67, v228
    v_mul_f32 v68, v68, v228
    v_mul_f32 v69, v69, v228
    v_mul_f32 v70, v70, v228
    v_mul_f32 v71, v71, v228
    v_mul_f32 v72, v72, v228
    v_mul_f32 v73, v73, v228
    v_mul_f32 v74, v74, v228
    v_mul_f32 v75, v75, v228
    v_mul_f32 v76, v76, v228
    v_mul_f32 v77, v77, v228
    v_mul_f32 v78, v78, v228
    v_mul_f32 v79, v79, v228
    v_mul_f32 v80, v80, v228
    v_mul_f32 v81, v81, v228
    v_mul_f32 v82, v82, v228
    v_mul_f32 v83, v83, v228
    v_mul_f32 v84, v84, v228
    v_mul_f32 v85, v85, v228
    v_mul_f32 v86, v86, v228
    v_mul_f32 v87, v87, v228
    v_mul_f32 v88, v88, v228
    v_mul_f32 v89, v89, v228
    v_mul_f32 v90, v90, v228
    v_mul_f32 v91, v91, v228
    v_mul_f32 v92, v92, v228
    v_mul_f32 v93, v93, v228
    v_mul_f32 v94, v94, v228
    v_mul_f32 v95, v95, v228
    v_mul_f32 v96, v96, v228
    v_mul_f32 v97, v97, v228
    v_mul_f32 v98, v98, v228
    v_mul_f32 v99, v99, v228
    v_mul_f32 v100, v100, v228
    v_mul_f32 v101, v101, v228
    v_mul_f32 v102, v102, v228
    v_mul_f32 v103, v103, v228
    v_mul_f32 v104, v104, v228
    v_mul_f32 v105, v105, v228
    v_mul_f32 v106, v106, v228
    v_mul_f32 v107, v107, v228
    v_mul_f32 v108, v108, v228
    v_mul_f32 v109, v109, v228
    v_mul_f32 v110, v110, v228
    v_mul_f32 v111, v111, v228
    v_lshlrev_b32 v226, 16, v184
    v_and_b32 v227, 0xffff0000, v184
    v_mul_f32 v226, v226, v228
    v_mul_f32 v227, v227, v228
    v_cvt_pk_bf16_f32 v184, v226, v227
    v_lshlrev_b32 v226, 16, v185
    v_and_b32 v227, 0xffff0000, v185
    v_mul_f32 v226, v226, v228
    v_mul_f32 v227, v227, v228
    v_cvt_pk_bf16_f32 v185, v226, v227
    v_lshlrev_b32 v226, 16, v186
    v_and_b32 v227, 0xffff0000, v186
    v_mul_f32 v226, v226, v228
    v_mul_f32 v227, v227, v228
    v_cvt_pk_bf16_f32 v186, v226, v227
    v_lshlrev_b32 v226, 16, v187
    v_and_b32 v227, 0xffff0000, v187
    v_mul_f32 v226, v226, v228
    v_mul_f32 v227, v227, v228
    v_cvt_pk_bf16_f32 v187, v226, v227
    v_lshlrev_b32 v226, 16, v188
    v_and_b32 v227, 0xffff0000, v188
    v_mul_f32 v226, v226, v228
    v_mul_f32 v227, v227, v228
    v_cvt_pk_bf16_f32 v188, v226, v227
    v_lshlrev_b32 v226, 16, v189
    v_and_b32 v227, 0xffff0000, v189
    v_mul_f32 v226, v226, v228
    v_mul_f32 v227, v227, v228
    v_cvt_pk_bf16_f32 v189, v226, v227
    v_lshlrev_b32 v226, 16, v190
    v_and_b32 v227, 0xffff0000, v190
    v_mul_f32 v226, v226, v228
    v_mul_f32 v227, v227, v228
    v_cvt_pk_bf16_f32 v190, v226, v227
    v_lshlrev_b32 v226, 16, v191
    v_and_b32 v227, 0xffff0000, v191
    v_mul_f32 v226, v226, v228
    v_mul_f32 v227, v227, v228
    v_cvt_pk_bf16_f32 v191, v226, v227
    s_nop 3
    s_branch BACK_0_2

SLOW_0_3:
    s_nop 15
    v_mov_b32 v226, v224
    s_nop 1
    v_permlane32_swap_b32 v224, v226
    v_max_f32 v226, v226, v224
    v_cmp_lt_f32 vcc, s32, v226
    s_nop 1
    v_cndmask_b32 v227, 0, v226, vcc
    v_exp_f32 v228, -v227
    v_sub_f32 v160, v160, v227
    v_sub_f32 v161, v161, v227
    v_sub_f32 v162, v162, v227
    v_sub_f32 v163, v163, v227
    v_sub_f32 v164, v164, v227
    v_sub_f32 v165, v165, v227
    v_sub_f32 v166, v166, v227
    v_sub_f32 v167, v167, v227
    v_sub_f32 v168, v168, v227
    v_sub_f32 v169, v169, v227
    v_sub_f32 v170, v170, v227
    v_sub_f32 v171, v171, v227
    v_sub_f32 v172, v172, v227
    v_sub_f32 v173, v173, v227
    v_sub_f32 v174, v174, v227
    v_sub_f32 v175, v175, v227
    v_sub_f32 v32, v32, v227
    v_sub_f32 v33, v33, v227
    v_sub_f32 v34, v34, v227
    v_sub_f32 v35, v35, v227
    v_sub_f32 v36, v36, v227
    v_sub_f32 v37, v37, v227
    v_sub_f32 v38, v38, v227
    v_sub_f32 v39, v39, v227
    v_sub_f32 v40, v40, v227
    v_sub_f32 v41, v41, v227
    v_sub_f32 v42, v42, v227
    v_sub_f32 v43, v43, v227
    v_sub_f32 v44, v44, v227
    v_sub_f32 v45, v45, v227
    v_sub_f32 v46, v46, v227
    v_sub_f32 v47, v47, v227
    v_mul_f32 v31, v31, v228
    v_mul_f32 v225, v225, v228
    v_mul_f32 v48, v48, v228
    v_mul_f32 v49, v49, v228
    v_mul_f32 v50, v50, v228
    v_mul_f32 v51, v51, v228
    v_mul_f32 v52, v52, v228
    v_mul_f32 v53, v53, v228
    v_mul_f32 v54, v54, v228
    v_mul_f32 v55, v55, v228
    v_mul_f32 v56, v56, v228
    v_mul_f32 v57, v57, v228
    v_mul_f32 v58, v58, v228
    v_mul_f32 v59, v59, v228
    v_mul_f32 v60, v60, v228
    v_mul_f32 v61, v61, v228
    v_mul_f32 v62, v62, v228
    v_mul_f32 v63, v63, v228
    v_mul_f32 v64, v64, v228
    v_mul_f32 v65, v65, v228
    v_mul_f32 v66, v66, v228
    v_mul_f32 v67, v67, v228
    v_mul_f32 v68, v68, v228
    v_mul_f32 v69, v69, v228
    v_mul_f32 v70, v70, v228
    v_mul_f32 v71, v71, v228
    v_mul_f32 v72, v72, v228
    v_mul_f32 v73, v73, v228
    v_mul_f32 v74, v74, v228
    v_mul_f32 v75, v75, v228
    v_mul_f32 v76, v76, v228
    v_mul_f32 v77, v77, v228
    v_mul_f32 v78, v78, v228
    v_mul_f32 v79, v79, v228
    v_mul_f32 v80, v80, v228
    v_mul_f32 v81, v81, v228
    v_mul_f32 v82, v82, v228
    v_mul_f32 v83, v83, v228
    v_mul_f32 v84, v84, v228
    v_mul_f32 v85, v85, v228
    v_mul_f32 v86, v86, v228
    v_mul_f32 v87, v87, v228
    v_mul_f32 v88, v88, v228
    v_mul_f32 v89, v89, v228
    v_mul_f32 v90, v90, v228
    v_mul_f32 v91, v91, v228
    v_mul_f32 v92, v92, v228
    v_mul_f32 v93, v93, v228
    v_mul_f32 v94, v94, v228
    v_mul_f32 v95, v95, v228
    v_mul_f32 v96, v96, v228
    v_mul_f32 v97, v97, v228
    v_mul_f32 v98, v98, v228
    v_mul_f32 v99, v99, v228
    v_mul_f32 v100, v100, v228
    v_mul_f32 v101, v101, v228
    v_mul_f32 v102, v102, v228
    v_mul_f32 v103, v103, v228
    v_mul_f32 v104, v104, v228
    v_mul_f32 v105, v105, v228
    v_mul_f32 v106, v106, v228
    v_mul_f32 v107, v107, v228
    v_mul_f32 v108, v108, v228
    v_mul_f32 v109, v109, v228
    v_mul_f32 v110, v110, v228
    v_mul_f32 v111, v111, v228
    v_lshlrev_b32 v226, 16, v176
    v_and_b32 v227, 0xffff0000, v176
    v_mul_f32 v226, v226, v228
    v_mul_f32 v227, v227, v228
    v_cvt_pk_bf16_f32 v176, v226, v227
    v_lshlrev_b32 v226, 16, v177
    v_and_b32 v227, 0xffff0000, v177
    v_mul_f32 v226, v226, v228
    v_mul_f32 v227, v227, v228
    v_cvt_pk_bf16_f32 v177, v226, v227
    v_lshlrev_b32 v226, 16, v178
    v_and_b32 v227, 0xffff0000, v178
    v_mul_f32 v226, v226, v228
    v_mul_f32 v227, v227, v228
    v_cvt_pk_bf16_f32 v178, v226, v227
    v_lshlrev_b32 v226, 16, v179
    v_and_b32 v227, 0xffff0000, v179
    v_mul_f32 v226, v226, v228
    v_mul_f32 v227, v227, v228
    v_cvt_pk_bf16_f32 v179, v226, v227
    v_lshlrev_b32 v226, 16, v180
    v_and_b32 v227, 0xffff0000, v180
    v_mul_f32 v226, v226, v228
    v_mul_f32 v227, v227, v228
    v_cvt_pk_bf16_f32 v180, v226, v227
    v_lshlrev_b32 v226, 16, v181
    v_and_b32 v227, 0xffff0000, v181
    v_mul_f32 v226, v226, v228
    v_mul_f32 v227, v227, v228
    v_cvt_pk_bf16_f32 v181, v226, v227
    v_lshlrev_b32 v226, 16, v182
    v_and_b32 v227, 0xffff0000, v182
    v_mul_f32 v226, v226, v228
    v_mul_f32 v227, v227, v228
    v_cvt_pk_bf16_f32 v182, v226, v227
    v_lshlrev_b32 v226, 16, v183
    v_and_b32 v227, 0xffff0000, v183
    v_mul_f32 v226, v226, v228
    v_mul_f32 v227, v227, v228
    v_cvt_pk_bf16_f32 v183, v226, v227
    s_nop 3
    s_branch BACK_0_3

SLOW_0_4:
    s_nop 15
    v_mov_b32 v226, v224
    s_nop 1
    v_permlane32_swap_b32 v224, v226
    v_max_f32 v226, v226, v224
    v_cmp_lt_f32 vcc, s32, v226
    s_nop 1
    v_cndmask_b32 v227, 0, v226, vcc
    v_exp_f32 v228, -v227
    v_sub_f32 v144, v144, v227
    v_sub_f32 v145, v145, v227
    v_sub_f32 v146, v146, v227
    v_sub_f32 v147, v147, v227
    v_sub_f32 v148, v148, v227
    v_sub_f32 v149, v149, v227
    v_sub_f32 v150, v150, v227
    v_sub_f32 v151, v151, v227
    v_sub_f32 v152, v152, v227
    v_sub_f32 v153, v153, v227
    v_sub_f32 v154, v154, v227
    v_sub_f32 v155, v155, v227
    v_sub_f32 v156, v156, v227
    v_sub_f32 v157, v157, v227
    v_sub_f32 v158, v158, v227
    v_sub_f32 v159, v159, v227
    v_sub_f32 v32, v32, v227
    v_sub_f32 v33, v33, v227
    v_sub_f32 v34, v34, v227
    v_sub_f32 v35, v35, v227
    v_sub_f32 v36, v36, v227
    v_sub_f32 v37, v37, v227
    v_sub_f32 v38, v38, v227
    v_sub_f32 v39, v39, v227
    v_sub_f32 v40, v40, v227
    v_sub_f32 v41, v41, v227
    v_sub_f32 v42, v42, v227
    v_sub_f32 v43, v43, v227
    v_sub_f32 v44, v44, v227
    v_sub_f32 v45, v45, v227
    v_sub_f32 v46, v46, v227
    v_sub_f32 v47, v47, v227
    v_mul_f32 v31, v31, v228
    v_mul_f32 v225, v225, v228
    v_mul_f32 v48, v48, v228
    v_mul_f32 v49, v49, v228
    v_mul_f32 v50, v50, v228
    v_mul_f32 v51, v51, v228
    v_mul_f32 v52, v52, v228
    v_mul_f32 v53, v53, v228
    v_mul_f32 v54, v54, v228
    v_mul_f32 v55, v55, v228
    v_mul_f32 v56, v56, v228
    v_mul_f32 v57, v57, v228
    v_mul_f32 v58, v58, v228
    v_mul_f32 v59, v59, v228
    v_mul_f32 v60, v60, v228
    v_mul_f32 v61, v61, v228
    v_mul_f32 v62, v62, v228
    v_mul_f32 v63, v63, v228
    v_mul_f32 v64, v64, v228
    v_mul_f32 v65, v65, v228
    v_mul_f32 v66, v66, v228
    v_mul_f32 v67, v67, v228
    v_mul_f32 v68, v68, v228
    v_mul_f32 v69, v69, v228
    v_mul_f32 v70, v70, v228
    v_mul_f32 v71, v71, v228
    v_mul_f32 v72, v72, v228
    v_mul_f32 v73, v73, v228
    v_mul_f32 v74, v74, v228
    v_mul_f32 v75, v75, v228
    v_mul_f32 v76, v76, v228
    v_mul_f32 v77, v77, v228
    v_mul_f32 v78, v78, v228
    v_mul_f32 v79, v79, v228
    v_mul_f32 v80, v80, v228
    v_mul_f32 v81, v81, v228
    v_mul_f32 v82, v82, v228
    v_mul_f32 v83, v83, v228
    v_mul_f32 v84, v84, v228
    v_mul_f32 v85, v85, v228
    v_mul_f32 v86, v86, v228
    v_mul_f32 v87, v87, v228
    v_mul_f32 v88, v88, v228
    v_mul_f32 v89, v89, v228
    v_mul_f32 v90, v90, v228
    v_mul_f32 v91, v91, v228
    v_mul_f32 v92, v92, v228
    v_mul_f32 v93, v93, v228
    v_mul_f32 v94, v94, v228
    v_mul_f32 v95, v95, v228
    v_mul_f32 v96, v96, v228
    v_mul_f32 v97, v97, v228
    v_mul_f32 v98, v98, v228
    v_mul_f32 v99, v99, v228
    v_mul_f32 v100, v100, v228
    v_mul_f32 v101, v101, v228
    v_mul_f32 v102, v102, v228
    v_mul_f32 v103, v103, v228
    v_mul_f32 v104, v104, v228
    v_mul_f32 v105, v105, v228
    v_mul_f32 v106, v106, v228
    v_mul_f32 v107, v107, v228
    v_mul_f32 v108, v108, v228
    v_mul_f32 v109, v109, v228
    v_mul_f32 v110, v110, v228
    v_mul_f32 v111, v111, v228
    v_lshlrev_b32 v226, 16, v184
    v_and_b32 v227, 0xffff0000, v184
    v_mul_f32 v226, v226, v228
    v_mul_f32 v227, v227, v228
    v_cvt_pk_bf16_f32 v184, v226, v227
    v_lshlrev_b32 v226, 16, v185
    v_and_b32 v227, 0xffff0000, v185
    v_mul_f32 v226, v226, v228
    v_mul_f32 v227, v227, v228
    v_cvt_pk_bf16_f32 v185, v226, v227
    v_lshlrev_b32 v226, 16, v186
    v_and_b32 v227, 0xffff0000, v186
    v_mul_f32 v226, v226, v228
    v_mul_f32 v227, v227, v228
    v_cvt_pk_bf16_f32 v186, v226, v227
    v_lshlrev_b32 v226, 16, v187
    v_and_b32 v227, 0xffff0000, v187
    v_mul_f32 v226, v226, v228
    v_mul_f32 v227, v227, v228
    v_cvt_pk_bf16_f32 v187, v226, v227
    v_lshlrev_b32 v226, 16, v188
    v_and_b32 v227, 0xffff0000, v188
    v_mul_f32 v226, v226, v228
    v_mul_f32 v227, v227, v228
    v_cvt_pk_bf16_f32 v188, v226, v227
    v_lshlrev_b32 v226, 16, v189
    v_and_b32 v227, 0xffff0000, v189
    v_mul_f32 v226, v226, v228
    v_mul_f32 v227, v227, v228
    v_cvt_pk_bf16_f32 v189, v226, v227
    v_lshlrev_b32 v226, 16, v190
    v_and_b32 v227, 0xffff0000, v190
    v_mul_f32 v226, v226, v228
    v_mul_f32 v227, v227, v228
    v_cvt_pk_bf16_f32 v190, v226, v227
    v_lshlrev_b32 v226, 16, v191
    v_and_b32 v227, 0xffff0000, v191
    v_mul_f32 v226, v226, v228
    v_mul_f32 v227, v227, v228
    v_cvt_pk_bf16_f32 v191, v226, v227
    s_nop 3
    s_branch BACK_0_4

SLOW_0_5:
    s_nop 15
    v_mov_b32 v226, v224
    s_nop 1
    v_permlane32_swap_b32 v224, v226
    v_max_f32 v226, v226, v224
    v_cmp_lt_f32 vcc, s32, v226
    s_nop 1
    v_cndmask_b32 v227, 0, v226, vcc
    v_exp_f32 v228, -v227
    v_sub_f32 v160, v160, v227
    v_sub_f32 v161, v161, v227
    v_sub_f32 v162, v162, v227
    v_sub_f32 v163, v163, v227
    v_sub_f32 v164, v164, v227
    v_sub_f32 v165, v165, v227
    v_sub_f32 v166, v166, v227
    v_sub_f32 v167, v167, v227
    v_sub_f32 v168, v168, v227
    v_sub_f32 v169, v169, v227
    v_sub_f32 v170, v170, v227
    v_sub_f32 v171, v171, v227
    v_sub_f32 v172, v172, v227
    v_sub_f32 v173, v173, v227
    v_sub_f32 v174, v174, v227
    v_sub_f32 v175, v175, v227
    v_sub_f32 v32, v32, v227
    v_sub_f32 v33, v33, v227
    v_sub_f32 v34, v34, v227
    v_sub_f32 v35, v35, v227
    v_sub_f32 v36, v36, v227
    v_sub_f32 v37, v37, v227
    v_sub_f32 v38, v38, v227
    v_sub_f32 v39, v39, v227
    v_sub_f32 v40, v40, v227
    v_sub_f32 v41, v41, v227
    v_sub_f32 v42, v42, v227
    v_sub_f32 v43, v43, v227
    v_sub_f32 v44, v44, v227
    v_sub_f32 v45, v45, v227
    v_sub_f32 v46, v46, v227
    v_sub_f32 v47, v47, v227
    v_mul_f32 v31, v31, v228
    v_mul_f32 v225, v225, v228
    v_mul_f32 v48, v48, v228
    v_mul_f32 v49, v49, v228
    v_mul_f32 v50, v50, v228
    v_mul_f32 v51, v51, v228
    v_mul_f32 v52, v52, v228
    v_mul_f32 v53, v53, v228
    v_mul_f32 v54, v54, v228
    v_mul_f32 v55, v55, v228
    v_mul_f32 v56, v56, v228
    v_mul_f32 v57, v57, v228
    v_mul_f32 v58, v58, v228
    v_mul_f32 v59, v59, v228
    v_mul_f32 v60, v60, v228
    v_mul_f32 v61, v61, v228
    v_mul_f32 v62, v62, v228
    v_mul_f32 v63, v63, v228
    v_mul_f32 v64, v64, v228
    v_mul_f32 v65, v65, v228
    v_mul_f32 v66, v66, v228
    v_mul_f32 v67, v67, v228
    v_mul_f32 v68, v68, v228
    v_mul_f32 v69, v69, v228
    v_mul_f32 v70, v70, v228
    v_mul_f32 v71, v71, v228
    v_mul_f32 v72, v72, v228
    v_mul_f32 v73, v73, v228
    v_mul_f32 v74, v74, v228
    v_mul_f32 v75, v75, v228
    v_mul_f32 v76, v76, v228
    v_mul_f32 v77, v77, v228
    v_mul_f32 v78, v78, v228
    v_mul_f32 v79, v79, v228
    v_mul_f32 v80, v80, v228
    v_mul_f32 v81, v81, v228
    v_mul_f32 v82, v82, v228
    v_mul_f32 v83, v83, v228
    v_mul_f32 v84, v84, v228
    v_mul_f32 v85, v85, v228
    v_mul_f32 v86, v86, v228
    v_mul_f32 v87, v87, v228
    v_mul_f32 v88, v88, v228
    v_mul_f32 v89, v89, v228
    v_mul_f32 v90, v90, v228
    v_mul_f32 v91, v91, v228
    v_mul_f32 v92, v92, v228
    v_mul_f32 v93, v93, v228
    v_mul_f32 v94, v94, v228
    v_mul_f32 v95, v95, v228
    v_mul_f32 v96, v96, v228
    v_mul_f32 v97, v97, v228
    v_mul_f32 v98, v98, v228
    v_mul_f32 v99, v99, v228
    v_mul_f32 v100, v100, v228
    v_mul_f32 v101, v101, v228
    v_mul_f32 v102, v102, v228
    v_mul_f32 v103, v103, v228
    v_mul_f32 v104, v104, v228
    v_mul_f32 v105, v105, v228
    v_mul_f32 v106, v106, v228
    v_mul_f32 v107, v107, v228
    v_mul_f32 v108, v108, v228
    v_mul_f32 v109, v109, v228
    v_mul_f32 v110, v110, v228
    v_mul_f32 v111, v111, v228
    v_lshlrev_b32 v226, 16, v176
    v_and_b32 v227, 0xffff0000, v176
    v_mul_f32 v226, v226, v228
    v_mul_f32 v227, v227, v228
    v_cvt_pk_bf16_f32 v176, v226, v227
    v_lshlrev_b32 v226, 16, v177
    v_and_b32 v227, 0xffff0000, v177
    v_mul_f32 v226, v226, v228
    v_mul_f32 v227, v227, v228
    v_cvt_pk_bf16_f32 v177, v226, v227
    v_lshlrev_b32 v226, 16, v178
    v_and_b32 v227, 0xffff0000, v178
    v_mul_f32 v226, v226, v228
    v_mul_f32 v227, v227, v228
    v_cvt_pk_bf16_f32 v178, v226, v227
    v_lshlrev_b32 v226, 16, v179
    v_and_b32 v227, 0xffff0000, v179
    v_mul_f32 v226, v226, v228
    v_mul_f32 v227, v227, v228
    v_cvt_pk_bf16_f32 v179, v226, v227
    v_lshlrev_b32 v226, 16, v180
    v_and_b32 v227, 0xffff0000, v180
    v_mul_f32 v226, v226, v228
    v_mul_f32 v227, v227, v228
    v_cvt_pk_bf16_f32 v180, v226, v227
    v_lshlrev_b32 v226, 16, v181
    v_and_b32 v227, 0xffff0000, v181
    v_mul_f32 v226, v226, v228
    v_mul_f32 v227, v227, v228
    v_cvt_pk_bf16_f32 v181, v226, v227
    v_lshlrev_b32 v226, 16, v182
    v_and_b32 v227, 0xffff0000, v182
    v_mul_f32 v226, v226, v228
    v_mul_f32 v227, v227, v228
    v_cvt_pk_bf16_f32 v182, v226, v227
    v_lshlrev_b32 v226, 16, v183
    v_and_b32 v227, 0xffff0000, v183
    v_mul_f32 v226, v226, v228
    v_mul_f32 v227, v227, v228
    v_cvt_pk_bf16_f32 v183, v226, v227
    s_nop 3
    s_branch BACK_0_5

SLOW_0_6:
    s_nop 15
    v_mov_b32 v226, v224
    s_nop 1
    v_permlane32_swap_b32 v224, v226
    v_max_f32 v226, v226, v224
    v_cmp_lt_f32 vcc, s32, v226
    s_nop 1
    v_cndmask_b32 v227, 0, v226, vcc
    v_exp_f32 v228, -v227
    v_sub_f32 v144, v144, v227
    v_sub_f32 v145, v145, v227
    v_sub_f32 v146, v146, v227
    v_sub_f32 v147, v147, v227
    v_sub_f32 v148, v148, v227
    v_sub_f32 v149, v149, v227
    v_sub_f32 v150, v150, v227
    v_sub_f32 v151, v151, v227
    v_sub_f32 v152, v152, v227
    v_sub_f32 v153, v153, v227
    v_sub_f32 v154, v154, v227
    v_sub_f32 v155, v155, v227
    v_sub_f32 v156, v156, v227
    v_sub_f32 v157, v157, v227
    v_sub_f32 v158, v158, v227
    v_sub_f32 v159, v159, v227
    v_sub_f32 v32, v32, v227
    v_sub_f32 v33, v33, v227
    v_sub_f32 v34, v34, v227
    v_sub_f32 v35, v35, v227
    v_sub_f32 v36, v36, v227
    v_sub_f32 v37, v37, v227
    v_sub_f32 v38, v38, v227
    v_sub_f32 v39, v39, v227
    v_sub_f32 v40, v40, v227
    v_sub_f32 v41, v41, v227
    v_sub_f32 v42, v42, v227
    v_sub_f32 v43, v43, v227
    v_sub_f32 v44, v44, v227
    v_sub_f32 v45, v45, v227
    v_sub_f32 v46, v46, v227
    v_sub_f32 v47, v47, v227
    v_mul_f32 v31, v31, v228
    v_mul_f32 v225, v225, v228
    v_mul_f32 v48, v48, v228
    v_mul_f32 v49, v49, v228
    v_mul_f32 v50, v50, v228
    v_mul_f32 v51, v51, v228
    v_mul_f32 v52, v52, v228
    v_mul_f32 v53, v53, v228
    v_mul_f32 v54, v54, v228
    v_mul_f32 v55, v55, v228
    v_mul_f32 v56, v56, v228
    v_mul_f32 v57, v57, v228
    v_mul_f32 v58, v58, v228
    v_mul_f32 v59, v59, v228
    v_mul_f32 v60, v60, v228
    v_mul_f32 v61, v61, v228
    v_mul_f32 v62, v62, v228
    v_mul_f32 v63, v63, v228
    v_mul_f32 v64, v64, v228
    v_mul_f32 v65, v65, v228
    v_mul_f32 v66, v66, v228
    v_mul_f32 v67, v67, v228
    v_mul_f32 v68, v68, v228
    v_mul_f32 v69, v69, v228
    v_mul_f32 v70, v70, v228
    v_mul_f32 v71, v71, v228
    v_mul_f32 v72, v72, v228
    v_mul_f32 v73, v73, v228
    v_mul_f32 v74, v74, v228
    v_mul_f32 v75, v75, v228
    v_mul_f32 v76, v76, v228
    v_mul_f32 v77, v77, v228
    v_mul_f32 v78, v78, v228
    v_mul_f32 v79, v79, v228
    v_mul_f32 v80, v80, v228
    v_mul_f32 v81, v81, v228
    v_mul_f32 v82, v82, v228
    v_mul_f32 v83, v83, v228
    v_mul_f32 v84, v84, v228
    v_mul_f32 v85, v85, v228
    v_mul_f32 v86, v86, v228
    v_mul_f32 v87, v87, v228
    v_mul_f32 v88, v88, v228
    v_mul_f32 v89, v89, v228
    v_mul_f32 v90, v90, v228
    v_mul_f32 v91, v91, v228
    v_mul_f32 v92, v92, v228
    v_mul_f32 v93, v93, v228
    v_mul_f32 v94, v94, v228
    v_mul_f32 v95, v95, v228
    v_mul_f32 v96, v96, v228
    v_mul_f32 v97, v97, v228
    v_mul_f32 v98, v98, v228
    v_mul_f32 v99, v99, v228
    v_mul_f32 v100, v100, v228
    v_mul_f32 v101, v101, v228
    v_mul_f32 v102, v102, v228
    v_mul_f32 v103, v103, v228
    v_mul_f32 v104, v104, v228
    v_mul_f32 v105, v105, v228
    v_mul_f32 v106, v106, v228
    v_mul_f32 v107, v107, v228
    v_mul_f32 v108, v108, v228
    v_mul_f32 v109, v109, v228
    v_mul_f32 v110, v110, v228
    v_mul_f32 v111, v111, v228
    v_lshlrev_b32 v226, 16, v184
    v_and_b32 v227, 0xffff0000, v184
    v_mul_f32 v226, v226, v228
    v_mul_f32 v227, v227, v228
    v_cvt_pk_bf16_f32 v184, v226, v227
    v_lshlrev_b32 v226, 16, v185
    v_and_b32 v227, 0xffff0000, v185
    v_mul_f32 v226, v226, v228
    v_mul_f32 v227, v227, v228
    v_cvt_pk_bf16_f32 v185, v226, v227
    v_lshlrev_b32 v226, 16, v186
    v_and_b32 v227, 0xffff0000, v186
    v_mul_f32 v226, v226, v228
    v_mul_f32 v227, v227, v228
    v_cvt_pk_bf16_f32 v186, v226, v227
    v_lshlrev_b32 v226, 16, v187
    v_and_b32 v227, 0xffff0000, v187
    v_mul_f32 v226, v226, v228
    v_mul_f32 v227, v227, v228
    v_cvt_pk_bf16_f32 v187, v226, v227
    v_lshlrev_b32 v226, 16, v188
    v_and_b32 v227, 0xffff0000, v188
    v_mul_f32 v226, v226, v228
    v_mul_f32 v227, v227, v228
    v_cvt_pk_bf16_f32 v188, v226, v227
    v_lshlrev_b32 v226, 16, v189
    v_and_b32 v227, 0xffff0000, v189
    v_mul_f32 v226, v226, v228
    v_mul_f32 v227, v227, v228
    v_cvt_pk_bf16_f32 v189, v226, v227
    v_lshlrev_b32 v226, 16, v190
    v_and_b32 v227, 0xffff0000, v190
    v_mul_f32 v226, v226, v228
    v_mul_f32 v227, v227, v228
    v_cvt_pk_bf16_f32 v190, v226, v227
    v_lshlrev_b32 v226, 16, v191
    v_and_b32 v227, 0xffff0000, v191
    v_mul_f32 v226, v226, v228
    v_mul_f32 v227, v227, v228
    v_cvt_pk_bf16_f32 v191, v226, v227
    s_nop 3
    s_branch BACK_0_6

SLOW_0_7:
    s_nop 15
    v_mov_b32 v226, v224
    s_nop 1
    v_permlane32_swap_b32 v224, v226
    v_max_f32 v226, v226, v224
    v_cmp_lt_f32 vcc, s32, v226
    s_nop 1
    v_cndmask_b32 v227, 0, v226, vcc
    v_exp_f32 v228, -v227
    v_sub_f32 v160, v160, v227
    v_sub_f32 v161, v161, v227
    v_sub_f32 v162, v162, v227
    v_sub_f32 v163, v163, v227
    v_sub_f32 v164, v164, v227
    v_sub_f32 v165, v165, v227
    v_sub_f32 v166, v166, v227
    v_sub_f32 v167, v167, v227
    v_sub_f32 v168, v168, v227
    v_sub_f32 v169, v169, v227
    v_sub_f32 v170, v170, v227
    v_sub_f32 v171, v171, v227
    v_sub_f32 v172, v172, v227
    v_sub_f32 v173, v173, v227
    v_sub_f32 v174, v174, v227
    v_sub_f32 v175, v175, v227
    v_sub_f32 v32, v32, v227
    v_sub_f32 v33, v33, v227
    v_sub_f32 v34, v34, v227
    v_sub_f32 v35, v35, v227
    v_sub_f32 v36, v36, v227
    v_sub_f32 v37, v37, v227
    v_sub_f32 v38, v38, v227
    v_sub_f32 v39, v39, v227
    v_sub_f32 v40, v40, v227
    v_sub_f32 v41, v41, v227
    v_sub_f32 v42, v42, v227
    v_sub_f32 v43, v43, v227
    v_sub_f32 v44, v44, v227
    v_sub_f32 v45, v45, v227
    v_sub_f32 v46, v46, v227
    v_sub_f32 v47, v47, v227
    v_mul_f32 v31, v31, v228
    v_mul_f32 v225, v225, v228
    v_mul_f32 v48, v48, v228
    v_mul_f32 v49, v49, v228
    v_mul_f32 v50, v50, v228
    v_mul_f32 v51, v51, v228
    v_mul_f32 v52, v52, v228
    v_mul_f32 v53, v53, v228
    v_mul_f32 v54, v54, v228
    v_mul_f32 v55, v55, v228
    v_mul_f32 v56, v56, v228
    v_mul_f32 v57, v57, v228
    v_mul_f32 v58, v58, v228
    v_mul_f32 v59, v59, v228
    v_mul_f32 v60, v60, v228
    v_mul_f32 v61, v61, v228
    v_mul_f32 v62, v62, v228
    v_mul_f32 v63, v63, v228
    v_mul_f32 v64, v64, v228
    v_mul_f32 v65, v65, v228
    v_mul_f32 v66, v66, v228
    v_mul_f32 v67, v67, v228
    v_mul_f32 v68, v68, v228
    v_mul_f32 v69, v69, v228
    v_mul_f32 v70, v70, v228
    v_mul_f32 v71, v71, v228
    v_mul_f32 v72, v72, v228
    v_mul_f32 v73, v73, v228
    v_mul_f32 v74, v74, v228
    v_mul_f32 v75, v75, v228
    v_mul_f32 v76, v76, v228
    v_mul_f32 v77, v77, v228
    v_mul_f32 v78, v78, v228
    v_mul_f32 v79, v79, v228
    v_mul_f32 v80, v80, v228
    v_mul_f32 v81, v81, v228
    v_mul_f32 v82, v82, v228
    v_mul_f32 v83, v83, v228
    v_mul_f32 v84, v84, v228
    v_mul_f32 v85, v85, v228
    v_mul_f32 v86, v86, v228
    v_mul_f32 v87, v87, v228
    v_mul_f32 v88, v88, v228
    v_mul_f32 v89, v89, v228
    v_mul_f32 v90, v90, v228
    v_mul_f32 v91, v91, v228
    v_mul_f32 v92, v92, v228
    v_mul_f32 v93, v93, v228
    v_mul_f32 v94, v94, v228
    v_mul_f32 v95, v95, v228
    v_mul_f32 v96, v96, v228
    v_mul_f32 v97, v97, v228
    v_mul_f32 v98, v98, v228
    v_mul_f32 v99, v99, v228
    v_mul_f32 v100, v100, v228
    v_mul_f32 v101, v101, v228
    v_mul_f32 v102, v102, v228
    v_mul_f32 v103, v103, v228
    v_mul_f32 v104, v104, v228
    v_mul_f32 v105, v105, v228
    v_mul_f32 v106, v106, v228
    v_mul_f32 v107, v107, v228
    v_mul_f32 v108, v108, v228
    v_mul_f32 v109, v109, v228
    v_mul_f32 v110, v110, v228
    v_mul_f32 v111, v111, v228
    v_lshlrev_b32 v226, 16, v176
    v_and_b32 v227, 0xffff0000, v176
    v_mul_f32 v226, v226, v228
    v_mul_f32 v227, v227, v228
    v_cvt_pk_bf16_f32 v176, v226, v227
    v_lshlrev_b32 v226, 16, v177
    v_and_b32 v227, 0xffff0000, v177
    v_mul_f32 v226, v226, v228
    v_mul_f32 v227, v227, v228
    v_cvt_pk_bf16_f32 v177, v226, v227
    v_lshlrev_b32 v226, 16, v178
    v_and_b32 v227, 0xffff0000, v178
    v_mul_f32 v226, v226, v228
    v_mul_f32 v227, v227, v228
    v_cvt_pk_bf16_f32 v178, v226, v227
    v_lshlrev_b32 v226, 16, v179
    v_and_b32 v227, 0xffff0000, v179
    v_mul_f32 v226, v226, v228
    v_mul_f32 v227, v227, v228
    v_cvt_pk_bf16_f32 v179, v226, v227
    v_lshlrev_b32 v226, 16, v180
    v_and_b32 v227, 0xffff0000, v180
    v_mul_f32 v226, v226, v228
    v_mul_f32 v227, v227, v228
    v_cvt_pk_bf16_f32 v180, v226, v227
    v_lshlrev_b32 v226, 16, v181
    v_and_b32 v227, 0xffff0000, v181
    v_mul_f32 v226, v226, v228
    v_mul_f32 v227, v227, v228
    v_cvt_pk_bf16_f32 v181, v226, v227
    v_lshlrev_b32 v226, 16, v182
    v_and_b32 v227, 0xffff0000, v182
    v_mul_f32 v226, v226, v228
    v_mul_f32 v227, v227, v228
    v_cvt_pk_bf16_f32 v182, v226, v227
    v_lshlrev_b32 v226, 16, v183
    v_and_b32 v227, 0xffff0000, v183
    v_mul_f32 v226, v226, v228
    v_mul_f32 v227, v227, v228
    v_cvt_pk_bf16_f32 v183, v226, v227
    s_nop 3
    s_branch BACK_0_7

SLOW_0_8:
    s_nop 15
    v_mov_b32 v226, v224
    s_nop 1
    v_permlane32_swap_b32 v224, v226
    v_max_f32 v226, v226, v224
    v_cmp_lt_f32 vcc, s32, v226
    s_nop 1
    v_cndmask_b32 v227, 0, v226, vcc
    v_exp_f32 v228, -v227
    v_sub_f32 v144, v144, v227
    v_sub_f32 v145, v145, v227
    v_sub_f32 v146, v146, v227
    v_sub_f32 v147, v147, v227
    v_sub_f32 v148, v148, v227
    v_sub_f32 v149, v149, v227
    v_sub_f32 v150, v150, v227
    v_sub_f32 v151, v151, v227
    v_sub_f32 v152, v152, v227
    v_sub_f32 v153, v153, v227
    v_sub_f32 v154, v154, v227
    v_sub_f32 v155, v155, v227
    v_sub_f32 v156, v156, v227
    v_sub_f32 v157, v157, v227
    v_sub_f32 v158, v158, v227
    v_sub_f32 v159, v159, v227
    v_sub_f32 v32, v32, v227
    v_sub_f32 v33, v33, v227
    v_sub_f32 v34, v34, v227
    v_sub_f32 v35, v35, v227
    v_sub_f32 v36, v36, v227
    v_sub_f32 v37, v37, v227
    v_sub_f32 v38, v38, v227
    v_sub_f32 v39, v39, v227
    v_sub_f32 v40, v40, v227
    v_sub_f32 v41, v41, v227
    v_sub_f32 v42, v42, v227
    v_sub_f32 v43, v43, v227
    v_sub_f32 v44, v44, v227
    v_sub_f32 v45, v45, v227
    v_sub_f32 v46, v46, v227
    v_sub_f32 v47, v47, v227
    v_mul_f32 v31, v31, v228
    v_mul_f32 v225, v225, v228
    v_mul_f32 v48, v48, v228
    v_mul_f32 v49, v49, v228
    v_mul_f32 v50, v50, v228
    v_mul_f32 v51, v51, v228
    v_mul_f32 v52, v52, v228
    v_mul_f32 v53, v53, v228
    v_mul_f32 v54, v54, v228
    v_mul_f32 v55, v55, v228
    v_mul_f32 v56, v56, v228
    v_mul_f32 v57, v57, v228
    v_mul_f32 v58, v58, v228
    v_mul_f32 v59, v59, v228
    v_mul_f32 v60, v60, v228
    v_mul_f32 v61, v61, v228
    v_mul_f32 v62, v62, v228
    v_mul_f32 v63, v63, v228
    v_mul_f32 v64, v64, v228
    v_mul_f32 v65, v65, v228
    v_mul_f32 v66, v66, v228
    v_mul_f32 v67, v67, v228
    v_mul_f32 v68, v68, v228
    v_mul_f32 v69, v69, v228
    v_mul_f32 v70, v70, v228
    v_mul_f32 v71, v71, v228
    v_mul_f32 v72, v72, v228
    v_mul_f32 v73, v73, v228
    v_mul_f32 v74, v74, v228
    v_mul_f32 v75, v75, v228
    v_mul_f32 v76, v76, v228
    v_mul_f32 v77, v77, v228
    v_mul_f32 v78, v78, v228
    v_mul_f32 v79, v79, v228
    v_mul_f32 v80, v80, v228
    v_mul_f32 v81, v81, v228
    v_mul_f32 v82, v82, v228
    v_mul_f32 v83, v83, v228
    v_mul_f32 v84, v84, v228
    v_mul_f32 v85, v85, v228
    v_mul_f32 v86, v86, v228
    v_mul_f32 v87, v87, v228
    v_mul_f32 v88, v88, v228
    v_mul_f32 v89, v89, v228
    v_mul_f32 v90, v90, v228
    v_mul_f32 v91, v91, v228
    v_mul_f32 v92, v92, v228
    v_mul_f32 v93, v93, v228
    v_mul_f32 v94, v94, v228
    v_mul_f32 v95, v95, v228
    v_mul_f32 v96, v96, v228
    v_mul_f32 v97, v97, v228
    v_mul_f32 v98, v98, v228
    v_mul_f32 v99, v99, v228
    v_mul_f32 v100, v100, v228
    v_mul_f32 v101, v101, v228
    v_mul_f32 v102, v102, v228
    v_mul_f32 v103, v103, v228
    v_mul_f32 v104, v104, v228
    v_mul_f32 v105, v105, v228
    v_mul_f32 v106, v106, v228
    v_mul_f32 v107, v107, v228
    v_mul_f32 v108, v108, v228
    v_mul_f32 v109, v109, v228
    v_mul_f32 v110, v110, v228
    v_mul_f32 v111, v111, v228
    v_lshlrev_b32 v226, 16, v184
    v_and_b32 v227, 0xffff0000, v184
    v_mul_f32 v226, v226, v228
    v_mul_f32 v227, v227, v228
    v_cvt_pk_bf16_f32 v184, v226, v227
    v_lshlrev_b32 v226, 16, v185
    v_and_b32 v227, 0xffff0000, v185
    v_mul_f32 v226, v226, v228
    v_mul_f32 v227, v227, v228
    v_cvt_pk_bf16_f32 v185, v226, v227
    v_lshlrev_b32 v226, 16, v186
    v_and_b32 v227, 0xffff0000, v186
    v_mul_f32 v226, v226, v228
    v_mul_f32 v227, v227, v228
    v_cvt_pk_bf16_f32 v186, v226, v227
    v_lshlrev_b32 v226, 16, v187
    v_and_b32 v227, 0xffff0000, v187
    v_mul_f32 v226, v226, v228
    v_mul_f32 v227, v227, v228
    v_cvt_pk_bf16_f32 v187, v226, v227
    v_lshlrev_b32 v226, 16, v188
    v_and_b32 v227, 0xffff0000, v188
    v_mul_f32 v226, v226, v228
    v_mul_f32 v227, v227, v228
    v_cvt_pk_bf16_f32 v188, v226, v227
    v_lshlrev_b32 v226, 16, v189
    v_and_b32 v227, 0xffff0000, v189
    v_mul_f32 v226, v226, v228
    v_mul_f32 v227, v227, v228
    v_cvt_pk_bf16_f32 v189, v226, v227
    v_lshlrev_b32 v226, 16, v190
    v_and_b32 v227, 0xffff0000, v190
    v_mul_f32 v226, v226, v228
    v_mul_f32 v227, v227, v228
    v_cvt_pk_bf16_f32 v190, v226, v227
    v_lshlrev_b32 v226, 16, v191
    v_and_b32 v227, 0xffff0000, v191
    v_mul_f32 v226, v226, v228
    v_mul_f32 v227, v227, v228
    v_cvt_pk_bf16_f32 v191, v226, v227
    s_nop 3
    s_branch BACK_0_8

SLOW_0_9:
    s_nop 15
    v_mov_b32 v226, v224
    s_nop 1
    v_permlane32_swap_b32 v224, v226
    v_max_f32 v226, v226, v224
    v_cmp_lt_f32 vcc, s32, v226
    s_nop 1
    v_cndmask_b32 v227, 0, v226, vcc
    v_exp_f32 v228, -v227
    v_sub_f32 v160, v160, v227
    v_sub_f32 v161, v161, v227
    v_sub_f32 v162, v162, v227
    v_sub_f32 v163, v163, v227
    v_sub_f32 v164, v164, v227
    v_sub_f32 v165, v165, v227
    v_sub_f32 v166, v166, v227
    v_sub_f32 v167, v167, v227
    v_sub_f32 v168, v168, v227
    v_sub_f32 v169, v169, v227
    v_sub_f32 v170, v170, v227
    v_sub_f32 v171, v171, v227
    v_sub_f32 v172, v172, v227
    v_sub_f32 v173, v173, v227
    v_sub_f32 v174, v174, v227
    v_sub_f32 v175, v175, v227
    v_sub_f32 v32, v32, v227
    v_sub_f32 v33, v33, v227
    v_sub_f32 v34, v34, v227
    v_sub_f32 v35, v35, v227
    v_sub_f32 v36, v36, v227
    v_sub_f32 v37, v37, v227
    v_sub_f32 v38, v38, v227
    v_sub_f32 v39, v39, v227
    v_sub_f32 v40, v40, v227
    v_sub_f32 v41, v41, v227
    v_sub_f32 v42, v42, v227
    v_sub_f32 v43, v43, v227
    v_sub_f32 v44, v44, v227
    v_sub_f32 v45, v45, v227
    v_sub_f32 v46, v46, v227
    v_sub_f32 v47, v47, v227
    v_mul_f32 v31, v31, v228
    v_mul_f32 v225, v225, v228
    v_mul_f32 v48, v48, v228
    v_mul_f32 v49, v49, v228
    v_mul_f32 v50, v50, v228
    v_mul_f32 v51, v51, v228
    v_mul_f32 v52, v52, v228
    v_mul_f32 v53, v53, v228
    v_mul_f32 v54, v54, v228
    v_mul_f32 v55, v55, v228
    v_mul_f32 v56, v56, v228
    v_mul_f32 v57, v57, v228
    v_mul_f32 v58, v58, v228
    v_mul_f32 v59, v59, v228
    v_mul_f32 v60, v60, v228
    v_mul_f32 v61, v61, v228
    v_mul_f32 v62, v62, v228
    v_mul_f32 v63, v63, v228
    v_mul_f32 v64, v64, v228
    v_mul_f32 v65, v65, v228
    v_mul_f32 v66, v66, v228
    v_mul_f32 v67, v67, v228
    v_mul_f32 v68, v68, v228
    v_mul_f32 v69, v69, v228
    v_mul_f32 v70, v70, v228
    v_mul_f32 v71, v71, v228
    v_mul_f32 v72, v72, v228
    v_mul_f32 v73, v73, v228
    v_mul_f32 v74, v74, v228
    v_mul_f32 v75, v75, v228
    v_mul_f32 v76, v76, v228
    v_mul_f32 v77, v77, v228
    v_mul_f32 v78, v78, v228
    v_mul_f32 v79, v79, v228
    v_mul_f32 v80, v80, v228
    v_mul_f32 v81, v81, v228
    v_mul_f32 v82, v82, v228
    v_mul_f32 v83, v83, v228
    v_mul_f32 v84, v84, v228
    v_mul_f32 v85, v85, v228
    v_mul_f32 v86, v86, v228
    v_mul_f32 v87, v87, v228
    v_mul_f32 v88, v88, v228
    v_mul_f32 v89, v89, v228
    v_mul_f32 v90, v90, v228
    v_mul_f32 v91, v91, v228
    v_mul_f32 v92, v92, v228
    v_mul_f32 v93, v93, v228
    v_mul_f32 v94, v94, v228
    v_mul_f32 v95, v95, v228
    v_mul_f32 v96, v96, v228
    v_mul_f32 v97, v97, v228
    v_mul_f32 v98, v98, v228
    v_mul_f32 v99, v99, v228
    v_mul_f32 v100, v100, v228
    v_mul_f32 v101, v101, v228
    v_mul_f32 v102, v102, v228
    v_mul_f32 v103, v103, v228
    v_mul_f32 v104, v104, v228
    v_mul_f32 v105, v105, v228
    v_mul_f32 v106, v106, v228
    v_mul_f32 v107, v107, v228
    v_mul_f32 v108, v108, v228
    v_mul_f32 v109, v109, v228
    v_mul_f32 v110, v110, v228
    v_mul_f32 v111, v111, v228
    v_lshlrev_b32 v226, 16, v176
    v_and_b32 v227, 0xffff0000, v176
    v_mul_f32 v226, v226, v228
    v_mul_f32 v227, v227, v228
    v_cvt_pk_bf16_f32 v176, v226, v227
    v_lshlrev_b32 v226, 16, v177
    v_and_b32 v227, 0xffff0000, v177
    v_mul_f32 v226, v226, v228
    v_mul_f32 v227, v227, v228
    v_cvt_pk_bf16_f32 v177, v226, v227
    v_lshlrev_b32 v226, 16, v178
    v_and_b32 v227, 0xffff0000, v178
    v_mul_f32 v226, v226, v228
    v_mul_f32 v227, v227, v228
    v_cvt_pk_bf16_f32 v178, v226, v227
    v_lshlrev_b32 v226, 16, v179
    v_and_b32 v227, 0xffff0000, v179
    v_mul_f32 v226, v226, v228
    v_mul_f32 v227, v227, v228
    v_cvt_pk_bf16_f32 v179, v226, v227
    v_lshlrev_b32 v226, 16, v180
    v_and_b32 v227, 0xffff0000, v180
    v_mul_f32 v226, v226, v228
    v_mul_f32 v227, v227, v228
    v_cvt_pk_bf16_f32 v180, v226, v227
    v_lshlrev_b32 v226, 16, v181
    v_and_b32 v227, 0xffff0000, v181
    v_mul_f32 v226, v226, v228
    v_mul_f32 v227, v227, v228
    v_cvt_pk_bf16_f32 v181, v226, v227
    v_lshlrev_b32 v226, 16, v182
    v_and_b32 v227, 0xffff0000, v182
    v_mul_f32 v226, v226, v228
    v_mul_f32 v227, v227, v228
    v_cvt_pk_bf16_f32 v182, v226, v227
    v_lshlrev_b32 v226, 16, v183
    v_and_b32 v227, 0xffff0000, v183
    v_mul_f32 v226, v226, v228
    v_mul_f32 v227, v227, v228
    v_cvt_pk_bf16_f32 v183, v226, v227
    s_nop 3
    s_branch BACK_0_9

SLOW_0_10:
    s_nop 15
    v_mov_b32 v226, v224
    s_nop 1
    v_permlane32_swap_b32 v224, v226
    v_max_f32 v226, v226, v224
    v_cmp_lt_f32 vcc, s32, v226
    s_nop 1
    v_cndmask_b32 v227, 0, v226, vcc
    v_exp_f32 v228, -v227
    v_sub_f32 v144, v144, v227
    v_sub_f32 v145, v145, v227
    v_sub_f32 v146, v146, v227
    v_sub_f32 v147, v147, v227
    v_sub_f32 v148, v148, v227
    v_sub_f32 v149, v149, v227
    v_sub_f32 v150, v150, v227
    v_sub_f32 v151, v151, v227
    v_sub_f32 v152, v152, v227
    v_sub_f32 v153, v153, v227
    v_sub_f32 v154, v154, v227
    v_sub_f32 v155, v155, v227
    v_sub_f32 v156, v156, v227
    v_sub_f32 v157, v157, v227
    v_sub_f32 v158, v158, v227
    v_sub_f32 v159, v159, v227
    v_sub_f32 v32, v32, v227
    v_sub_f32 v33, v33, v227
    v_sub_f32 v34, v34, v227
    v_sub_f32 v35, v35, v227
    v_sub_f32 v36, v36, v227
    v_sub_f32 v37, v37, v227
    v_sub_f32 v38, v38, v227
    v_sub_f32 v39, v39, v227
    v_sub_f32 v40, v40, v227
    v_sub_f32 v41, v41, v227
    v_sub_f32 v42, v42, v227
    v_sub_f32 v43, v43, v227
    v_sub_f32 v44, v44, v227
    v_sub_f32 v45, v45, v227
    v_sub_f32 v46, v46, v227
    v_sub_f32 v47, v47, v227
    v_mul_f32 v31, v31, v228
    v_mul_f32 v225, v225, v228
    v_mul_f32 v48, v48, v228
    v_mul_f32 v49, v49, v228
    v_mul_f32 v50, v50, v228
    v_mul_f32 v51, v51, v228
    v_mul_f32 v52, v52, v228
    v_mul_f32 v53, v53, v228
    v_mul_f32 v54, v54, v228
    v_mul_f32 v55, v55, v228
    v_mul_f32 v56, v56, v228
    v_mul_f32 v57, v57, v228
    v_mul_f32 v58, v58, v228
    v_mul_f32 v59, v59, v228
    v_mul_f32 v60, v60, v228
    v_mul_f32 v61, v61, v228
    v_mul_f32 v62, v62, v228
    v_mul_f32 v63, v63, v228
    v_mul_f32 v64, v64, v228
    v_mul_f32 v65, v65, v228
    v_mul_f32 v66, v66, v228
    v_mul_f32 v67, v67, v228
    v_mul_f32 v68, v68, v228
    v_mul_f32 v69, v69, v228
    v_mul_f32 v70, v70, v228
    v_mul_f32 v71, v71, v228
    v_mul_f32 v72, v72, v228
    v_mul_f32 v73, v73, v228
    v_mul_f32 v74, v74, v228
    v_mul_f32 v75, v75, v228
    v_mul_f32 v76, v76, v228
    v_mul_f32 v77, v77, v228
    v_mul_f32 v78, v78, v228
    v_mul_f32 v79, v79, v228
    v_mul_f32 v80, v80, v228
    v_mul_f32 v81, v81, v228
    v_mul_f32 v82, v82, v228
    v_mul_f32 v83, v83, v228
    v_mul_f32 v84, v84, v228
    v_mul_f32 v85, v85, v228
    v_mul_f32 v86, v86, v228
    v_mul_f32 v87, v87, v228
    v_mul_f32 v88, v88, v228
    v_mul_f32 v89, v89, v228
    v_mul_f32 v90, v90, v228
    v_mul_f32 v91, v91, v228
    v_mul_f32 v92, v92, v228
    v_mul_f32 v93, v93, v228
    v_mul_f32 v94, v94, v228
    v_mul_f32 v95, v95, v228
    v_mul_f32 v96, v96, v228
    v_mul_f32 v97, v97, v228
    v_mul_f32 v98, v98, v228
    v_mul_f32 v99, v99, v228
    v_mul_f32 v100, v100, v228
    v_mul_f32 v101, v101, v228
    v_mul_f32 v102, v102, v228
    v_mul_f32 v103, v103, v228
    v_mul_f32 v104, v104, v228
    v_mul_f32 v105, v105, v228
    v_mul_f32 v106, v106, v228
    v_mul_f32 v107, v107, v228
    v_mul_f32 v108, v108, v228
    v_mul_f32 v109, v109, v228
    v_mul_f32 v110, v110, v228
    v_mul_f32 v111, v111, v228
    v_lshlrev_b32 v226, 16, v184
    v_and_b32 v227, 0xffff0000, v184
    v_mul_f32 v226, v226, v228
    v_mul_f32 v227, v227, v228
    v_cvt_pk_bf16_f32 v184, v226, v227
    v_lshlrev_b32 v226, 16, v185
    v_and_b32 v227, 0xffff0000, v185
    v_mul_f32 v226, v226, v228
    v_mul_f32 v227, v227, v228
    v_cvt_pk_bf16_f32 v185, v226, v227
    v_lshlrev_b32 v226, 16, v186
    v_and_b32 v227, 0xffff0000, v186
    v_mul_f32 v226, v226, v228
    v_mul_f32 v227, v227, v228
    v_cvt_pk_bf16_f32 v186, v226, v227
    v_lshlrev_b32 v226, 16, v187
    v_and_b32 v227, 0xffff0000, v187
    v_mul_f32 v226, v226, v228
    v_mul_f32 v227, v227, v228
    v_cvt_pk_bf16_f32 v187, v226, v227
    v_lshlrev_b32 v226, 16, v188
    v_and_b32 v227, 0xffff0000, v188
    v_mul_f32 v226, v226, v228
    v_mul_f32 v227, v227, v228
    v_cvt_pk_bf16_f32 v188, v226, v227
    v_lshlrev_b32 v226, 16, v189
    v_and_b32 v227, 0xffff0000, v189
    v_mul_f32 v226, v226, v228
    v_mul_f32 v227, v227, v228
    v_cvt_pk_bf16_f32 v189, v226, v227
    v_lshlrev_b32 v226, 16, v190
    v_and_b32 v227, 0xffff0000, v190
    v_mul_f32 v226, v226, v228
    v_mul_f32 v227, v227, v228
    v_cvt_pk_bf16_f32 v190, v226, v227
    v_lshlrev_b32 v226, 16, v191
    v_and_b32 v227, 0xffff0000, v191
    v_mul_f32 v226, v226, v228
    v_mul_f32 v227, v227, v228
    v_cvt_pk_bf16_f32 v191, v226, v227
    s_nop 3
    s_branch BACK_0_10

SLOW_0_11:
    s_nop 15
    v_mov_b32 v226, v224
    s_nop 1
    v_permlane32_swap_b32 v224, v226
    v_max_f32 v226, v226, v224
    v_cmp_lt_f32 vcc, s32, v226
    s_nop 1
    v_cndmask_b32 v227, 0, v226, vcc
    v_exp_f32 v228, -v227
    v_sub_f32 v160, v160, v227
    v_sub_f32 v161, v161, v227
    v_sub_f32 v162, v162, v227
    v_sub_f32 v163, v163, v227
    v_sub_f32 v164, v164, v227
    v_sub_f32 v165, v165, v227
    v_sub_f32 v166, v166, v227
    v_sub_f32 v167, v167, v227
    v_sub_f32 v168, v168, v227
    v_sub_f32 v169, v169, v227
    v_sub_f32 v170, v170, v227
    v_sub_f32 v171, v171, v227
    v_sub_f32 v172, v172, v227
    v_sub_f32 v173, v173, v227
    v_sub_f32 v174, v174, v227
    v_sub_f32 v175, v175, v227
    v_sub_f32 v32, v32, v227
    v_sub_f32 v33, v33, v227
    v_sub_f32 v34, v34, v227
    v_sub_f32 v35, v35, v227
    v_sub_f32 v36, v36, v227
    v_sub_f32 v37, v37, v227
    v_sub_f32 v38, v38, v227
    v_sub_f32 v39, v39, v227
    v_sub_f32 v40, v40, v227
    v_sub_f32 v41, v41, v227
    v_sub_f32 v42, v42, v227
    v_sub_f32 v43, v43, v227
    v_sub_f32 v44, v44, v227
    v_sub_f32 v45, v45, v227
    v_sub_f32 v46, v46, v227
    v_sub_f32 v47, v47, v227
    v_mul_f32 v31, v31, v228
    v_mul_f32 v225, v225, v228
    v_mul_f32 v48, v48, v228
    v_mul_f32 v49, v49, v228
    v_mul_f32 v50, v50, v228
    v_mul_f32 v51, v51, v228
    v_mul_f32 v52, v52, v228
    v_mul_f32 v53, v53, v228
    v_mul_f32 v54, v54, v228
    v_mul_f32 v55, v55, v228
    v_mul_f32 v56, v56, v228
    v_mul_f32 v57, v57, v228
    v_mul_f32 v58, v58, v228
    v_mul_f32 v59, v59, v228
    v_mul_f32 v60, v60, v228
    v_mul_f32 v61, v61, v228
    v_mul_f32 v62, v62, v228
    v_mul_f32 v63, v63, v228
    v_mul_f32 v64, v64, v228
    v_mul_f32 v65, v65, v228
    v_mul_f32 v66, v66, v228
    v_mul_f32 v67, v67, v228
    v_mul_f32 v68, v68, v228
    v_mul_f32 v69, v69, v228
    v_mul_f32 v70, v70, v228
    v_mul_f32 v71, v71, v228
    v_mul_f32 v72, v72, v228
    v_mul_f32 v73, v73, v228
    v_mul_f32 v74, v74, v228
    v_mul_f32 v75, v75, v228
    v_mul_f32 v76, v76, v228
    v_mul_f32 v77, v77, v228
    v_mul_f32 v78, v78, v228
    v_mul_f32 v79, v79, v228
    v_mul_f32 v80, v80, v228
    v_mul_f32 v81, v81, v228
    v_mul_f32 v82, v82, v228
    v_mul_f32 v83, v83, v228
    v_mul_f32 v84, v84, v228
    v_mul_f32 v85, v85, v228
    v_mul_f32 v86, v86, v228
    v_mul_f32 v87, v87, v228
    v_mul_f32 v88, v88, v228
    v_mul_f32 v89, v89, v228
    v_mul_f32 v90, v90, v228
    v_mul_f32 v91, v91, v228
    v_mul_f32 v92, v92, v228
    v_mul_f32 v93, v93, v228
    v_mul_f32 v94, v94, v228
    v_mul_f32 v95, v95, v228
    v_mul_f32 v96, v96, v228
    v_mul_f32 v97, v97, v228
    v_mul_f32 v98, v98, v228
    v_mul_f32 v99, v99, v228
    v_mul_f32 v100, v100, v228
    v_mul_f32 v101, v101, v228
    v_mul_f32 v102, v102, v228
    v_mul_f32 v103, v103, v228
    v_mul_f32 v104, v104, v228
    v_mul_f32 v105, v105, v228
    v_mul_f32 v106, v106, v228
    v_mul_f32 v107, v107, v228
    v_mul_f32 v108, v108, v228
    v_mul_f32 v109, v109, v228
    v_mul_f32 v110, v110, v228
    v_mul_f32 v111, v111, v228
    v_lshlrev_b32 v226, 16, v176
    v_and_b32 v227, 0xffff0000, v176
    v_mul_f32 v226, v226, v228
    v_mul_f32 v227, v227, v228
    v_cvt_pk_bf16_f32 v176, v226, v227
    v_lshlrev_b32 v226, 16, v177
    v_and_b32 v227, 0xffff0000, v177
    v_mul_f32 v226, v226, v228
    v_mul_f32 v227, v227, v228
    v_cvt_pk_bf16_f32 v177, v226, v227
    v_lshlrev_b32 v226, 16, v178
    v_and_b32 v227, 0xffff0000, v178
    v_mul_f32 v226, v226, v228
    v_mul_f32 v227, v227, v228
    v_cvt_pk_bf16_f32 v178, v226, v227
    v_lshlrev_b32 v226, 16, v179
    v_and_b32 v227, 0xffff0000, v179
    v_mul_f32 v226, v226, v228
    v_mul_f32 v227, v227, v228
    v_cvt_pk_bf16_f32 v179, v226, v227
    v_lshlrev_b32 v226, 16, v180
    v_and_b32 v227, 0xffff0000, v180
    v_mul_f32 v226, v226, v228
    v_mul_f32 v227, v227, v228
    v_cvt_pk_bf16_f32 v180, v226, v227
    v_lshlrev_b32 v226, 16, v181
    v_and_b32 v227, 0xffff0000, v181
    v_mul_f32 v226, v226, v228
    v_mul_f32 v227, v227, v228
    v_cvt_pk_bf16_f32 v181, v226, v227
    v_lshlrev_b32 v226, 16, v182
    v_and_b32 v227, 0xffff0000, v182
    v_mul_f32 v226, v226, v228
    v_mul_f32 v227, v227, v228
    v_cvt_pk_bf16_f32 v182, v226, v227
    v_lshlrev_b32 v226, 16, v183
    v_and_b32 v227, 0xffff0000, v183
    v_mul_f32 v226, v226, v228
    v_mul_f32 v227, v227, v228
    v_cvt_pk_bf16_f32 v183, v226, v227
    s_nop 3
    s_branch BACK_0_11

SLOW_0_12:
    s_nop 15
    v_mov_b32 v226, v224
    s_nop 1
    v_permlane32_swap_b32 v224, v226
    v_max_f32 v226, v226, v224
    v_cmp_lt_f32 vcc, s32, v226
    s_nop 1
    v_cndmask_b32 v227, 0, v226, vcc
    v_exp_f32 v228, -v227
    v_sub_f32 v144, v144, v227
    v_sub_f32 v145, v145, v227
    v_sub_f32 v146, v146, v227
    v_sub_f32 v147, v147, v227
    v_sub_f32 v148, v148, v227
    v_sub_f32 v149, v149, v227
    v_sub_f32 v150, v150, v227
    v_sub_f32 v151, v151, v227
    v_sub_f32 v152, v152, v227
    v_sub_f32 v153, v153, v227
    v_sub_f32 v154, v154, v227
    v_sub_f32 v155, v155, v227
    v_sub_f32 v156, v156, v227
    v_sub_f32 v157, v157, v227
    v_sub_f32 v158, v158, v227
    v_sub_f32 v159, v159, v227
    v_sub_f32 v32, v32, v227
    v_sub_f32 v33, v33, v227
    v_sub_f32 v34, v34, v227
    v_sub_f32 v35, v35, v227
    v_sub_f32 v36, v36, v227
    v_sub_f32 v37, v37, v227
    v_sub_f32 v38, v38, v227
    v_sub_f32 v39, v39, v227
    v_sub_f32 v40, v40, v227
    v_sub_f32 v41, v41, v227
    v_sub_f32 v42, v42, v227
    v_sub_f32 v43, v43, v227
    v_sub_f32 v44, v44, v227
    v_sub_f32 v45, v45, v227
    v_sub_f32 v46, v46, v227
    v_sub_f32 v47, v47, v227
    v_mul_f32 v31, v31, v228
    v_mul_f32 v225, v225, v228
    v_mul_f32 v48, v48, v228
    v_mul_f32 v49, v49, v228
    v_mul_f32 v50, v50, v228
    v_mul_f32 v51, v51, v228
    v_mul_f32 v52, v52, v228
    v_mul_f32 v53, v53, v228
    v_mul_f32 v54, v54, v228
    v_mul_f32 v55, v55, v228
    v_mul_f32 v56, v56, v228
    v_mul_f32 v57, v57, v228
    v_mul_f32 v58, v58, v228
    v_mul_f32 v59, v59, v228
    v_mul_f32 v60, v60, v228
    v_mul_f32 v61, v61, v228
    v_mul_f32 v62, v62, v228
    v_mul_f32 v63, v63, v228
    v_mul_f32 v64, v64, v228
    v_mul_f32 v65, v65, v228
    v_mul_f32 v66, v66, v228
    v_mul_f32 v67, v67, v228
    v_mul_f32 v68, v68, v228
    v_mul_f32 v69, v69, v228
    v_mul_f32 v70, v70, v228
    v_mul_f32 v71, v71, v228
    v_mul_f32 v72, v72, v228
    v_mul_f32 v73, v73, v228
    v_mul_f32 v74, v74, v228
    v_mul_f32 v75, v75, v228
    v_mul_f32 v76, v76, v228
    v_mul_f32 v77, v77, v228
    v_mul_f32 v78, v78, v228
    v_mul_f32 v79, v79, v228
    v_mul_f32 v80, v80, v228
    v_mul_f32 v81, v81, v228
    v_mul_f32 v82, v82, v228
    v_mul_f32 v83, v83, v228
    v_mul_f32 v84, v84, v228
    v_mul_f32 v85, v85, v228
    v_mul_f32 v86, v86, v228
    v_mul_f32 v87, v87, v228
    v_mul_f32 v88, v88, v228
    v_mul_f32 v89, v89, v228
    v_mul_f32 v90, v90, v228
    v_mul_f32 v91, v91, v228
    v_mul_f32 v92, v92, v228
    v_mul_f32 v93, v93, v228
    v_mul_f32 v94, v94, v228
    v_mul_f32 v95, v95, v228
    v_mul_f32 v96, v96, v228
    v_mul_f32 v97, v97, v228
    v_mul_f32 v98, v98, v228
    v_mul_f32 v99, v99, v228
    v_mul_f32 v100, v100, v228
    v_mul_f32 v101, v101, v228
    v_mul_f32 v102, v102, v228
    v_mul_f32 v103, v103, v228
    v_mul_f32 v104, v104, v228
    v_mul_f32 v105, v105, v228
    v_mul_f32 v106, v106, v228
    v_mul_f32 v107, v107, v228
    v_mul_f32 v108, v108, v228
    v_mul_f32 v109, v109, v228
    v_mul_f32 v110, v110, v228
    v_mul_f32 v111, v111, v228
    v_lshlrev_b32 v226, 16, v184
    v_and_b32 v227, 0xffff0000, v184
    v_mul_f32 v226, v226, v228
    v_mul_f32 v227, v227, v228
    v_cvt_pk_bf16_f32 v184, v226, v227
    v_lshlrev_b32 v226, 16, v185
    v_and_b32 v227, 0xffff0000, v185
    v_mul_f32 v226, v226, v228
    v_mul_f32 v227, v227, v228
    v_cvt_pk_bf16_f32 v185, v226, v227
    v_lshlrev_b32 v226, 16, v186
    v_and_b32 v227, 0xffff0000, v186
    v_mul_f32 v226, v226, v228
    v_mul_f32 v227, v227, v228
    v_cvt_pk_bf16_f32 v186, v226, v227
    v_lshlrev_b32 v226, 16, v187
    v_and_b32 v227, 0xffff0000, v187
    v_mul_f32 v226, v226, v228
    v_mul_f32 v227, v227, v228
    v_cvt_pk_bf16_f32 v187, v226, v227
    v_lshlrev_b32 v226, 16, v188
    v_and_b32 v227, 0xffff0000, v188
    v_mul_f32 v226, v226, v228
    v_mul_f32 v227, v227, v228
    v_cvt_pk_bf16_f32 v188, v226, v227
    v_lshlrev_b32 v226, 16, v189
    v_and_b32 v227, 0xffff0000, v189
    v_mul_f32 v226, v226, v228
    v_mul_f32 v227, v227, v228
    v_cvt_pk_bf16_f32 v189, v226, v227
    v_lshlrev_b32 v226, 16, v190
    v_and_b32 v227, 0xffff0000, v190
    v_mul_f32 v226, v226, v228
    v_mul_f32 v227, v227, v228
    v_cvt_pk_bf16_f32 v190, v226, v227
    v_lshlrev_b32 v226, 16, v191
    v_and_b32 v227, 0xffff0000, v191
    v_mul_f32 v226, v226, v228
    v_mul_f32 v227, v227, v228
    v_cvt_pk_bf16_f32 v191, v226, v227
    s_nop 3
    s_branch BACK_0_12

SLOW_0_13:
    s_nop 15
    v_mov_b32 v226, v224
    s_nop 1
    v_permlane32_swap_b32 v224, v226
    v_max_f32 v226, v226, v224
    v_cmp_lt_f32 vcc, s32, v226
    s_nop 1
    v_cndmask_b32 v227, 0, v226, vcc
    v_exp_f32 v228, -v227
    v_sub_f32 v160, v160, v227
    v_sub_f32 v161, v161, v227
    v_sub_f32 v162, v162, v227
    v_sub_f32 v163, v163, v227
    v_sub_f32 v164, v164, v227
    v_sub_f32 v165, v165, v227
    v_sub_f32 v166, v166, v227
    v_sub_f32 v167, v167, v227
    v_sub_f32 v168, v168, v227
    v_sub_f32 v169, v169, v227
    v_sub_f32 v170, v170, v227
    v_sub_f32 v171, v171, v227
    v_sub_f32 v172, v172, v227
    v_sub_f32 v173, v173, v227
    v_sub_f32 v174, v174, v227
    v_sub_f32 v175, v175, v227
    v_sub_f32 v32, v32, v227
    v_sub_f32 v33, v33, v227
    v_sub_f32 v34, v34, v227
    v_sub_f32 v35, v35, v227
    v_sub_f32 v36, v36, v227
    v_sub_f32 v37, v37, v227
    v_sub_f32 v38, v38, v227
    v_sub_f32 v39, v39, v227
    v_sub_f32 v40, v40, v227
    v_sub_f32 v41, v41, v227
    v_sub_f32 v42, v42, v227
    v_sub_f32 v43, v43, v227
    v_sub_f32 v44, v44, v227
    v_sub_f32 v45, v45, v227
    v_sub_f32 v46, v46, v227
    v_sub_f32 v47, v47, v227
    v_mul_f32 v31, v31, v228
    v_mul_f32 v225, v225, v228
    v_mul_f32 v48, v48, v228
    v_mul_f32 v49, v49, v228
    v_mul_f32 v50, v50, v228
    v_mul_f32 v51, v51, v228
    v_mul_f32 v52, v52, v228
    v_mul_f32 v53, v53, v228
    v_mul_f32 v54, v54, v228
    v_mul_f32 v55, v55, v228
    v_mul_f32 v56, v56, v228
    v_mul_f32 v57, v57, v228
    v_mul_f32 v58, v58, v228
    v_mul_f32 v59, v59, v228
    v_mul_f32 v60, v60, v228
    v_mul_f32 v61, v61, v228
    v_mul_f32 v62, v62, v228
    v_mul_f32 v63, v63, v228
    v_mul_f32 v64, v64, v228
    v_mul_f32 v65, v65, v228
    v_mul_f32 v66, v66, v228
    v_mul_f32 v67, v67, v228
    v_mul_f32 v68, v68, v228
    v_mul_f32 v69, v69, v228
    v_mul_f32 v70, v70, v228
    v_mul_f32 v71, v71, v228
    v_mul_f32 v72, v72, v228
    v_mul_f32 v73, v73, v228
    v_mul_f32 v74, v74, v228
    v_mul_f32 v75, v75, v228
    v_mul_f32 v76, v76, v228
    v_mul_f32 v77, v77, v228
    v_mul_f32 v78, v78, v228
    v_mul_f32 v79, v79, v228
    v_mul_f32 v80, v80, v228
    v_mul_f32 v81, v81, v228
    v_mul_f32 v82, v82, v228
    v_mul_f32 v83, v83, v228
    v_mul_f32 v84, v84, v228
    v_mul_f32 v85, v85, v228
    v_mul_f32 v86, v86, v228
    v_mul_f32 v87, v87, v228
    v_mul_f32 v88, v88, v228
    v_mul_f32 v89, v89, v228
    v_mul_f32 v90, v90, v228
    v_mul_f32 v91, v91, v228
    v_mul_f32 v92, v92, v228
    v_mul_f32 v93, v93, v228
    v_mul_f32 v94, v94, v228
    v_mul_f32 v95, v95, v228
    v_mul_f32 v96, v96, v228
    v_mul_f32 v97, v97, v228
    v_mul_f32 v98, v98, v228
    v_mul_f32 v99, v99, v228
    v_mul_f32 v100, v100, v228
    v_mul_f32 v101, v101, v228
    v_mul_f32 v102, v102, v228
    v_mul_f32 v103, v103, v228
    v_mul_f32 v104, v104, v228
    v_mul_f32 v105, v105, v228
    v_mul_f32 v106, v106, v228
    v_mul_f32 v107, v107, v228
    v_mul_f32 v108, v108, v228
    v_mul_f32 v109, v109, v228
    v_mul_f32 v110, v110, v228
    v_mul_f32 v111, v111, v228
    v_lshlrev_b32 v226, 16, v176
    v_and_b32 v227, 0xffff0000, v176
    v_mul_f32 v226, v226, v228
    v_mul_f32 v227, v227, v228
    v_cvt_pk_bf16_f32 v176, v226, v227
    v_lshlrev_b32 v226, 16, v177
    v_and_b32 v227, 0xffff0000, v177
    v_mul_f32 v226, v226, v228
    v_mul_f32 v227, v227, v228
    v_cvt_pk_bf16_f32 v177, v226, v227
    v_lshlrev_b32 v226, 16, v178
    v_and_b32 v227, 0xffff0000, v178
    v_mul_f32 v226, v226, v228
    v_mul_f32 v227, v227, v228
    v_cvt_pk_bf16_f32 v178, v226, v227
    v_lshlrev_b32 v226, 16, v179
    v_and_b32 v227, 0xffff0000, v179
    v_mul_f32 v226, v226, v228
    v_mul_f32 v227, v227, v228
    v_cvt_pk_bf16_f32 v179, v226, v227
    v_lshlrev_b32 v226, 16, v180
    v_and_b32 v227, 0xffff0000, v180
    v_mul_f32 v226, v226, v228
    v_mul_f32 v227, v227, v228
    v_cvt_pk_bf16_f32 v180, v226, v227
    v_lshlrev_b32 v226, 16, v181
    v_and_b32 v227, 0xffff0000, v181
    v_mul_f32 v226, v226, v228
    v_mul_f32 v227, v227, v228
    v_cvt_pk_bf16_f32 v181, v226, v227
    v_lshlrev_b32 v226, 16, v182
    v_and_b32 v227, 0xffff0000, v182
    v_mul_f32 v226, v226, v228
    v_mul_f32 v227, v227, v228
    v_cvt_pk_bf16_f32 v182, v226, v227
    v_lshlrev_b32 v226, 16, v183
    v_and_b32 v227, 0xffff0000, v183
    v_mul_f32 v226, v226, v228
    v_mul_f32 v227, v227, v228
    v_cvt_pk_bf16_f32 v183, v226, v227
    s_nop 3
    s_branch BACK_0_13

SLOW_0_14:
    s_nop 15
    v_mov_b32 v226, v224
    s_nop 1
    v_permlane32_swap_b32 v224, v226
    v_max_f32 v226, v226, v224
    v_cmp_lt_f32 vcc, s32, v226
    s_nop 1
    v_cndmask_b32 v227, 0, v226, vcc
    v_exp_f32 v228, -v227
    v_sub_f32 v144, v144, v227
    v_sub_f32 v145, v145, v227
    v_sub_f32 v146, v146, v227
    v_sub_f32 v147, v147, v227
    v_sub_f32 v148, v148, v227
    v_sub_f32 v149, v149, v227
    v_sub_f32 v150, v150, v227
    v_sub_f32 v151, v151, v227
    v_sub_f32 v152, v152, v227
    v_sub_f32 v153, v153, v227
    v_sub_f32 v154, v154, v227
    v_sub_f32 v155, v155, v227
    v_sub_f32 v156, v156, v227
    v_sub_f32 v157, v157, v227
    v_sub_f32 v158, v158, v227
    v_sub_f32 v159, v159, v227
    v_sub_f32 v32, v32, v227
    v_sub_f32 v33, v33, v227
    v_sub_f32 v34, v34, v227
    v_sub_f32 v35, v35, v227
    v_sub_f32 v36, v36, v227
    v_sub_f32 v37, v37, v227
    v_sub_f32 v38, v38, v227
    v_sub_f32 v39, v39, v227
    v_sub_f32 v40, v40, v227
    v_sub_f32 v41, v41, v227
    v_sub_f32 v42, v42, v227
    v_sub_f32 v43, v43, v227
    v_sub_f32 v44, v44, v227
    v_sub_f32 v45, v45, v227
    v_sub_f32 v46, v46, v227
    v_sub_f32 v47, v47, v227
    v_mul_f32 v31, v31, v228
    v_mul_f32 v225, v225, v228
    v_mul_f32 v48, v48, v228
    v_mul_f32 v49, v49, v228
    v_mul_f32 v50, v50, v228
    v_mul_f32 v51, v51, v228
    v_mul_f32 v52, v52, v228
    v_mul_f32 v53, v53, v228
    v_mul_f32 v54, v54, v228
    v_mul_f32 v55, v55, v228
    v_mul_f32 v56, v56, v228
    v_mul_f32 v57, v57, v228
    v_mul_f32 v58, v58, v228
    v_mul_f32 v59, v59, v228
    v_mul_f32 v60, v60, v228
    v_mul_f32 v61, v61, v228
    v_mul_f32 v62, v62, v228
    v_mul_f32 v63, v63, v228
    v_mul_f32 v64, v64, v228
    v_mul_f32 v65, v65, v228
    v_mul_f32 v66, v66, v228
    v_mul_f32 v67, v67, v228
    v_mul_f32 v68, v68, v228
    v_mul_f32 v69, v69, v228
    v_mul_f32 v70, v70, v228
    v_mul_f32 v71, v71, v228
    v_mul_f32 v72, v72, v228
    v_mul_f32 v73, v73, v228
    v_mul_f32 v74, v74, v228
    v_mul_f32 v75, v75, v228
    v_mul_f32 v76, v76, v228
    v_mul_f32 v77, v77, v228
    v_mul_f32 v78, v78, v228
    v_mul_f32 v79, v79, v228
    v_mul_f32 v80, v80, v228
    v_mul_f32 v81, v81, v228
    v_mul_f32 v82, v82, v228
    v_mul_f32 v83, v83, v228
    v_mul_f32 v84, v84, v228
    v_mul_f32 v85, v85, v228
    v_mul_f32 v86, v86, v228
    v_mul_f32 v87, v87, v228
    v_mul_f32 v88, v88, v228
    v_mul_f32 v89, v89, v228
    v_mul_f32 v90, v90, v228
    v_mul_f32 v91, v91, v228
    v_mul_f32 v92, v92, v228
    v_mul_f32 v93, v93, v228
    v_mul_f32 v94, v94, v228
    v_mul_f32 v95, v95, v228
    v_mul_f32 v96, v96, v228
    v_mul_f32 v97, v97, v228
    v_mul_f32 v98, v98, v228
    v_mul_f32 v99, v99, v228
    v_mul_f32 v100, v100, v228
    v_mul_f32 v101, v101, v228
    v_mul_f32 v102, v102, v228
    v_mul_f32 v103, v103, v228
    v_mul_f32 v104, v104, v228
    v_mul_f32 v105, v105, v228
    v_mul_f32 v106, v106, v228
    v_mul_f32 v107, v107, v228
    v_mul_f32 v108, v108, v228
    v_mul_f32 v109, v109, v228
    v_mul_f32 v110, v110, v228
    v_mul_f32 v111, v111, v228
    v_lshlrev_b32 v226, 16, v184
    v_and_b32 v227, 0xffff0000, v184
    v_mul_f32 v226, v226, v228
    v_mul_f32 v227, v227, v228
    v_cvt_pk_bf16_f32 v184, v226, v227
    v_lshlrev_b32 v226, 16, v185
    v_and_b32 v227, 0xffff0000, v185
    v_mul_f32 v226, v226, v228
    v_mul_f32 v227, v227, v228
    v_cvt_pk_bf16_f32 v185, v226, v227
    v_lshlrev_b32 v226, 16, v186
    v_and_b32 v227, 0xffff0000, v186
    v_mul_f32 v226, v226, v228
    v_mul_f32 v227, v227, v228
    v_cvt_pk_bf16_f32 v186, v226, v227
    v_lshlrev_b32 v226, 16, v187
    v_and_b32 v227, 0xffff0000, v187
    v_mul_f32 v226, v226, v228
    v_mul_f32 v227, v227, v228
    v_cvt_pk_bf16_f32 v187, v226, v227
    v_lshlrev_b32 v226, 16, v188
    v_and_b32 v227, 0xffff0000, v188
    v_mul_f32 v226, v226, v228
    v_mul_f32 v227, v227, v228
    v_cvt_pk_bf16_f32 v188, v226, v227
    v_lshlrev_b32 v226, 16, v189
    v_and_b32 v227, 0xffff0000, v189
    v_mul_f32 v226, v226, v228
    v_mul_f32 v227, v227, v228
    v_cvt_pk_bf16_f32 v189, v226, v227
    v_lshlrev_b32 v226, 16, v190
    v_and_b32 v227, 0xffff0000, v190
    v_mul_f32 v226, v226, v228
    v_mul_f32 v227, v227, v228
    v_cvt_pk_bf16_f32 v190, v226, v227
    v_lshlrev_b32 v226, 16, v191
    v_and_b32 v227, 0xffff0000, v191
    v_mul_f32 v226, v226, v228
    v_mul_f32 v227, v227, v228
    v_cvt_pk_bf16_f32 v191, v226, v227
    s_nop 3
    s_branch BACK_0_14

SLOW_0_15:
    s_nop 15
    v_mov_b32 v226, v224
    s_nop 1
    v_permlane32_swap_b32 v224, v226
    v_max_f32 v226, v226, v224
    v_cmp_lt_f32 vcc, s32, v226
    s_nop 1
    v_cndmask_b32 v227, 0, v226, vcc
    v_exp_f32 v228, -v227
    v_sub_f32 v160, v160, v227
    v_sub_f32 v161, v161, v227
    v_sub_f32 v162, v162, v227
    v_sub_f32 v163, v163, v227
    v_sub_f32 v164, v164, v227
    v_sub_f32 v165, v165, v227
    v_sub_f32 v166, v166, v227
    v_sub_f32 v167, v167, v227
    v_sub_f32 v168, v168, v227
    v_sub_f32 v169, v169, v227
    v_sub_f32 v170, v170, v227
    v_sub_f32 v171, v171, v227
    v_sub_f32 v172, v172, v227
    v_sub_f32 v173, v173, v227
    v_sub_f32 v174, v174, v227
    v_sub_f32 v175, v175, v227
    v_sub_f32 v32, v32, v227
    v_sub_f32 v33, v33, v227
    v_sub_f32 v34, v34, v227
    v_sub_f32 v35, v35, v227
    v_sub_f32 v36, v36, v227
    v_sub_f32 v37, v37, v227
    v_sub_f32 v38, v38, v227
    v_sub_f32 v39, v39, v227
    v_sub_f32 v40, v40, v227
    v_sub_f32 v41, v41, v227
    v_sub_f32 v42, v42, v227
    v_sub_f32 v43, v43, v227
    v_sub_f32 v44, v44, v227
    v_sub_f32 v45, v45, v227
    v_sub_f32 v46, v46, v227
    v_sub_f32 v47, v47, v227
    v_mul_f32 v31, v31, v228
    v_mul_f32 v225, v225, v228
    v_mul_f32 v48, v48, v228
    v_mul_f32 v49, v49, v228
    v_mul_f32 v50, v50, v228
    v_mul_f32 v51, v51, v228
    v_mul_f32 v52, v52, v228
    v_mul_f32 v53, v53, v228
    v_mul_f32 v54, v54, v228
    v_mul_f32 v55, v55, v228
    v_mul_f32 v56, v56, v228
    v_mul_f32 v57, v57, v228
    v_mul_f32 v58, v58, v228
    v_mul_f32 v59, v59, v228
    v_mul_f32 v60, v60, v228
    v_mul_f32 v61, v61, v228
    v_mul_f32 v62, v62, v228
    v_mul_f32 v63, v63, v228
    v_mul_f32 v64, v64, v228
    v_mul_f32 v65, v65, v228
    v_mul_f32 v66, v66, v228
    v_mul_f32 v67, v67, v228
    v_mul_f32 v68, v68, v228
    v_mul_f32 v69, v69, v228
    v_mul_f32 v70, v70, v228
    v_mul_f32 v71, v71, v228
    v_mul_f32 v72, v72, v228
    v_mul_f32 v73, v73, v228
    v_mul_f32 v74, v74, v228
    v_mul_f32 v75, v75, v228
    v_mul_f32 v76, v76, v228
    v_mul_f32 v77, v77, v228
    v_mul_f32 v78, v78, v228
    v_mul_f32 v79, v79, v228
    v_mul_f32 v80, v80, v228
    v_mul_f32 v81, v81, v228
    v_mul_f32 v82, v82, v228
    v_mul_f32 v83, v83, v228
    v_mul_f32 v84, v84, v228
    v_mul_f32 v85, v85, v228
    v_mul_f32 v86, v86, v228
    v_mul_f32 v87, v87, v228
    v_mul_f32 v88, v88, v228
    v_mul_f32 v89, v89, v228
    v_mul_f32 v90, v90, v228
    v_mul_f32 v91, v91, v228
    v_mul_f32 v92, v92, v228
    v_mul_f32 v93, v93, v228
    v_mul_f32 v94, v94, v228
    v_mul_f32 v95, v95, v228
    v_mul_f32 v96, v96, v228
    v_mul_f32 v97, v97, v228
    v_mul_f32 v98, v98, v228
    v_mul_f32 v99, v99, v228
    v_mul_f32 v100, v100, v228
    v_mul_f32 v101, v101, v228
    v_mul_f32 v102, v102, v228
    v_mul_f32 v103, v103, v228
    v_mul_f32 v104, v104, v228
    v_mul_f32 v105, v105, v228
    v_mul_f32 v106, v106, v228
    v_mul_f32 v107, v107, v228
    v_mul_f32 v108, v108, v228
    v_mul_f32 v109, v109, v228
    v_mul_f32 v110, v110, v228
    v_mul_f32 v111, v111, v228
    v_lshlrev_b32 v226, 16, v176
    v_and_b32 v227, 0xffff0000, v176
    v_mul_f32 v226, v226, v228
    v_mul_f32 v227, v227, v228
    v_cvt_pk_bf16_f32 v176, v226, v227
    v_lshlrev_b32 v226, 16, v177
    v_and_b32 v227, 0xffff0000, v177
    v_mul_f32 v226, v226, v228
    v_mul_f32 v227, v227, v228
    v_cvt_pk_bf16_f32 v177, v226, v227
    v_lshlrev_b32 v226, 16, v178
    v_and_b32 v227, 0xffff0000, v178
    v_mul_f32 v226, v226, v228
    v_mul_f32 v227, v227, v228
    v_cvt_pk_bf16_f32 v178, v226, v227
    v_lshlrev_b32 v226, 16, v179
    v_and_b32 v227, 0xffff0000, v179
    v_mul_f32 v226, v226, v228
    v_mul_f32 v227, v227, v228
    v_cvt_pk_bf16_f32 v179, v226, v227
    v_lshlrev_b32 v226, 16, v180
    v_and_b32 v227, 0xffff0000, v180
    v_mul_f32 v226, v226, v228
    v_mul_f32 v227, v227, v228
    v_cvt_pk_bf16_f32 v180, v226, v227
    v_lshlrev_b32 v226, 16, v181
    v_and_b32 v227, 0xffff0000, v181
    v_mul_f32 v226, v226, v228
    v_mul_f32 v227, v227, v228
    v_cvt_pk_bf16_f32 v181, v226, v227
    v_lshlrev_b32 v226, 16, v182
    v_and_b32 v227, 0xffff0000, v182
    v_mul_f32 v226, v226, v228
    v_mul_f32 v227, v227, v228
    v_cvt_pk_bf16_f32 v182, v226, v227
    v_lshlrev_b32 v226, 16, v183
    v_and_b32 v227, 0xffff0000, v183
    v_mul_f32 v226, v226, v228
    v_mul_f32 v227, v227, v228
    v_cvt_pk_bf16_f32 v183, v226, v227
    s_nop 3
    s_branch BACK_0_15

SLOW_1_1:
    s_nop 15
    v_mov_b32 v226, v224
    s_nop 1
    v_permlane32_swap_b32 v224, v226
    v_max_f32 v226, v226, v224
    v_cmp_lt_f32 vcc, s32, v226
    s_nop 1
    v_cndmask_b32 v227, 0, v226, vcc
    v_exp_f32 v228, -v227
    v_sub_f32 v160, v160, v227
    v_sub_f32 v161, v161, v227
    v_sub_f32 v162, v162, v227
    v_sub_f32 v163, v163, v227
    v_sub_f32 v164, v164, v227
    v_sub_f32 v165, v165, v227
    v_sub_f32 v166, v166, v227
    v_sub_f32 v167, v167, v227
    v_sub_f32 v168, v168, v227
    v_sub_f32 v169, v169, v227
    v_sub_f32 v170, v170, v227
    v_sub_f32 v171, v171, v227
    v_sub_f32 v172, v172, v227
    v_sub_f32 v173, v173, v227
    v_sub_f32 v174, v174, v227
    v_sub_f32 v175, v175, v227
    v_sub_f32 v32, v32, v227
    v_sub_f32 v33, v33, v227
    v_sub_f32 v34, v34, v227
    v_sub_f32 v35, v35, v227
    v_sub_f32 v36, v36, v227
    v_sub_f32 v37, v37, v227
    v_sub_f32 v38, v38, v227
    v_sub_f32 v39, v39, v227
    v_sub_f32 v40, v40, v227
    v_sub_f32 v41, v41, v227
    v_sub_f32 v42, v42, v227
    v_sub_f32 v43, v43, v227
    v_sub_f32 v44, v44, v227
    v_sub_f32 v45, v45, v227
    v_sub_f32 v46, v46, v227
    v_sub_f32 v47, v47, v227
    v_mul_f32 v31, v31, v228
    v_mul_f32 v225, v225, v228
    v_lshlrev_b32 v226, 16, v176
    v_and_b32 v227, 0xffff0000, v176
    v_mul_f32 v226, v226, v228
    v_mul_f32 v227, v227, v228
    v_cvt_pk_bf16_f32 v176, v226, v227
    v_lshlrev_b32 v226, 16, v177
    v_and_b32 v227, 0xffff0000, v177
    v_mul_f32 v226, v226, v228
    v_mul_f32 v227, v227, v228
    v_cvt_pk_bf16_f32 v177, v226, v227
    v_lshlrev_b32 v226, 16, v178
    v_and_b32 v227, 0xffff0000, v178
    v_mul_f32 v226, v226, v228
    v_mul_f32 v227, v227, v228
    v_cvt_pk_bf16_f32 v178, v226, v227
    v_lshlrev_b32 v226, 16, v179
    v_and_b32 v227, 0xffff0000, v179
    v_mul_f32 v226, v226, v228
    v_mul_f32 v227, v227, v228
    v_cvt_pk_bf16_f32 v179, v226, v227
    v_lshlrev_b32 v226, 16, v180
    v_and_b32 v227, 0xffff0000, v180
    v_mul_f32 v226, v226, v228
    v_mul_f32 v227, v227, v228
    v_cvt_pk_bf16_f32 v180, v226, v227
    v_lshlrev_b32 v226, 16, v181
    v_and_b32 v227, 0xffff0000, v181
    v_mul_f32 v226, v226, v228
    v_mul_f32 v227, v227, v228
    v_cvt_pk_bf16_f32 v181, v226, v227
    v_lshlrev_b32 v226, 16, v182
    v_and_b32 v227, 0xffff0000, v182
    v_mul_f32 v226, v226, v228
    v_mul_f32 v227, v227, v228
    v_cvt_pk_bf16_f32 v182, v226, v227
    v_lshlrev_b32 v226, 16, v183
    v_and_b32 v227, 0xffff0000, v183
    v_mul_f32 v226, v226, v228
    v_mul_f32 v227, v227, v228
    v_cvt_pk_bf16_f32 v183, v226, v227
    s_nop 3
    s_branch BACK_1_1

SLOW_1_2:
    s_nop 15
    v_mov_b32 v226, v224
    s_nop 1
    v_permlane32_swap_b32 v224, v226
    v_max_f32 v226, v226, v224
    v_cmp_lt_f32 vcc, s32, v226
    s_nop 1
    v_cndmask_b32 v227, 0, v226, vcc
    v_exp_f32 v228, -v227
    v_sub_f32 v144, v144, v227
    v_sub_f32 v145, v145, v227
    v_sub_f32 v146, v146, v227
    v_sub_f32 v147, v147, v227
    v_sub_f32 v148, v148, v227
    v_sub_f32 v149, v149, v227
    v_sub_f32 v150, v150, v227
    v_sub_f32 v151, v151, v227
    v_sub_f32 v152, v152, v227
    v_sub_f32 v153, v153, v227
    v_sub_f32 v154, v154, v227
    v_sub_f32 v155, v155, v227
    v_sub_f32 v156, v156, v227
    v_sub_f32 v157, v157, v227
    v_sub_f32 v158, v158, v227
    v_sub_f32 v159, v159, v227
    v_sub_f32 v32, v32, v227
    v_sub_f32 v33, v33, v227
    v_sub_f32 v34, v34, v227
    v_sub_f32 v35, v35, v227
    v_sub_f32 v36, v36, v227
    v_sub_f32 v37, v37, v227
    v_sub_f32 v38, v38, v227
    v_sub_f32 v39, v39, v227
    v_sub_f32 v40, v40, v227
    v_sub_f32 v41, v41, v227
    v_sub_f32 v42, v42, v227
    v_sub_f32 v43, v43, v227
    v_sub_f32 v44, v44, v227
    v_sub_f32 v45, v45, v227
    v_sub_f32 v46, v46, v227
    v_sub_f32 v47, v47, v227
    v_mul_f32 v31, v31, v228
    v_mul_f32 v225, v225, v228
    v_mul_f32 v48, v48, v228
    v_mul_f32 v49, v49, v228
    v_mul_f32 v50, v50, v228
    v_mul_f32 v51, v51, v228
    v_mul_f32 v52, v52, v228
    v_mul_f32 v53, v53, v228
    v_mul_f32 v54, v54, v228
    v_mul_f32 v55, v55, v228
    v_mul_f32 v56, v56, v228
    v_mul_f32 v57, v57, v228
    v_mul_f32 v58, v58, v228
    v_mul_f32 v59, v59, v228
    v_mul_f32 v60, v60, v228
    v_mul_f32 v61, v61, v228
    v_mul_f32 v62, v62, v228
    v_mul_f32 v63, v63, v228
    v_mul_f32 v64, v64, v228
    v_mul_f32 v65, v65, v228
    v_mul_f32 v66, v66, v228
    v_mul_f32 v67, v67, v228
    v_mul_f32 v68, v68, v228
    v_mul_f32 v69, v69, v228
    v_mul_f32 v70, v70, v228
    v_mul_f32 v71, v71, v228
    v_mul_f32 v72, v72, v228
    v_mul_f32 v73, v73, v228
    v_mul_f32 v74, v74, v228
    v_mul_f32 v75, v75, v228
    v_mul_f32 v76, v76, v228
    v_mul_f32 v77, v77, v228
    v_mul_f32 v78, v78, v228
    v_mul_f32 v79, v79, v228
    v_mul_f32 v80, v80, v228
    v_mul_f32 v81, v81, v228
    v_mul_f32 v82, v82, v228
    v_mul_f32 v83, v83, v228
    v_mul_f32 v84, v84, v228
    v_mul_f32 v85, v85, v228
    v_mul_f32 v86, v86, v228
    v_mul_f32 v87, v87, v228
    v_mul_f32 v88, v88, v228
    v_mul_f32 v89, v89, v228
    v_mul_f32 v90, v90, v228
    v_mul_f32 v91, v91, v228
    v_mul_f32 v92, v92, v228
    v_mul_f32 v93, v93, v228
    v_mul_f32 v94, v94, v228
    v_mul_f32 v95, v95, v228
    v_mul_f32 v96, v96, v228
    v_mul_f32 v97, v97, v228
    v_mul_f32 v98, v98, v228
    v_mul_f32 v99, v99, v228
    v_mul_f32 v100, v100, v228
    v_mul_f32 v101, v101, v228
    v_mul_f32 v102, v102, v228
    v_mul_f32 v103, v103, v228
    v_mul_f32 v104, v104, v228
    v_mul_f32 v105, v105, v228
    v_mul_f32 v106, v106, v228
    v_mul_f32 v107, v107, v228
    v_mul_f32 v108, v108, v228
    v_mul_f32 v109, v109, v228
    v_mul_f32 v110, v110, v228
    v_mul_f32 v111, v111, v228
    v_lshlrev_b32 v226, 16, v184
    v_and_b32 v227, 0xffff0000, v184
    v_mul_f32 v226, v226, v228
    v_mul_f32 v227, v227, v228
    v_cvt_pk_bf16_f32 v184, v226, v227
    v_lshlrev_b32 v226, 16, v185
    v_and_b32 v227, 0xffff0000, v185
    v_mul_f32 v226, v226, v228
    v_mul_f32 v227, v227, v228
    v_cvt_pk_bf16_f32 v185, v226, v227
    v_lshlrev_b32 v226, 16, v186
    v_and_b32 v227, 0xffff0000, v186
    v_mul_f32 v226, v226, v228
    v_mul_f32 v227, v227, v228
    v_cvt_pk_bf16_f32 v186, v226, v227
    v_lshlrev_b32 v226, 16, v187
    v_and_b32 v227, 0xffff0000, v187
    v_mul_f32 v226, v226, v228
    v_mul_f32 v227, v227, v228
    v_cvt_pk_bf16_f32 v187, v226, v227
    v_lshlrev_b32 v226, 16, v188
    v_and_b32 v227, 0xffff0000, v188
    v_mul_f32 v226, v226, v228
    v_mul_f32 v227, v227, v228
    v_cvt_pk_bf16_f32 v188, v226, v227
    v_lshlrev_b32 v226, 16, v189
    v_and_b32 v227, 0xffff0000, v189
    v_mul_f32 v226, v226, v228
    v_mul_f32 v227, v227, v228
    v_cvt_pk_bf16_f32 v189, v226, v227
    v_lshlrev_b32 v226, 16, v190
    v_and_b32 v227, 0xffff0000, v190
    v_mul_f32 v226, v226, v228
    v_mul_f32 v227, v227, v228
    v_cvt_pk_bf16_f32 v190, v226, v227
    v_lshlrev_b32 v226, 16, v191
    v_and_b32 v227, 0xffff0000, v191
    v_mul_f32 v226, v226, v228
    v_mul_f32 v227, v227, v228
    v_cvt_pk_bf16_f32 v191, v226, v227
    s_nop 3
    s_branch BACK_1_2

SLOW_1_3:
    s_nop 15
    v_mov_b32 v226, v224
    s_nop 1
    v_permlane32_swap_b32 v224, v226
    v_max_f32 v226, v226, v224
    v_cmp_lt_f32 vcc, s32, v226
    s_nop 1
    v_cndmask_b32 v227, 0, v226, vcc
    v_exp_f32 v228, -v227
    v_sub_f32 v160, v160, v227
    v_sub_f32 v161, v161, v227
    v_sub_f32 v162, v162, v227
    v_sub_f32 v163, v163, v227
    v_sub_f32 v164, v164, v227
    v_sub_f32 v165, v165, v227
    v_sub_f32 v166, v166, v227
    v_sub_f32 v167, v167, v227
    v_sub_f32 v168, v168, v227
    v_sub_f32 v169, v169, v227
    v_sub_f32 v170, v170, v227
    v_sub_f32 v171, v171, v227
    v_sub_f32 v172, v172, v227
    v_sub_f32 v173, v173, v227
    v_sub_f32 v174, v174, v227
    v_sub_f32 v175, v175, v227
    v_sub_f32 v32, v32, v227
    v_sub_f32 v33, v33, v227
    v_sub_f32 v34, v34, v227
    v_sub_f32 v35, v35, v227
    v_sub_f32 v36, v36, v227
    v_sub_f32 v37, v37, v227
    v_sub_f32 v38, v38, v227
    v_sub_f32 v39, v39, v227
    v_sub_f32 v40, v40, v227
    v_sub_f32 v41, v41, v227
    v_sub_f32 v42, v42, v227
    v_sub_f32 v43, v43, v227
    v_sub_f32 v44, v44, v227
    v_sub_f32 v45, v45, v227
    v_sub_f32 v46, v46, v227
    v_sub_f32 v47, v47, v227
    v_mul_f32 v31, v31, v228
    v_mul_f32 v225, v225, v228
    v_mul_f32 v48, v48, v228
    v_mul_f32 v49, v49, v228
    v_mul_f32 v50, v50, v228
    v_mul_f32 v51, v51, v228
    v_mul_f32 v52, v52, v228
    v_mul_f32 v53, v53, v228
    v_mul_f32 v54, v54, v228
    v_mul_f32 v55, v55, v228
    v_mul_f32 v56, v56, v228
    v_mul_f32 v57, v57, v228
    v_mul_f32 v58, v58, v228
    v_mul_f32 v59, v59, v228
    v_mul_f32 v60, v60, v228
    v_mul_f32 v61, v61, v228
    v_mul_f32 v62, v62, v228
    v_mul_f32 v63, v63, v228
    v_mul_f32 v64, v64, v228
    v_mul_f32 v65, v65, v228
    v_mul_f32 v66, v66, v228
    v_mul_f32 v67, v67, v228
    v_mul_f32 v68, v68, v228
    v_mul_f32 v69, v69, v228
    v_mul_f32 v70, v70, v228
    v_mul_f32 v71, v71, v228
    v_mul_f32 v72, v72, v228
    v_mul_f32 v73, v73, v228
    v_mul_f32 v74, v74, v228
    v_mul_f32 v75, v75, v228
    v_mul_f32 v76, v76, v228
    v_mul_f32 v77, v77, v228
    v_mul_f32 v78, v78, v228
    v_mul_f32 v79, v79, v228
    v_mul_f32 v80, v80, v228
    v_mul_f32 v81, v81, v228
    v_mul_f32 v82, v82, v228
    v_mul_f32 v83, v83, v228
    v_mul_f32 v84, v84, v228
    v_mul_f32 v85, v85, v228
    v_mul_f32 v86, v86, v228
    v_mul_f32 v87, v87, v228
    v_mul_f32 v88, v88, v228
    v_mul_f32 v89, v89, v228
    v_mul_f32 v90, v90, v228
    v_mul_f32 v91, v91, v228
    v_mul_f32 v92, v92, v228
    v_mul_f32 v93, v93, v228
    v_mul_f32 v94, v94, v228
    v_mul_f32 v95, v95, v228
    v_mul_f32 v96, v96, v228
    v_mul_f32 v97, v97, v228
    v_mul_f32 v98, v98, v228
    v_mul_f32 v99, v99, v228
    v_mul_f32 v100, v100, v228
    v_mul_f32 v101, v101, v228
    v_mul_f32 v102, v102, v228
    v_mul_f32 v103, v103, v228
    v_mul_f32 v104, v104, v228
    v_mul_f32 v105, v105, v228
    v_mul_f32 v106, v106, v228
    v_mul_f32 v107, v107, v228
    v_mul_f32 v108, v108, v228
    v_mul_f32 v109, v109, v228
    v_mul_f32 v110, v110, v228
    v_mul_f32 v111, v111, v228
    v_lshlrev_b32 v226, 16, v176
    v_and_b32 v227, 0xffff0000, v176
    v_mul_f32 v226, v226, v228
    v_mul_f32 v227, v227, v228
    v_cvt_pk_bf16_f32 v176, v226, v227
    v_lshlrev_b32 v226, 16, v177
    v_and_b32 v227, 0xffff0000, v177
    v_mul_f32 v226, v226, v228
    v_mul_f32 v227, v227, v228
    v_cvt_pk_bf16_f32 v177, v226, v227
    v_lshlrev_b32 v226, 16, v178
    v_and_b32 v227, 0xffff0000, v178
    v_mul_f32 v226, v226, v228
    v_mul_f32 v227, v227, v228
    v_cvt_pk_bf16_f32 v178, v226, v227
    v_lshlrev_b32 v226, 16, v179
    v_and_b32 v227, 0xffff0000, v179
    v_mul_f32 v226, v226, v228
    v_mul_f32 v227, v227, v228
    v_cvt_pk_bf16_f32 v179, v226, v227
    v_lshlrev_b32 v226, 16, v180
    v_and_b32 v227, 0xffff0000, v180
    v_mul_f32 v226, v226, v228
    v_mul_f32 v227, v227, v228
    v_cvt_pk_bf16_f32 v180, v226, v227
    v_lshlrev_b32 v226, 16, v181
    v_and_b32 v227, 0xffff0000, v181
    v_mul_f32 v226, v226, v228
    v_mul_f32 v227, v227, v228
    v_cvt_pk_bf16_f32 v181, v226, v227
    v_lshlrev_b32 v226, 16, v182
    v_and_b32 v227, 0xffff0000, v182
    v_mul_f32 v226, v226, v228
    v_mul_f32 v227, v227, v228
    v_cvt_pk_bf16_f32 v182, v226, v227
    v_lshlrev_b32 v226, 16, v183
    v_and_b32 v227, 0xffff0000, v183
    v_mul_f32 v226, v226, v228
    v_mul_f32 v227, v227, v228
    v_cvt_pk_bf16_f32 v183, v226, v227
    s_nop 3
    s_branch BACK_1_3

SLOW_1_4:
    s_nop 15
    v_mov_b32 v226, v224
    s_nop 1
    v_permlane32_swap_b32 v224, v226
    v_max_f32 v226, v226, v224
    v_cmp_lt_f32 vcc, s32, v226
    s_nop 1
    v_cndmask_b32 v227, 0, v226, vcc
    v_exp_f32 v228, -v227
    v_sub_f32 v144, v144, v227
    v_sub_f32 v145, v145, v227
    v_sub_f32 v146, v146, v227
    v_sub_f32 v147, v147, v227
    v_sub_f32 v148, v148, v227
    v_sub_f32 v149, v149, v227
    v_sub_f32 v150, v150, v227
    v_sub_f32 v151, v151, v227
    v_sub_f32 v152, v152, v227
    v_sub_f32 v153, v153, v227
    v_sub_f32 v154, v154, v227
    v_sub_f32 v155, v155, v227
    v_sub_f32 v156, v156, v227
    v_sub_f32 v157, v157, v227
    v_sub_f32 v158, v158, v227
    v_sub_f32 v159, v159, v227
    v_sub_f32 v32, v32, v227
    v_sub_f32 v33, v33, v227
    v_sub_f32 v34, v34, v227
    v_sub_f32 v35, v35, v227
    v_sub_f32 v36, v36, v227
    v_sub_f32 v37, v37, v227
    v_sub_f32 v38, v38, v227
    v_sub_f32 v39, v39, v227
    v_sub_f32 v40, v40, v227
    v_sub_f32 v41, v41, v227
    v_sub_f32 v42, v42, v227
    v_sub_f32 v43, v43, v227
    v_sub_f32 v44, v44, v227
    v_sub_f32 v45, v45, v227
    v_sub_f32 v46, v46, v227
    v_sub_f32 v47, v47, v227
    v_mul_f32 v31, v31, v228
    v_mul_f32 v225, v225, v228
    v_mul_f32 v48, v48, v228
    v_mul_f32 v49, v49, v228
    v_mul_f32 v50, v50, v228
    v_mul_f32 v51, v51, v228
    v_mul_f32 v52, v52, v228
    v_mul_f32 v53, v53, v228
    v_mul_f32 v54, v54, v228
    v_mul_f32 v55, v55, v228
    v_mul_f32 v56, v56, v228
    v_mul_f32 v57, v57, v228
    v_mul_f32 v58, v58, v228
    v_mul_f32 v59, v59, v228
    v_mul_f32 v60, v60, v228
    v_mul_f32 v61, v61, v228
    v_mul_f32 v62, v62, v228
    v_mul_f32 v63, v63, v228
    v_mul_f32 v64, v64, v228
    v_mul_f32 v65, v65, v228
    v_mul_f32 v66, v66, v228
    v_mul_f32 v67, v67, v228
    v_mul_f32 v68, v68, v228
    v_mul_f32 v69, v69, v228
    v_mul_f32 v70, v70, v228
    v_mul_f32 v71, v71, v228
    v_mul_f32 v72, v72, v228
    v_mul_f32 v73, v73, v228
    v_mul_f32 v74, v74, v228
    v_mul_f32 v75, v75, v228
    v_mul_f32 v76, v76, v228
    v_mul_f32 v77, v77, v228
    v_mul_f32 v78, v78, v228
    v_mul_f32 v79, v79, v228
    v_mul_f32 v80, v80, v228
    v_mul_f32 v81, v81, v228
    v_mul_f32 v82, v82, v228
    v_mul_f32 v83, v83, v228
    v_mul_f32 v84, v84, v228
    v_mul_f32 v85, v85, v228
    v_mul_f32 v86, v86, v228
    v_mul_f32 v87, v87, v228
    v_mul_f32 v88, v88, v228
    v_mul_f32 v89, v89, v228
    v_mul_f32 v90, v90, v228
    v_mul_f32 v91, v91, v228
    v_mul_f32 v92, v92, v228
    v_mul_f32 v93, v93, v228
    v_mul_f32 v94, v94, v228
    v_mul_f32 v95, v95, v228
    v_mul_f32 v96, v96, v228
    v_mul_f32 v97, v97, v228
    v_mul_f32 v98, v98, v228
    v_mul_f32 v99, v99, v228
    v_mul_f32 v100, v100, v228
    v_mul_f32 v101, v101, v228
    v_mul_f32 v102, v102, v228
    v_mul_f32 v103, v103, v228
    v_mul_f32 v104, v104, v228
    v_mul_f32 v105, v105, v228
    v_mul_f32 v106, v106, v228
    v_mul_f32 v107, v107, v228
    v_mul_f32 v108, v108, v228
    v_mul_f32 v109, v109, v228
    v_mul_f32 v110, v110, v228
    v_mul_f32 v111, v111, v228
    v_lshlrev_b32 v226, 16, v184
    v_and_b32 v227, 0xffff0000, v184
    v_mul_f32 v226, v226, v228
    v_mul_f32 v227, v227, v228
    v_cvt_pk_bf16_f32 v184, v226, v227
    v_lshlrev_b32 v226, 16, v185
    v_and_b32 v227, 0xffff0000, v185
    v_mul_f32 v226, v226, v228
    v_mul_f32 v227, v227, v228
    v_cvt_pk_bf16_f32 v185, v226, v227
    v_lshlrev_b32 v226, 16, v186
    v_and_b32 v227, 0xffff0000, v186
    v_mul_f32 v226, v226, v228
    v_mul_f32 v227, v227, v228
    v_cvt_pk_bf16_f32 v186, v226, v227
    v_lshlrev_b32 v226, 16, v187
    v_and_b32 v227, 0xffff0000, v187
    v_mul_f32 v226, v226, v228
    v_mul_f32 v227, v227, v228
    v_cvt_pk_bf16_f32 v187, v226, v227
    v_lshlrev_b32 v226, 16, v188
    v_and_b32 v227, 0xffff0000, v188
    v_mul_f32 v226, v226, v228
    v_mul_f32 v227, v227, v228
    v_cvt_pk_bf16_f32 v188, v226, v227
    v_lshlrev_b32 v226, 16, v189
    v_and_b32 v227, 0xffff0000, v189
    v_mul_f32 v226, v226, v228
    v_mul_f32 v227, v227, v228
    v_cvt_pk_bf16_f32 v189, v226, v227
    v_lshlrev_b32 v226, 16, v190
    v_and_b32 v227, 0xffff0000, v190
    v_mul_f32 v226, v226, v228
    v_mul_f32 v227, v227, v228
    v_cvt_pk_bf16_f32 v190, v226, v227
    v_lshlrev_b32 v226, 16, v191
    v_and_b32 v227, 0xffff0000, v191
    v_mul_f32 v226, v226, v228
    v_mul_f32 v227, v227, v228
    v_cvt_pk_bf16_f32 v191, v226, v227
    s_nop 3
    s_branch BACK_1_4

SLOW_1_5:
    s_nop 15
    v_mov_b32 v226, v224
    s_nop 1
    v_permlane32_swap_b32 v224, v226
    v_max_f32 v226, v226, v224
    v_cmp_lt_f32 vcc, s32, v226
    s_nop 1
    v_cndmask_b32 v227, 0, v226, vcc
    v_exp_f32 v228, -v227
    v_sub_f32 v160, v160, v227
    v_sub_f32 v161, v161, v227
    v_sub_f32 v162, v162, v227
    v_sub_f32 v163, v163, v227
    v_sub_f32 v164, v164, v227
    v_sub_f32 v165, v165, v227
    v_sub_f32 v166, v166, v227
    v_sub_f32 v167, v167, v227
    v_sub_f32 v168, v168, v227
    v_sub_f32 v169, v169, v227
    v_sub_f32 v170, v170, v227
    v_sub_f32 v171, v171, v227
    v_sub_f32 v172, v172, v227
    v_sub_f32 v173, v173, v227
    v_sub_f32 v174, v174, v227
    v_sub_f32 v175, v175, v227
    v_sub_f32 v32, v32, v227
    v_sub_f32 v33, v33, v227
    v_sub_f32 v34, v34, v227
    v_sub_f32 v35, v35, v227
    v_sub_f32 v36, v36, v227
    v_sub_f32 v37, v37, v227
    v_sub_f32 v38, v38, v227
    v_sub_f32 v39, v39, v227
    v_sub_f32 v40, v40, v227
    v_sub_f32 v41, v41, v227
    v_sub_f32 v42, v42, v227
    v_sub_f32 v43, v43, v227
    v_sub_f32 v44, v44, v227
    v_sub_f32 v45, v45, v227
    v_sub_f32 v46, v46, v227
    v_sub_f32 v47, v47, v227
    v_mul_f32 v31, v31, v228
    v_mul_f32 v225, v225, v228
    v_mul_f32 v48, v48, v228
    v_mul_f32 v49, v49, v228
    v_mul_f32 v50, v50, v228
    v_mul_f32 v51, v51, v228
    v_mul_f32 v52, v52, v228
    v_mul_f32 v53, v53, v228
    v_mul_f32 v54, v54, v228
    v_mul_f32 v55, v55, v228
    v_mul_f32 v56, v56, v228
    v_mul_f32 v57, v57, v228
    v_mul_f32 v58, v58, v228
    v_mul_f32 v59, v59, v228
    v_mul_f32 v60, v60, v228
    v_mul_f32 v61, v61, v228
    v_mul_f32 v62, v62, v228
    v_mul_f32 v63, v63, v228
    v_mul_f32 v64, v64, v228
    v_mul_f32 v65, v65, v228
    v_mul_f32 v66, v66, v228
    v_mul_f32 v67, v67, v228
    v_mul_f32 v68, v68, v228
    v_mul_f32 v69, v69, v228
    v_mul_f32 v70, v70, v228
    v_mul_f32 v71, v71, v228
    v_mul_f32 v72, v72, v228
    v_mul_f32 v73, v73, v228
    v_mul_f32 v74, v74, v228
    v_mul_f32 v75, v75, v228
    v_mul_f32 v76, v76, v228
    v_mul_f32 v77, v77, v228
    v_mul_f32 v78, v78, v228
    v_mul_f32 v79, v79, v228
    v_mul_f32 v80, v80, v228
    v_mul_f32 v81, v81, v228
    v_mul_f32 v82, v82, v228
    v_mul_f32 v83, v83, v228
    v_mul_f32 v84, v84, v228
    v_mul_f32 v85, v85, v228
    v_mul_f32 v86, v86, v228
    v_mul_f32 v87, v87, v228
    v_mul_f32 v88, v88, v228
    v_mul_f32 v89, v89, v228
    v_mul_f32 v90, v90, v228
    v_mul_f32 v91, v91, v228
    v_mul_f32 v92, v92, v228
    v_mul_f32 v93, v93, v228
    v_mul_f32 v94, v94, v228
    v_mul_f32 v95, v95, v228
    v_mul_f32 v96, v96, v228
    v_mul_f32 v97, v97, v228
    v_mul_f32 v98, v98, v228
    v_mul_f32 v99, v99, v228
    v_mul_f32 v100, v100, v228
    v_mul_f32 v101, v101, v228
    v_mul_f32 v102, v102, v228
    v_mul_f32 v103, v103, v228
    v_mul_f32 v104, v104, v228
    v_mul_f32 v105, v105, v228
    v_mul_f32 v106, v106, v228
    v_mul_f32 v107, v107, v228
    v_mul_f32 v108, v108, v228
    v_mul_f32 v109, v109, v228
    v_mul_f32 v110, v110, v228
    v_mul_f32 v111, v111, v228
    v_lshlrev_b32 v226, 16, v176
    v_and_b32 v227, 0xffff0000, v176
    v_mul_f32 v226, v226, v228
    v_mul_f32 v227, v227, v228
    v_cvt_pk_bf16_f32 v176, v226, v227
    v_lshlrev_b32 v226, 16, v177
    v_and_b32 v227, 0xffff0000, v177
    v_mul_f32 v226, v226, v228
    v_mul_f32 v227, v227, v228
    v_cvt_pk_bf16_f32 v177, v226, v227
    v_lshlrev_b32 v226, 16, v178
    v_and_b32 v227, 0xffff0000, v178
    v_mul_f32 v226, v226, v228
    v_mul_f32 v227, v227, v228
    v_cvt_pk_bf16_f32 v178, v226, v227
    v_lshlrev_b32 v226, 16, v179
    v_and_b32 v227, 0xffff0000, v179
    v_mul_f32 v226, v226, v228
    v_mul_f32 v227, v227, v228
    v_cvt_pk_bf16_f32 v179, v226, v227
    v_lshlrev_b32 v226, 16, v180
    v_and_b32 v227, 0xffff0000, v180
    v_mul_f32 v226, v226, v228
    v_mul_f32 v227, v227, v228
    v_cvt_pk_bf16_f32 v180, v226, v227
    v_lshlrev_b32 v226, 16, v181
    v_and_b32 v227, 0xffff0000, v181
    v_mul_f32 v226, v226, v228
    v_mul_f32 v227, v227, v228
    v_cvt_pk_bf16_f32 v181, v226, v227
    v_lshlrev_b32 v226, 16, v182
    v_and_b32 v227, 0xffff0000, v182
    v_mul_f32 v226, v226, v228
    v_mul_f32 v227, v227, v228
    v_cvt_pk_bf16_f32 v182, v226, v227
    v_lshlrev_b32 v226, 16, v183
    v_and_b32 v227, 0xffff0000, v183
    v_mul_f32 v226, v226, v228
    v_mul_f32 v227, v227, v228
    v_cvt_pk_bf16_f32 v183, v226, v227
    s_nop 3
    s_branch BACK_1_5

SLOW_1_6:
    s_nop 15
    v_mov_b32 v226, v224
    s_nop 1
    v_permlane32_swap_b32 v224, v226
    v_max_f32 v226, v226, v224
    v_cmp_lt_f32 vcc, s32, v226
    s_nop 1
    v_cndmask_b32 v227, 0, v226, vcc
    v_exp_f32 v228, -v227
    v_sub_f32 v144, v144, v227
    v_sub_f32 v145, v145, v227
    v_sub_f32 v146, v146, v227
    v_sub_f32 v147, v147, v227
    v_sub_f32 v148, v148, v227
    v_sub_f32 v149, v149, v227
    v_sub_f32 v150, v150, v227
    v_sub_f32 v151, v151, v227
    v_sub_f32 v152, v152, v227
    v_sub_f32 v153, v153, v227
    v_sub_f32 v154, v154, v227
    v_sub_f32 v155, v155, v227
    v_sub_f32 v156, v156, v227
    v_sub_f32 v157, v157, v227
    v_sub_f32 v158, v158, v227
    v_sub_f32 v159, v159, v227
    v_sub_f32 v32, v32, v227
    v_sub_f32 v33, v33, v227
    v_sub_f32 v34, v34, v227
    v_sub_f32 v35, v35, v227
    v_sub_f32 v36, v36, v227
    v_sub_f32 v37, v37, v227
    v_sub_f32 v38, v38, v227
    v_sub_f32 v39, v39, v227
    v_sub_f32 v40, v40, v227
    v_sub_f32 v41, v41, v227
    v_sub_f32 v42, v42, v227
    v_sub_f32 v43, v43, v227
    v_sub_f32 v44, v44, v227
    v_sub_f32 v45, v45, v227
    v_sub_f32 v46, v46, v227
    v_sub_f32 v47, v47, v227
    v_mul_f32 v31, v31, v228
    v_mul_f32 v225, v225, v228
    v_mul_f32 v48, v48, v228
    v_mul_f32 v49, v49, v228
    v_mul_f32 v50, v50, v228
    v_mul_f32 v51, v51, v228
    v_mul_f32 v52, v52, v228
    v_mul_f32 v53, v53, v228
    v_mul_f32 v54, v54, v228
    v_mul_f32 v55, v55, v228
    v_mul_f32 v56, v56, v228
    v_mul_f32 v57, v57, v228
    v_mul_f32 v58, v58, v228
    v_mul_f32 v59, v59, v228
    v_mul_f32 v60, v60, v228
    v_mul_f32 v61, v61, v228
    v_mul_f32 v62, v62, v228
    v_mul_f32 v63, v63, v228
    v_mul_f32 v64, v64, v228
    v_mul_f32 v65, v65, v228
    v_mul_f32 v66, v66, v228
    v_mul_f32 v67, v67, v228
    v_mul_f32 v68, v68, v228
    v_mul_f32 v69, v69, v228
    v_mul_f32 v70, v70, v228
    v_mul_f32 v71, v71, v228
    v_mul_f32 v72, v72, v228
    v_mul_f32 v73, v73, v228
    v_mul_f32 v74, v74, v228
    v_mul_f32 v75, v75, v228
    v_mul_f32 v76, v76, v228
    v_mul_f32 v77, v77, v228
    v_mul_f32 v78, v78, v228
    v_mul_f32 v79, v79, v228
    v_mul_f32 v80, v80, v228
    v_mul_f32 v81, v81, v228
    v_mul_f32 v82, v82, v228
    v_mul_f32 v83, v83, v228
    v_mul_f32 v84, v84, v228
    v_mul_f32 v85, v85, v228
    v_mul_f32 v86, v86, v228
    v_mul_f32 v87, v87, v228
    v_mul_f32 v88, v88, v228
    v_mul_f32 v89, v89, v228
    v_mul_f32 v90, v90, v228
    v_mul_f32 v91, v91, v228
    v_mul_f32 v92, v92, v228
    v_mul_f32 v93, v93, v228
    v_mul_f32 v94, v94, v228
    v_mul_f32 v95, v95, v228
    v_mul_f32 v96, v96, v228
    v_mul_f32 v97, v97, v228
    v_mul_f32 v98, v98, v228
    v_mul_f32 v99, v99, v228
    v_mul_f32 v100, v100, v228
    v_mul_f32 v101, v101, v228
    v_mul_f32 v102, v102, v228
    v_mul_f32 v103, v103, v228
    v_mul_f32 v104, v104, v228
    v_mul_f32 v105, v105, v228
    v_mul_f32 v106, v106, v228
    v_mul_f32 v107, v107, v228
    v_mul_f32 v108, v108, v228
    v_mul_f32 v109, v109, v228
    v_mul_f32 v110, v110, v228
    v_mul_f32 v111, v111, v228
    v_lshlrev_b32 v226, 16, v184
    v_and_b32 v227, 0xffff0000, v184
    v_mul_f32 v226, v226, v228
    v_mul_f32 v227, v227, v228
    v_cvt_pk_bf16_f32 v184, v226, v227
    v_lshlrev_b32 v226, 16, v185
    v_and_b32 v227, 0xffff0000, v185
    v_mul_f32 v226, v226, v228
    v_mul_f32 v227, v227, v228
    v_cvt_pk_bf16_f32 v185, v226, v227
    v_lshlrev_b32 v226, 16, v186
    v_and_b32 v227, 0xffff0000, v186
    v_mul_f32 v226, v226, v228
    v_mul_f32 v227, v227, v228
    v_cvt_pk_bf16_f32 v186, v226, v227
    v_lshlrev_b32 v226, 16, v187
    v_and_b32 v227, 0xffff0000, v187
    v_mul_f32 v226, v226, v228
    v_mul_f32 v227, v227, v228
    v_cvt_pk_bf16_f32 v187, v226, v227
    v_lshlrev_b32 v226, 16, v188
    v_and_b32 v227, 0xffff0000, v188
    v_mul_f32 v226, v226, v228
    v_mul_f32 v227, v227, v228
    v_cvt_pk_bf16_f32 v188, v226, v227
    v_lshlrev_b32 v226, 16, v189
    v_and_b32 v227, 0xffff0000, v189
    v_mul_f32 v226, v226, v228
    v_mul_f32 v227, v227, v228
    v_cvt_pk_bf16_f32 v189, v226, v227
    v_lshlrev_b32 v226, 16, v190
    v_and_b32 v227, 0xffff0000, v190
    v_mul_f32 v226, v226, v228
    v_mul_f32 v227, v227, v228
    v_cvt_pk_bf16_f32 v190, v226, v227
    v_lshlrev_b32 v226, 16, v191
    v_and_b32 v227, 0xffff0000, v191
    v_mul_f32 v226, v226, v228
    v_mul_f32 v227, v227, v228
    v_cvt_pk_bf16_f32 v191, v226, v227
    s_nop 3
    s_branch BACK_1_6

SLOW_1_7:
    s_nop 15
    v_mov_b32 v226, v224
    s_nop 1
    v_permlane32_swap_b32 v224, v226
    v_max_f32 v226, v226, v224
    v_cmp_lt_f32 vcc, s32, v226
    s_nop 1
    v_cndmask_b32 v227, 0, v226, vcc
    v_exp_f32 v228, -v227
    v_sub_f32 v160, v160, v227
    v_sub_f32 v161, v161, v227
    v_sub_f32 v162, v162, v227
    v_sub_f32 v163, v163, v227
    v_sub_f32 v164, v164, v227
    v_sub_f32 v165, v165, v227
    v_sub_f32 v166, v166, v227
    v_sub_f32 v167, v167, v227
    v_sub_f32 v168, v168, v227
    v_sub_f32 v169, v169, v227
    v_sub_f32 v170, v170, v227
    v_sub_f32 v171, v171, v227
    v_sub_f32 v172, v172, v227
    v_sub_f32 v173, v173, v227
    v_sub_f32 v174, v174, v227
    v_sub_f32 v175, v175, v227
    v_sub_f32 v32, v32, v227
    v_sub_f32 v33, v33, v227
    v_sub_f32 v34, v34, v227
    v_sub_f32 v35, v35, v227
    v_sub_f32 v36, v36, v227
    v_sub_f32 v37, v37, v227
    v_sub_f32 v38, v38, v227
    v_sub_f32 v39, v39, v227
    v_sub_f32 v40, v40, v227
    v_sub_f32 v41, v41, v227
    v_sub_f32 v42, v42, v227
    v_sub_f32 v43, v43, v227
    v_sub_f32 v44, v44, v227
    v_sub_f32 v45, v45, v227
    v_sub_f32 v46, v46, v227
    v_sub_f32 v47, v47, v227
    v_mul_f32 v31, v31, v228
    v_mul_f32 v225, v225, v228
    v_mul_f32 v48, v48, v228
    v_mul_f32 v49, v49, v228
    v_mul_f32 v50, v50, v228
    v_mul_f32 v51, v51, v228
    v_mul_f32 v52, v52, v228
    v_mul_f32 v53, v53, v228
    v_mul_f32 v54, v54, v228
    v_mul_f32 v55, v55, v228
    v_mul_f32 v56, v56, v228
    v_mul_f32 v57, v57, v228
    v_mul_f32 v58, v58, v228
    v_mul_f32 v59, v59, v228
    v_mul_f32 v60, v60, v228
    v_mul_f32 v61, v61, v228
    v_mul_f32 v62, v62, v228
    v_mul_f32 v63, v63, v228
    v_mul_f32 v64, v64, v228
    v_mul_f32 v65, v65, v228
    v_mul_f32 v66, v66, v228
    v_mul_f32 v67, v67, v228
    v_mul_f32 v68, v68, v228
    v_mul_f32 v69, v69, v228
    v_mul_f32 v70, v70, v228
    v_mul_f32 v71, v71, v228
    v_mul_f32 v72, v72, v228
    v_mul_f32 v73, v73, v228
    v_mul_f32 v74, v74, v228
    v_mul_f32 v75, v75, v228
    v_mul_f32 v76, v76, v228
    v_mul_f32 v77, v77, v228
    v_mul_f32 v78, v78, v228
    v_mul_f32 v79, v79, v228
    v_mul_f32 v80, v80, v228
    v_mul_f32 v81, v81, v228
    v_mul_f32 v82, v82, v228
    v_mul_f32 v83, v83, v228
    v_mul_f32 v84, v84, v228
    v_mul_f32 v85, v85, v228
    v_mul_f32 v86, v86, v228
    v_mul_f32 v87, v87, v228
    v_mul_f32 v88, v88, v228
    v_mul_f32 v89, v89, v228
    v_mul_f32 v90, v90, v228
    v_mul_f32 v91, v91, v228
    v_mul_f32 v92, v92, v228
    v_mul_f32 v93, v93, v228
    v_mul_f32 v94, v94, v228
    v_mul_f32 v95, v95, v228
    v_mul_f32 v96, v96, v228
    v_mul_f32 v97, v97, v228
    v_mul_f32 v98, v98, v228
    v_mul_f32 v99, v99, v228
    v_mul_f32 v100, v100, v228
    v_mul_f32 v101, v101, v228
    v_mul_f32 v102, v102, v228
    v_mul_f32 v103, v103, v228
    v_mul_f32 v104, v104, v228
    v_mul_f32 v105, v105, v228
    v_mul_f32 v106, v106, v228
    v_mul_f32 v107, v107, v228
    v_mul_f32 v108, v108, v228
    v_mul_f32 v109, v109, v228
    v_mul_f32 v110, v110, v228
    v_mul_f32 v111, v111, v228
    v_lshlrev_b32 v226, 16, v176
    v_and_b32 v227, 0xffff0000, v176
    v_mul_f32 v226, v226, v228
    v_mul_f32 v227, v227, v228
    v_cvt_pk_bf16_f32 v176, v226, v227
    v_lshlrev_b32 v226, 16, v177
    v_and_b32 v227, 0xffff0000, v177
    v_mul_f32 v226, v226, v228
    v_mul_f32 v227, v227, v228
    v_cvt_pk_bf16_f32 v177, v226, v227
    v_lshlrev_b32 v226, 16, v178
    v_and_b32 v227, 0xffff0000, v178
    v_mul_f32 v226, v226, v228
    v_mul_f32 v227, v227, v228
    v_cvt_pk_bf16_f32 v178, v226, v227
    v_lshlrev_b32 v226, 16, v179
    v_and_b32 v227, 0xffff0000, v179
    v_mul_f32 v226, v226, v228
    v_mul_f32 v227, v227, v228
    v_cvt_pk_bf16_f32 v179, v226, v227
    v_lshlrev_b32 v226, 16, v180
    v_and_b32 v227, 0xffff0000, v180
    v_mul_f32 v226, v226, v228
    v_mul_f32 v227, v227, v228
    v_cvt_pk_bf16_f32 v180, v226, v227
    v_lshlrev_b32 v226, 16, v181
    v_and_b32 v227, 0xffff0000, v181
    v_mul_f32 v226, v226, v228
    v_mul_f32 v227, v227, v228
    v_cvt_pk_bf16_f32 v181, v226, v227
    v_lshlrev_b32 v226, 16, v182
    v_and_b32 v227, 0xffff0000, v182
    v_mul_f32 v226, v226, v228
    v_mul_f32 v227, v227, v228
    v_cvt_pk_bf16_f32 v182, v226, v227
    v_lshlrev_b32 v226, 16, v183
    v_and_b32 v227, 0xffff0000, v183
    v_mul_f32 v226, v226, v228
    v_mul_f32 v227, v227, v228
    v_cvt_pk_bf16_f32 v183, v226, v227
    s_nop 3
    s_branch BACK_1_7

SLOW_1_8:
    s_nop 15
    v_mov_b32 v226, v224
    s_nop 1
    v_permlane32_swap_b32 v224, v226
    v_max_f32 v226, v226, v224
    v_cmp_lt_f32 vcc, s32, v226
    s_nop 1
    v_cndmask_b32 v227, 0, v226, vcc
    v_exp_f32 v228, -v227
    v_sub_f32 v144, v144, v227
    v_sub_f32 v145, v145, v227
    v_sub_f32 v146, v146, v227
    v_sub_f32 v147, v147, v227
    v_sub_f32 v148, v148, v227
    v_sub_f32 v149, v149, v227
    v_sub_f32 v150, v150, v227
    v_sub_f32 v151, v151, v227
    v_sub_f32 v152, v152, v227
    v_sub_f32 v153, v153, v227
    v_sub_f32 v154, v154, v227
    v_sub_f32 v155, v155, v227
    v_sub_f32 v156, v156, v227
    v_sub_f32 v157, v157, v227
    v_sub_f32 v158, v158, v227
    v_sub_f32 v159, v159, v227
    v_sub_f32 v32, v32, v227
    v_sub_f32 v33, v33, v227
    v_sub_f32 v34, v34, v227
    v_sub_f32 v35, v35, v227
    v_sub_f32 v36, v36, v227
    v_sub_f32 v37, v37, v227
    v_sub_f32 v38, v38, v227
    v_sub_f32 v39, v39, v227
    v_sub_f32 v40, v40, v227
    v_sub_f32 v41, v41, v227
    v_sub_f32 v42, v42, v227
    v_sub_f32 v43, v43, v227
    v_sub_f32 v44, v44, v227
    v_sub_f32 v45, v45, v227
    v_sub_f32 v46, v46, v227
    v_sub_f32 v47, v47, v227
    v_mul_f32 v31, v31, v228
    v_mul_f32 v225, v225, v228
    v_mul_f32 v48, v48, v228
    v_mul_f32 v49, v49, v228
    v_mul_f32 v50, v50, v228
    v_mul_f32 v51, v51, v228
    v_mul_f32 v52, v52, v228
    v_mul_f32 v53, v53, v228
    v_mul_f32 v54, v54, v228
    v_mul_f32 v55, v55, v228
    v_mul_f32 v56, v56, v228
    v_mul_f32 v57, v57, v228
    v_mul_f32 v58, v58, v228
    v_mul_f32 v59, v59, v228
    v_mul_f32 v60, v60, v228
    v_mul_f32 v61, v61, v228
    v_mul_f32 v62, v62, v228
    v_mul_f32 v63, v63, v228
    v_mul_f32 v64, v64, v228
    v_mul_f32 v65, v65, v228
    v_mul_f32 v66, v66, v228
    v_mul_f32 v67, v67, v228
    v_mul_f32 v68, v68, v228
    v_mul_f32 v69, v69, v228
    v_mul_f32 v70, v70, v228
    v_mul_f32 v71, v71, v228
    v_mul_f32 v72, v72, v228
    v_mul_f32 v73, v73, v228
    v_mul_f32 v74, v74, v228
    v_mul_f32 v75, v75, v228
    v_mul_f32 v76, v76, v228
    v_mul_f32 v77, v77, v228
    v_mul_f32 v78, v78, v228
    v_mul_f32 v79, v79, v228
    v_mul_f32 v80, v80, v228
    v_mul_f32 v81, v81, v228
    v_mul_f32 v82, v82, v228
    v_mul_f32 v83, v83, v228
    v_mul_f32 v84, v84, v228
    v_mul_f32 v85, v85, v228
    v_mul_f32 v86, v86, v228
    v_mul_f32 v87, v87, v228
    v_mul_f32 v88, v88, v228
    v_mul_f32 v89, v89, v228
    v_mul_f32 v90, v90, v228
    v_mul_f32 v91, v91, v228
    v_mul_f32 v92, v92, v228
    v_mul_f32 v93, v93, v228
    v_mul_f32 v94, v94, v228
    v_mul_f32 v95, v95, v228
    v_mul_f32 v96, v96, v228
    v_mul_f32 v97, v97, v228
    v_mul_f32 v98, v98, v228
    v_mul_f32 v99, v99, v228
    v_mul_f32 v100, v100, v228
    v_mul_f32 v101, v101, v228
    v_mul_f32 v102, v102, v228
    v_mul_f32 v103, v103, v228
    v_mul_f32 v104, v104, v228
    v_mul_f32 v105, v105, v228
    v_mul_f32 v106, v106, v228
    v_mul_f32 v107, v107, v228
    v_mul_f32 v108, v108, v228
    v_mul_f32 v109, v109, v228
    v_mul_f32 v110, v110, v228
    v_mul_f32 v111, v111, v228
    v_lshlrev_b32 v226, 16, v184
    v_and_b32 v227, 0xffff0000, v184
    v_mul_f32 v226, v226, v228
    v_mul_f32 v227, v227, v228
    v_cvt_pk_bf16_f32 v184, v226, v227
    v_lshlrev_b32 v226, 16, v185
    v_and_b32 v227, 0xffff0000, v185
    v_mul_f32 v226, v226, v228
    v_mul_f32 v227, v227, v228
    v_cvt_pk_bf16_f32 v185, v226, v227
    v_lshlrev_b32 v226, 16, v186
    v_and_b32 v227, 0xffff0000, v186
    v_mul_f32 v226, v226, v228
    v_mul_f32 v227, v227, v228
    v_cvt_pk_bf16_f32 v186, v226, v227
    v_lshlrev_b32 v226, 16, v187
    v_and_b32 v227, 0xffff0000, v187
    v_mul_f32 v226, v226, v228
    v_mul_f32 v227, v227, v228
    v_cvt_pk_bf16_f32 v187, v226, v227
    v_lshlrev_b32 v226, 16, v188
    v_and_b32 v227, 0xffff0000, v188
    v_mul_f32 v226, v226, v228
    v_mul_f32 v227, v227, v228
    v_cvt_pk_bf16_f32 v188, v226, v227
    v_lshlrev_b32 v226, 16, v189
    v_and_b32 v227, 0xffff0000, v189
    v_mul_f32 v226, v226, v228
    v_mul_f32 v227, v227, v228
    v_cvt_pk_bf16_f32 v189, v226, v227
    v_lshlrev_b32 v226, 16, v190
    v_and_b32 v227, 0xffff0000, v190
    v_mul_f32 v226, v226, v228
    v_mul_f32 v227, v227, v228
    v_cvt_pk_bf16_f32 v190, v226, v227
    v_lshlrev_b32 v226, 16, v191
    v_and_b32 v227, 0xffff0000, v191
    v_mul_f32 v226, v226, v228
    v_mul_f32 v227, v227, v228
    v_cvt_pk_bf16_f32 v191, v226, v227
    s_nop 3
    s_branch BACK_1_8

SLOW_1_9:
    s_nop 15
    v_mov_b32 v226, v224
    s_nop 1
    v_permlane32_swap_b32 v224, v226
    v_max_f32 v226, v226, v224
    v_cmp_lt_f32 vcc, s32, v226
    s_nop 1
    v_cndmask_b32 v227, 0, v226, vcc
    v_exp_f32 v228, -v227
    v_sub_f32 v160, v160, v227
    v_sub_f32 v161, v161, v227
    v_sub_f32 v162, v162, v227
    v_sub_f32 v163, v163, v227
    v_sub_f32 v164, v164, v227
    v_sub_f32 v165, v165, v227
    v_sub_f32 v166, v166, v227
    v_sub_f32 v167, v167, v227
    v_sub_f32 v168, v168, v227
    v_sub_f32 v169, v169, v227
    v_sub_f32 v170, v170, v227
    v_sub_f32 v171, v171, v227
    v_sub_f32 v172, v172, v227
    v_sub_f32 v173, v173, v227
    v_sub_f32 v174, v174, v227
    v_sub_f32 v175, v175, v227
    v_sub_f32 v32, v32, v227
    v_sub_f32 v33, v33, v227
    v_sub_f32 v34, v34, v227
    v_sub_f32 v35, v35, v227
    v_sub_f32 v36, v36, v227
    v_sub_f32 v37, v37, v227
    v_sub_f32 v38, v38, v227
    v_sub_f32 v39, v39, v227
    v_sub_f32 v40, v40, v227
    v_sub_f32 v41, v41, v227
    v_sub_f32 v42, v42, v227
    v_sub_f32 v43, v43, v227
    v_sub_f32 v44, v44, v227
    v_sub_f32 v45, v45, v227
    v_sub_f32 v46, v46, v227
    v_sub_f32 v47, v47, v227
    v_mul_f32 v31, v31, v228
    v_mul_f32 v225, v225, v228
    v_mul_f32 v48, v48, v228
    v_mul_f32 v49, v49, v228
    v_mul_f32 v50, v50, v228
    v_mul_f32 v51, v51, v228
    v_mul_f32 v52, v52, v228
    v_mul_f32 v53, v53, v228
    v_mul_f32 v54, v54, v228
    v_mul_f32 v55, v55, v228
    v_mul_f32 v56, v56, v228
    v_mul_f32 v57, v57, v228
    v_mul_f32 v58, v58, v228
    v_mul_f32 v59, v59, v228
    v_mul_f32 v60, v60, v228
    v_mul_f32 v61, v61, v228
    v_mul_f32 v62, v62, v228
    v_mul_f32 v63, v63, v228
    v_mul_f32 v64, v64, v228
    v_mul_f32 v65, v65, v228
    v_mul_f32 v66, v66, v228
    v_mul_f32 v67, v67, v228
    v_mul_f32 v68, v68, v228
    v_mul_f32 v69, v69, v228
    v_mul_f32 v70, v70, v228
    v_mul_f32 v71, v71, v228
    v_mul_f32 v72, v72, v228
    v_mul_f32 v73, v73, v228
    v_mul_f32 v74, v74, v228
    v_mul_f32 v75, v75, v228
    v_mul_f32 v76, v76, v228
    v_mul_f32 v77, v77, v228
    v_mul_f32 v78, v78, v228
    v_mul_f32 v79, v79, v228
    v_mul_f32 v80, v80, v228
    v_mul_f32 v81, v81, v228
    v_mul_f32 v82, v82, v228
    v_mul_f32 v83, v83, v228
    v_mul_f32 v84, v84, v228
    v_mul_f32 v85, v85, v228
    v_mul_f32 v86, v86, v228
    v_mul_f32 v87, v87, v228
    v_mul_f32 v88, v88, v228
    v_mul_f32 v89, v89, v228
    v_mul_f32 v90, v90, v228
    v_mul_f32 v91, v91, v228
    v_mul_f32 v92, v92, v228
    v_mul_f32 v93, v93, v228
    v_mul_f32 v94, v94, v228
    v_mul_f32 v95, v95, v228
    v_mul_f32 v96, v96, v228
    v_mul_f32 v97, v97, v228
    v_mul_f32 v98, v98, v228
    v_mul_f32 v99, v99, v228
    v_mul_f32 v100, v100, v228
    v_mul_f32 v101, v101, v228
    v_mul_f32 v102, v102, v228
    v_mul_f32 v103, v103, v228
    v_mul_f32 v104, v104, v228
    v_mul_f32 v105, v105, v228
    v_mul_f32 v106, v106, v228
    v_mul_f32 v107, v107, v228
    v_mul_f32 v108, v108, v228
    v_mul_f32 v109, v109, v228
    v_mul_f32 v110, v110, v228
    v_mul_f32 v111, v111, v228
    v_lshlrev_b32 v226, 16, v176
    v_and_b32 v227, 0xffff0000, v176
    v_mul_f32 v226, v226, v228
    v_mul_f32 v227, v227, v228
    v_cvt_pk_bf16_f32 v176, v226, v227
    v_lshlrev_b32 v226, 16, v177
    v_and_b32 v227, 0xffff0000, v177
    v_mul_f32 v226, v226, v228
    v_mul_f32 v227, v227, v228
    v_cvt_pk_bf16_f32 v177, v226, v227
    v_lshlrev_b32 v226, 16, v178
    v_and_b32 v227, 0xffff0000, v178
    v_mul_f32 v226, v226, v228
    v_mul_f32 v227, v227, v228
    v_cvt_pk_bf16_f32 v178, v226, v227
    v_lshlrev_b32 v226, 16, v179
    v_and_b32 v227, 0xffff0000, v179
    v_mul_f32 v226, v226, v228
    v_mul_f32 v227, v227, v228
    v_cvt_pk_bf16_f32 v179, v226, v227
    v_lshlrev_b32 v226, 16, v180
    v_and_b32 v227, 0xffff0000, v180
    v_mul_f32 v226, v226, v228
    v_mul_f32 v227, v227, v228
    v_cvt_pk_bf16_f32 v180, v226, v227
    v_lshlrev_b32 v226, 16, v181
    v_and_b32 v227, 0xffff0000, v181
    v_mul_f32 v226, v226, v228
    v_mul_f32 v227, v227, v228
    v_cvt_pk_bf16_f32 v181, v226, v227
    v_lshlrev_b32 v226, 16, v182
    v_and_b32 v227, 0xffff0000, v182
    v_mul_f32 v226, v226, v228
    v_mul_f32 v227, v227, v228
    v_cvt_pk_bf16_f32 v182, v226, v227
    v_lshlrev_b32 v226, 16, v183
    v_and_b32 v227, 0xffff0000, v183
    v_mul_f32 v226, v226, v228
    v_mul_f32 v227, v227, v228
    v_cvt_pk_bf16_f32 v183, v226, v227
    s_nop 3
    s_branch BACK_1_9

SLOW_1_10:
    s_nop 15
    v_mov_b32 v226, v224
    s_nop 1
    v_permlane32_swap_b32 v224, v226
    v_max_f32 v226, v226, v224
    v_cmp_lt_f32 vcc, s32, v226
    s_nop 1
    v_cndmask_b32 v227, 0, v226, vcc
    v_exp_f32 v228, -v227
    v_sub_f32 v144, v144, v227
    v_sub_f32 v145, v145, v227
    v_sub_f32 v146, v146, v227
    v_sub_f32 v147, v147, v227
    v_sub_f32 v148, v148, v227
    v_sub_f32 v149, v149, v227
    v_sub_f32 v150, v150, v227
    v_sub_f32 v151, v151, v227
    v_sub_f32 v152, v152, v227
    v_sub_f32 v153, v153, v227
    v_sub_f32 v154, v154, v227
    v_sub_f32 v155, v155, v227
    v_sub_f32 v156, v156, v227
    v_sub_f32 v157, v157, v227
    v_sub_f32 v158, v158, v227
    v_sub_f32 v159, v159, v227
    v_sub_f32 v32, v32, v227
    v_sub_f32 v33, v33, v227
    v_sub_f32 v34, v34, v227
    v_sub_f32 v35, v35, v227
    v_sub_f32 v36, v36, v227
    v_sub_f32 v37, v37, v227
    v_sub_f32 v38, v38, v227
    v_sub_f32 v39, v39, v227
    v_sub_f32 v40, v40, v227
    v_sub_f32 v41, v41, v227
    v_sub_f32 v42, v42, v227
    v_sub_f32 v43, v43, v227
    v_sub_f32 v44, v44, v227
    v_sub_f32 v45, v45, v227
    v_sub_f32 v46, v46, v227
    v_sub_f32 v47, v47, v227
    v_mul_f32 v31, v31, v228
    v_mul_f32 v225, v225, v228
    v_mul_f32 v48, v48, v228
    v_mul_f32 v49, v49, v228
    v_mul_f32 v50, v50, v228
    v_mul_f32 v51, v51, v228
    v_mul_f32 v52, v52, v228
    v_mul_f32 v53, v53, v228
    v_mul_f32 v54, v54, v228
    v_mul_f32 v55, v55, v228
    v_mul_f32 v56, v56, v228
    v_mul_f32 v57, v57, v228
    v_mul_f32 v58, v58, v228
    v_mul_f32 v59, v59, v228
    v_mul_f32 v60, v60, v228
    v_mul_f32 v61, v61, v228
    v_mul_f32 v62, v62, v228
    v_mul_f32 v63, v63, v228
    v_mul_f32 v64, v64, v228
    v_mul_f32 v65, v65, v228
    v_mul_f32 v66, v66, v228
    v_mul_f32 v67, v67, v228
    v_mul_f32 v68, v68, v228
    v_mul_f32 v69, v69, v228
    v_mul_f32 v70, v70, v228
    v_mul_f32 v71, v71, v228
    v_mul_f32 v72, v72, v228
    v_mul_f32 v73, v73, v228
    v_mul_f32 v74, v74, v228
    v_mul_f32 v75, v75, v228
    v_mul_f32 v76, v76, v228
    v_mul_f32 v77, v77, v228
    v_mul_f32 v78, v78, v228
    v_mul_f32 v79, v79, v228
    v_mul_f32 v80, v80, v228
    v_mul_f32 v81, v81, v228
    v_mul_f32 v82, v82, v228
    v_mul_f32 v83, v83, v228
    v_mul_f32 v84, v84, v228
    v_mul_f32 v85, v85, v228
    v_mul_f32 v86, v86, v228
    v_mul_f32 v87, v87, v228
    v_mul_f32 v88, v88, v228
    v_mul_f32 v89, v89, v228
    v_mul_f32 v90, v90, v228
    v_mul_f32 v91, v91, v228
    v_mul_f32 v92, v92, v228
    v_mul_f32 v93, v93, v228
    v_mul_f32 v94, v94, v228
    v_mul_f32 v95, v95, v228
    v_mul_f32 v96, v96, v228
    v_mul_f32 v97, v97, v228
    v_mul_f32 v98, v98, v228
    v_mul_f32 v99, v99, v228
    v_mul_f32 v100, v100, v228
    v_mul_f32 v101, v101, v228
    v_mul_f32 v102, v102, v228
    v_mul_f32 v103, v103, v228
    v_mul_f32 v104, v104, v228
    v_mul_f32 v105, v105, v228
    v_mul_f32 v106, v106, v228
    v_mul_f32 v107, v107, v228
    v_mul_f32 v108, v108, v228
    v_mul_f32 v109, v109, v228
    v_mul_f32 v110, v110, v228
    v_mul_f32 v111, v111, v228
    v_lshlrev_b32 v226, 16, v184
    v_and_b32 v227, 0xffff0000, v184
    v_mul_f32 v226, v226, v228
    v_mul_f32 v227, v227, v228
    v_cvt_pk_bf16_f32 v184, v226, v227
    v_lshlrev_b32 v226, 16, v185
    v_and_b32 v227, 0xffff0000, v185
    v_mul_f32 v226, v226, v228
    v_mul_f32 v227, v227, v228
    v_cvt_pk_bf16_f32 v185, v226, v227
    v_lshlrev_b32 v226, 16, v186
    v_and_b32 v227, 0xffff0000, v186
    v_mul_f32 v226, v226, v228
    v_mul_f32 v227, v227, v228
    v_cvt_pk_bf16_f32 v186, v226, v227
    v_lshlrev_b32 v226, 16, v187
    v_and_b32 v227, 0xffff0000, v187
    v_mul_f32 v226, v226, v228
    v_mul_f32 v227, v227, v228
    v_cvt_pk_bf16_f32 v187, v226, v227
    v_lshlrev_b32 v226, 16, v188
    v_and_b32 v227, 0xffff0000, v188
    v_mul_f32 v226, v226, v228
    v_mul_f32 v227, v227, v228
    v_cvt_pk_bf16_f32 v188, v226, v227
    v_lshlrev_b32 v226, 16, v189
    v_and_b32 v227, 0xffff0000, v189
    v_mul_f32 v226, v226, v228
    v_mul_f32 v227, v227, v228
    v_cvt_pk_bf16_f32 v189, v226, v227
    v_lshlrev_b32 v226, 16, v190
    v_and_b32 v227, 0xffff0000, v190
    v_mul_f32 v226, v226, v228
    v_mul_f32 v227, v227, v228
    v_cvt_pk_bf16_f32 v190, v226, v227
    v_lshlrev_b32 v226, 16, v191
    v_and_b32 v227, 0xffff0000, v191
    v_mul_f32 v226, v226, v228
    v_mul_f32 v227, v227, v228
    v_cvt_pk_bf16_f32 v191, v226, v227
    s_nop 3
    s_branch BACK_1_10

SLOW_1_11:
    s_nop 15
    v_mov_b32 v226, v224
    s_nop 1
    v_permlane32_swap_b32 v224, v226
    v_max_f32 v226, v226, v224
    v_cmp_lt_f32 vcc, s32, v226
    s_nop 1
    v_cndmask_b32 v227, 0, v226, vcc
    v_exp_f32 v228, -v227
    v_sub_f32 v160, v160, v227
    v_sub_f32 v161, v161, v227
    v_sub_f32 v162, v162, v227
    v_sub_f32 v163, v163, v227
    v_sub_f32 v164, v164, v227
    v_sub_f32 v165, v165, v227
    v_sub_f32 v166, v166, v227
    v_sub_f32 v167, v167, v227
    v_sub_f32 v168, v168, v227
    v_sub_f32 v169, v169, v227
    v_sub_f32 v170, v170, v227
    v_sub_f32 v171, v171, v227
    v_sub_f32 v172, v172, v227
    v_sub_f32 v173, v173, v227
    v_sub_f32 v174, v174, v227
    v_sub_f32 v175, v175, v227
    v_sub_f32 v32, v32, v227
    v_sub_f32 v33, v33, v227
    v_sub_f32 v34, v34, v227
    v_sub_f32 v35, v35, v227
    v_sub_f32 v36, v36, v227
    v_sub_f32 v37, v37, v227
    v_sub_f32 v38, v38, v227
    v_sub_f32 v39, v39, v227
    v_sub_f32 v40, v40, v227
    v_sub_f32 v41, v41, v227
    v_sub_f32 v42, v42, v227
    v_sub_f32 v43, v43, v227
    v_sub_f32 v44, v44, v227
    v_sub_f32 v45, v45, v227
    v_sub_f32 v46, v46, v227
    v_sub_f32 v47, v47, v227
    v_mul_f32 v31, v31, v228
    v_mul_f32 v225, v225, v228
    v_mul_f32 v48, v48, v228
    v_mul_f32 v49, v49, v228
    v_mul_f32 v50, v50, v228
    v_mul_f32 v51, v51, v228
    v_mul_f32 v52, v52, v228
    v_mul_f32 v53, v53, v228
    v_mul_f32 v54, v54, v228
    v_mul_f32 v55, v55, v228
    v_mul_f32 v56, v56, v228
    v_mul_f32 v57, v57, v228
    v_mul_f32 v58, v58, v228
    v_mul_f32 v59, v59, v228
    v_mul_f32 v60, v60, v228
    v_mul_f32 v61, v61, v228
    v_mul_f32 v62, v62, v228
    v_mul_f32 v63, v63, v228
    v_mul_f32 v64, v64, v228
    v_mul_f32 v65, v65, v228
    v_mul_f32 v66, v66, v228
    v_mul_f32 v67, v67, v228
    v_mul_f32 v68, v68, v228
    v_mul_f32 v69, v69, v228
    v_mul_f32 v70, v70, v228
    v_mul_f32 v71, v71, v228
    v_mul_f32 v72, v72, v228
    v_mul_f32 v73, v73, v228
    v_mul_f32 v74, v74, v228
    v_mul_f32 v75, v75, v228
    v_mul_f32 v76, v76, v228
    v_mul_f32 v77, v77, v228
    v_mul_f32 v78, v78, v228
    v_mul_f32 v79, v79, v228
    v_mul_f32 v80, v80, v228
    v_mul_f32 v81, v81, v228
    v_mul_f32 v82, v82, v228
    v_mul_f32 v83, v83, v228
    v_mul_f32 v84, v84, v228
    v_mul_f32 v85, v85, v228
    v_mul_f32 v86, v86, v228
    v_mul_f32 v87, v87, v228
    v_mul_f32 v88, v88, v228
    v_mul_f32 v89, v89, v228
    v_mul_f32 v90, v90, v228
    v_mul_f32 v91, v91, v228
    v_mul_f32 v92, v92, v228
    v_mul_f32 v93, v93, v228
    v_mul_f32 v94, v94, v228
    v_mul_f32 v95, v95, v228
    v_mul_f32 v96, v96, v228
    v_mul_f32 v97, v97, v228
    v_mul_f32 v98, v98, v228
    v_mul_f32 v99, v99, v228
    v_mul_f32 v100, v100, v228
    v_mul_f32 v101, v101, v228
    v_mul_f32 v102, v102, v228
    v_mul_f32 v103, v103, v228
    v_mul_f32 v104, v104, v228
    v_mul_f32 v105, v105, v228
    v_mul_f32 v106, v106, v228
    v_mul_f32 v107, v107, v228
    v_mul_f32 v108, v108, v228
    v_mul_f32 v109, v109, v228
    v_mul_f32 v110, v110, v228
    v_mul_f32 v111, v111, v228
    v_lshlrev_b32 v226, 16, v176
    v_and_b32 v227, 0xffff0000, v176
    v_mul_f32 v226, v226, v228
    v_mul_f32 v227, v227, v228
    v_cvt_pk_bf16_f32 v176, v226, v227
    v_lshlrev_b32 v226, 16, v177
    v_and_b32 v227, 0xffff0000, v177
    v_mul_f32 v226, v226, v228
    v_mul_f32 v227, v227, v228
    v_cvt_pk_bf16_f32 v177, v226, v227
    v_lshlrev_b32 v226, 16, v178
    v_and_b32 v227, 0xffff0000, v178
    v_mul_f32 v226, v226, v228
    v_mul_f32 v227, v227, v228
    v_cvt_pk_bf16_f32 v178, v226, v227
    v_lshlrev_b32 v226, 16, v179
    v_and_b32 v227, 0xffff0000, v179
    v_mul_f32 v226, v226, v228
    v_mul_f32 v227, v227, v228
    v_cvt_pk_bf16_f32 v179, v226, v227
    v_lshlrev_b32 v226, 16, v180
    v_and_b32 v227, 0xffff0000, v180
    v_mul_f32 v226, v226, v228
    v_mul_f32 v227, v227, v228
    v_cvt_pk_bf16_f32 v180, v226, v227
    v_lshlrev_b32 v226, 16, v181
    v_and_b32 v227, 0xffff0000, v181
    v_mul_f32 v226, v226, v228
    v_mul_f32 v227, v227, v228
    v_cvt_pk_bf16_f32 v181, v226, v227
    v_lshlrev_b32 v226, 16, v182
    v_and_b32 v227, 0xffff0000, v182
    v_mul_f32 v226, v226, v228
    v_mul_f32 v227, v227, v228
    v_cvt_pk_bf16_f32 v182, v226, v227
    v_lshlrev_b32 v226, 16, v183
    v_and_b32 v227, 0xffff0000, v183
    v_mul_f32 v226, v226, v228
    v_mul_f32 v227, v227, v228
    v_cvt_pk_bf16_f32 v183, v226, v227
    s_nop 3
    s_branch BACK_1_11

SLOW_1_12:
    s_nop 15
    v_mov_b32 v226, v224
    s_nop 1
    v_permlane32_swap_b32 v224, v226
    v_max_f32 v226, v226, v224
    v_cmp_lt_f32 vcc, s32, v226
    s_nop 1
    v_cndmask_b32 v227, 0, v226, vcc
    v_exp_f32 v228, -v227
    v_sub_f32 v144, v144, v227
    v_sub_f32 v145, v145, v227
    v_sub_f32 v146, v146, v227
    v_sub_f32 v147, v147, v227
    v_sub_f32 v148, v148, v227
    v_sub_f32 v149, v149, v227
    v_sub_f32 v150, v150, v227
    v_sub_f32 v151, v151, v227
    v_sub_f32 v152, v152, v227
    v_sub_f32 v153, v153, v227
    v_sub_f32 v154, v154, v227
    v_sub_f32 v155, v155, v227
    v_sub_f32 v156, v156, v227
    v_sub_f32 v157, v157, v227
    v_sub_f32 v158, v158, v227
    v_sub_f32 v159, v159, v227
    v_sub_f32 v32, v32, v227
    v_sub_f32 v33, v33, v227
    v_sub_f32 v34, v34, v227
    v_sub_f32 v35, v35, v227
    v_sub_f32 v36, v36, v227
    v_sub_f32 v37, v37, v227
    v_sub_f32 v38, v38, v227
    v_sub_f32 v39, v39, v227
    v_sub_f32 v40, v40, v227
    v_sub_f32 v41, v41, v227
    v_sub_f32 v42, v42, v227
    v_sub_f32 v43, v43, v227
    v_sub_f32 v44, v44, v227
    v_sub_f32 v45, v45, v227
    v_sub_f32 v46, v46, v227
    v_sub_f32 v47, v47, v227
    v_mul_f32 v31, v31, v228
    v_mul_f32 v225, v225, v228
    v_mul_f32 v48, v48, v228
    v_mul_f32 v49, v49, v228
    v_mul_f32 v50, v50, v228
    v_mul_f32 v51, v51, v228
    v_mul_f32 v52, v52, v228
    v_mul_f32 v53, v53, v228
    v_mul_f32 v54, v54, v228
    v_mul_f32 v55, v55, v228
    v_mul_f32 v56, v56, v228
    v_mul_f32 v57, v57, v228
    v_mul_f32 v58, v58, v228
    v_mul_f32 v59, v59, v228
    v_mul_f32 v60, v60, v228
    v_mul_f32 v61, v61, v228
    v_mul_f32 v62, v62, v228
    v_mul_f32 v63, v63, v228
    v_mul_f32 v64, v64, v228
    v_mul_f32 v65, v65, v228
    v_mul_f32 v66, v66, v228
    v_mul_f32 v67, v67, v228
    v_mul_f32 v68, v68, v228
    v_mul_f32 v69, v69, v228
    v_mul_f32 v70, v70, v228
    v_mul_f32 v71, v71, v228
    v_mul_f32 v72, v72, v228
    v_mul_f32 v73, v73, v228
    v_mul_f32 v74, v74, v228
    v_mul_f32 v75, v75, v228
    v_mul_f32 v76, v76, v228
    v_mul_f32 v77, v77, v228
    v_mul_f32 v78, v78, v228
    v_mul_f32 v79, v79, v228
    v_mul_f32 v80, v80, v228
    v_mul_f32 v81, v81, v228
    v_mul_f32 v82, v82, v228
    v_mul_f32 v83, v83, v228
    v_mul_f32 v84, v84, v228
    v_mul_f32 v85, v85, v228
    v_mul_f32 v86, v86, v228
    v_mul_f32 v87, v87, v228
    v_mul_f32 v88, v88, v228
    v_mul_f32 v89, v89, v228
    v_mul_f32 v90, v90, v228
    v_mul_f32 v91, v91, v228
    v_mul_f32 v92, v92, v228
    v_mul_f32 v93, v93, v228
    v_mul_f32 v94, v94, v228
    v_mul_f32 v95, v95, v228
    v_mul_f32 v96, v96, v228
    v_mul_f32 v97, v97, v228
    v_mul_f32 v98, v98, v228
    v_mul_f32 v99, v99, v228
    v_mul_f32 v100, v100, v228
    v_mul_f32 v101, v101, v228
    v_mul_f32 v102, v102, v228
    v_mul_f32 v103, v103, v228
    v_mul_f32 v104, v104, v228
    v_mul_f32 v105, v105, v228
    v_mul_f32 v106, v106, v228
    v_mul_f32 v107, v107, v228
    v_mul_f32 v108, v108, v228
    v_mul_f32 v109, v109, v228
    v_mul_f32 v110, v110, v228
    v_mul_f32 v111, v111, v228
    v_lshlrev_b32 v226, 16, v184
    v_and_b32 v227, 0xffff0000, v184
    v_mul_f32 v226, v226, v228
    v_mul_f32 v227, v227, v228
    v_cvt_pk_bf16_f32 v184, v226, v227
    v_lshlrev_b32 v226, 16, v185
    v_and_b32 v227, 0xffff0000, v185
    v_mul_f32 v226, v226, v228
    v_mul_f32 v227, v227, v228
    v_cvt_pk_bf16_f32 v185, v226, v227
    v_lshlrev_b32 v226, 16, v186
    v_and_b32 v227, 0xffff0000, v186
    v_mul_f32 v226, v226, v228
    v_mul_f32 v227, v227, v228
    v_cvt_pk_bf16_f32 v186, v226, v227
    v_lshlrev_b32 v226, 16, v187
    v_and_b32 v227, 0xffff0000, v187
    v_mul_f32 v226, v226, v228
    v_mul_f32 v227, v227, v228
    v_cvt_pk_bf16_f32 v187, v226, v227
    v_lshlrev_b32 v226, 16, v188
    v_and_b32 v227, 0xffff0000, v188
    v_mul_f32 v226, v226, v228
    v_mul_f32 v227, v227, v228
    v_cvt_pk_bf16_f32 v188, v226, v227
    v_lshlrev_b32 v226, 16, v189
    v_and_b32 v227, 0xffff0000, v189
    v_mul_f32 v226, v226, v228
    v_mul_f32 v227, v227, v228
    v_cvt_pk_bf16_f32 v189, v226, v227
    v_lshlrev_b32 v226, 16, v190
    v_and_b32 v227, 0xffff0000, v190
    v_mul_f32 v226, v226, v228
    v_mul_f32 v227, v227, v228
    v_cvt_pk_bf16_f32 v190, v226, v227
    v_lshlrev_b32 v226, 16, v191
    v_and_b32 v227, 0xffff0000, v191
    v_mul_f32 v226, v226, v228
    v_mul_f32 v227, v227, v228
    v_cvt_pk_bf16_f32 v191, v226, v227
    s_nop 3
    s_branch BACK_1_12

SLOW_1_13:
    s_nop 15
    v_mov_b32 v226, v224
    s_nop 1
    v_permlane32_swap_b32 v224, v226
    v_max_f32 v226, v226, v224
    v_cmp_lt_f32 vcc, s32, v226
    s_nop 1
    v_cndmask_b32 v227, 0, v226, vcc
    v_exp_f32 v228, -v227
    v_sub_f32 v160, v160, v227
    v_sub_f32 v161, v161, v227
    v_sub_f32 v162, v162, v227
    v_sub_f32 v163, v163, v227
    v_sub_f32 v164, v164, v227
    v_sub_f32 v165, v165, v227
    v_sub_f32 v166, v166, v227
    v_sub_f32 v167, v167, v227
    v_sub_f32 v168, v168, v227
    v_sub_f32 v169, v169, v227
    v_sub_f32 v170, v170, v227
    v_sub_f32 v171, v171, v227
    v_sub_f32 v172, v172, v227
    v_sub_f32 v173, v173, v227
    v_sub_f32 v174, v174, v227
    v_sub_f32 v175, v175, v227
    v_sub_f32 v32, v32, v227
    v_sub_f32 v33, v33, v227
    v_sub_f32 v34, v34, v227
    v_sub_f32 v35, v35, v227
    v_sub_f32 v36, v36, v227
    v_sub_f32 v37, v37, v227
    v_sub_f32 v38, v38, v227
    v_sub_f32 v39, v39, v227
    v_sub_f32 v40, v40, v227
    v_sub_f32 v41, v41, v227
    v_sub_f32 v42, v42, v227
    v_sub_f32 v43, v43, v227
    v_sub_f32 v44, v44, v227
    v_sub_f32 v45, v45, v227
    v_sub_f32 v46, v46, v227
    v_sub_f32 v47, v47, v227
    v_mul_f32 v31, v31, v228
    v_mul_f32 v225, v225, v228
    v_mul_f32 v48, v48, v228
    v_mul_f32 v49, v49, v228
    v_mul_f32 v50, v50, v228
    v_mul_f32 v51, v51, v228
    v_mul_f32 v52, v52, v228
    v_mul_f32 v53, v53, v228
    v_mul_f32 v54, v54, v228
    v_mul_f32 v55, v55, v228
    v_mul_f32 v56, v56, v228
    v_mul_f32 v57, v57, v228
    v_mul_f32 v58, v58, v228
    v_mul_f32 v59, v59, v228
    v_mul_f32 v60, v60, v228
    v_mul_f32 v61, v61, v228
    v_mul_f32 v62, v62, v228
    v_mul_f32 v63, v63, v228
    v_mul_f32 v64, v64, v228
    v_mul_f32 v65, v65, v228
    v_mul_f32 v66, v66, v228
    v_mul_f32 v67, v67, v228
    v_mul_f32 v68, v68, v228
    v_mul_f32 v69, v69, v228
    v_mul_f32 v70, v70, v228
    v_mul_f32 v71, v71, v228
    v_mul_f32 v72, v72, v228
    v_mul_f32 v73, v73, v228
    v_mul_f32 v74, v74, v228
    v_mul_f32 v75, v75, v228
    v_mul_f32 v76, v76, v228
    v_mul_f32 v77, v77, v228
    v_mul_f32 v78, v78, v228
    v_mul_f32 v79, v79, v228
    v_mul_f32 v80, v80, v228
    v_mul_f32 v81, v81, v228
    v_mul_f32 v82, v82, v228
    v_mul_f32 v83, v83, v228
    v_mul_f32 v84, v84, v228
    v_mul_f32 v85, v85, v228
    v_mul_f32 v86, v86, v228
    v_mul_f32 v87, v87, v228
    v_mul_f32 v88, v88, v228
    v_mul_f32 v89, v89, v228
    v_mul_f32 v90, v90, v228
    v_mul_f32 v91, v91, v228
    v_mul_f32 v92, v92, v228
    v_mul_f32 v93, v93, v228
    v_mul_f32 v94, v94, v228
    v_mul_f32 v95, v95, v228
    v_mul_f32 v96, v96, v228
    v_mul_f32 v97, v97, v228
    v_mul_f32 v98, v98, v228
    v_mul_f32 v99, v99, v228
    v_mul_f32 v100, v100, v228
    v_mul_f32 v101, v101, v228
    v_mul_f32 v102, v102, v228
    v_mul_f32 v103, v103, v228
    v_mul_f32 v104, v104, v228
    v_mul_f32 v105, v105, v228
    v_mul_f32 v106, v106, v228
    v_mul_f32 v107, v107, v228
    v_mul_f32 v108, v108, v228
    v_mul_f32 v109, v109, v228
    v_mul_f32 v110, v110, v228
    v_mul_f32 v111, v111, v228
    v_lshlrev_b32 v226, 16, v176
    v_and_b32 v227, 0xffff0000, v176
    v_mul_f32 v226, v226, v228
    v_mul_f32 v227, v227, v228
    v_cvt_pk_bf16_f32 v176, v226, v227
    v_lshlrev_b32 v226, 16, v177
    v_and_b32 v227, 0xffff0000, v177
    v_mul_f32 v226, v226, v228
    v_mul_f32 v227, v227, v228
    v_cvt_pk_bf16_f32 v177, v226, v227
    v_lshlrev_b32 v226, 16, v178
    v_and_b32 v227, 0xffff0000, v178
    v_mul_f32 v226, v226, v228
    v_mul_f32 v227, v227, v228
    v_cvt_pk_bf16_f32 v178, v226, v227
    v_lshlrev_b32 v226, 16, v179
    v_and_b32 v227, 0xffff0000, v179
    v_mul_f32 v226, v226, v228
    v_mul_f32 v227, v227, v228
    v_cvt_pk_bf16_f32 v179, v226, v227
    v_lshlrev_b32 v226, 16, v180
    v_and_b32 v227, 0xffff0000, v180
    v_mul_f32 v226, v226, v228
    v_mul_f32 v227, v227, v228
    v_cvt_pk_bf16_f32 v180, v226, v227
    v_lshlrev_b32 v226, 16, v181
    v_and_b32 v227, 0xffff0000, v181
    v_mul_f32 v226, v226, v228
    v_mul_f32 v227, v227, v228
    v_cvt_pk_bf16_f32 v181, v226, v227
    v_lshlrev_b32 v226, 16, v182
    v_and_b32 v227, 0xffff0000, v182
    v_mul_f32 v226, v226, v228
    v_mul_f32 v227, v227, v228
    v_cvt_pk_bf16_f32 v182, v226, v227
    v_lshlrev_b32 v226, 16, v183
    v_and_b32 v227, 0xffff0000, v183
    v_mul_f32 v226, v226, v228
    v_mul_f32 v227, v227, v228
    v_cvt_pk_bf16_f32 v183, v226, v227
    s_nop 3
    s_branch BACK_1_13

SLOW_1_14:
    s_nop 15
    v_mov_b32 v226, v224
    s_nop 1
    v_permlane32_swap_b32 v224, v226
    v_max_f32 v226, v226, v224
    v_cmp_lt_f32 vcc, s32, v226
    s_nop 1
    v_cndmask_b32 v227, 0, v226, vcc
    v_exp_f32 v228, -v227
    v_sub_f32 v144, v144, v227
    v_sub_f32 v145, v145, v227
    v_sub_f32 v146, v146, v227
    v_sub_f32 v147, v147, v227
    v_sub_f32 v148, v148, v227
    v_sub_f32 v149, v149, v227
    v_sub_f32 v150, v150, v227
    v_sub_f32 v151, v151, v227
    v_sub_f32 v152, v152, v227
    v_sub_f32 v153, v153, v227
    v_sub_f32 v154, v154, v227
    v_sub_f32 v155, v155, v227
    v_sub_f32 v156, v156, v227
    v_sub_f32 v157, v157, v227
    v_sub_f32 v158, v158, v227
    v_sub_f32 v159, v159, v227
    v_sub_f32 v32, v32, v227
    v_sub_f32 v33, v33, v227
    v_sub_f32 v34, v34, v227
    v_sub_f32 v35, v35, v227
    v_sub_f32 v36, v36, v227
    v_sub_f32 v37, v37, v227
    v_sub_f32 v38, v38, v227
    v_sub_f32 v39, v39, v227
    v_sub_f32 v40, v40, v227
    v_sub_f32 v41, v41, v227
    v_sub_f32 v42, v42, v227
    v_sub_f32 v43, v43, v227
    v_sub_f32 v44, v44, v227
    v_sub_f32 v45, v45, v227
    v_sub_f32 v46, v46, v227
    v_sub_f32 v47, v47, v227
    v_mul_f32 v31, v31, v228
    v_mul_f32 v225, v225, v228
    v_mul_f32 v48, v48, v228
    v_mul_f32 v49, v49, v228
    v_mul_f32 v50, v50, v228
    v_mul_f32 v51, v51, v228
    v_mul_f32 v52, v52, v228
    v_mul_f32 v53, v53, v228
    v_mul_f32 v54, v54, v228
    v_mul_f32 v55, v55, v228
    v_mul_f32 v56, v56, v228
    v_mul_f32 v57, v57, v228
    v_mul_f32 v58, v58, v228
    v_mul_f32 v59, v59, v228
    v_mul_f32 v60, v60, v228
    v_mul_f32 v61, v61, v228
    v_mul_f32 v62, v62, v228
    v_mul_f32 v63, v63, v228
    v_mul_f32 v64, v64, v228
    v_mul_f32 v65, v65, v228
    v_mul_f32 v66, v66, v228
    v_mul_f32 v67, v67, v228
    v_mul_f32 v68, v68, v228
    v_mul_f32 v69, v69, v228
    v_mul_f32 v70, v70, v228
    v_mul_f32 v71, v71, v228
    v_mul_f32 v72, v72, v228
    v_mul_f32 v73, v73, v228
    v_mul_f32 v74, v74, v228
    v_mul_f32 v75, v75, v228
    v_mul_f32 v76, v76, v228
    v_mul_f32 v77, v77, v228
    v_mul_f32 v78, v78, v228
    v_mul_f32 v79, v79, v228
    v_mul_f32 v80, v80, v228
    v_mul_f32 v81, v81, v228
    v_mul_f32 v82, v82, v228
    v_mul_f32 v83, v83, v228
    v_mul_f32 v84, v84, v228
    v_mul_f32 v85, v85, v228
    v_mul_f32 v86, v86, v228
    v_mul_f32 v87, v87, v228
    v_mul_f32 v88, v88, v228
    v_mul_f32 v89, v89, v228
    v_mul_f32 v90, v90, v228
    v_mul_f32 v91, v91, v228
    v_mul_f32 v92, v92, v228
    v_mul_f32 v93, v93, v228
    v_mul_f32 v94, v94, v228
    v_mul_f32 v95, v95, v228
    v_mul_f32 v96, v96, v228
    v_mul_f32 v97, v97, v228
    v_mul_f32 v98, v98, v228
    v_mul_f32 v99, v99, v228
    v_mul_f32 v100, v100, v228
    v_mul_f32 v101, v101, v228
    v_mul_f32 v102, v102, v228
    v_mul_f32 v103, v103, v228
    v_mul_f32 v104, v104, v228
    v_mul_f32 v105, v105, v228
    v_mul_f32 v106, v106, v228
    v_mul_f32 v107, v107, v228
    v_mul_f32 v108, v108, v228
    v_mul_f32 v109, v109, v228
    v_mul_f32 v110, v110, v228
    v_mul_f32 v111, v111, v228
    v_lshlrev_b32 v226, 16, v184
    v_and_b32 v227, 0xffff0000, v184
    v_mul_f32 v226, v226, v228
    v_mul_f32 v227, v227, v228
    v_cvt_pk_bf16_f32 v184, v226, v227
    v_lshlrev_b32 v226, 16, v185
    v_and_b32 v227, 0xffff0000, v185
    v_mul_f32 v226, v226, v228
    v_mul_f32 v227, v227, v228
    v_cvt_pk_bf16_f32 v185, v226, v227
    v_lshlrev_b32 v226, 16, v186
    v_and_b32 v227, 0xffff0000, v186
    v_mul_f32 v226, v226, v228
    v_mul_f32 v227, v227, v228
    v_cvt_pk_bf16_f32 v186, v226, v227
    v_lshlrev_b32 v226, 16, v187
    v_and_b32 v227, 0xffff0000, v187
    v_mul_f32 v226, v226, v228
    v_mul_f32 v227, v227, v228
    v_cvt_pk_bf16_f32 v187, v226, v227
    v_lshlrev_b32 v226, 16, v188
    v_and_b32 v227, 0xffff0000, v188
    v_mul_f32 v226, v226, v228
    v_mul_f32 v227, v227, v228
    v_cvt_pk_bf16_f32 v188, v226, v227
    v_lshlrev_b32 v226, 16, v189
    v_and_b32 v227, 0xffff0000, v189
    v_mul_f32 v226, v226, v228
    v_mul_f32 v227, v227, v228
    v_cvt_pk_bf16_f32 v189, v226, v227
    v_lshlrev_b32 v226, 16, v190
    v_and_b32 v227, 0xffff0000, v190
    v_mul_f32 v226, v226, v228
    v_mul_f32 v227, v227, v228
    v_cvt_pk_bf16_f32 v190, v226, v227
    v_lshlrev_b32 v226, 16, v191
    v_and_b32 v227, 0xffff0000, v191
    v_mul_f32 v226, v226, v228
    v_mul_f32 v227, v227, v228
    v_cvt_pk_bf16_f32 v191, v226, v227
    s_nop 3
    s_branch BACK_1_14

SLOW_1_15:
    s_nop 15
    v_mov_b32 v226, v224
    s_nop 1
    v_permlane32_swap_b32 v224, v226
    v_max_f32 v226, v226, v224
    v_cmp_lt_f32 vcc, s32, v226
    s_nop 1
    v_cndmask_b32 v227, 0, v226, vcc
    v_exp_f32 v228, -v227
    v_sub_f32 v160, v160, v227
    v_sub_f32 v161, v161, v227
    v_sub_f32 v162, v162, v227
    v_sub_f32 v163, v163, v227
    v_sub_f32 v164, v164, v227
    v_sub_f32 v165, v165, v227
    v_sub_f32 v166, v166, v227
    v_sub_f32 v167, v167, v227
    v_sub_f32 v168, v168, v227
    v_sub_f32 v169, v169, v227
    v_sub_f32 v170, v170, v227
    v_sub_f32 v171, v171, v227
    v_sub_f32 v172, v172, v227
    v_sub_f32 v173, v173, v227
    v_sub_f32 v174, v174, v227
    v_sub_f32 v175, v175, v227
    v_sub_f32 v32, v32, v227
    v_sub_f32 v33, v33, v227
    v_sub_f32 v34, v34, v227
    v_sub_f32 v35, v35, v227
    v_sub_f32 v36, v36, v227
    v_sub_f32 v37, v37, v227
    v_sub_f32 v38, v38, v227
    v_sub_f32 v39, v39, v227
    v_sub_f32 v40, v40, v227
    v_sub_f32 v41, v41, v227
    v_sub_f32 v42, v42, v227
    v_sub_f32 v43, v43, v227
    v_sub_f32 v44, v44, v227
    v_sub_f32 v45, v45, v227
    v_sub_f32 v46, v46, v227
    v_sub_f32 v47, v47, v227
    v_mul_f32 v31, v31, v228
    v_mul_f32 v225, v225, v228
    v_mul_f32 v48, v48, v228
    v_mul_f32 v49, v49, v228
    v_mul_f32 v50, v50, v228
    v_mul_f32 v51, v51, v228
    v_mul_f32 v52, v52, v228
    v_mul_f32 v53, v53, v228
    v_mul_f32 v54, v54, v228
    v_mul_f32 v55, v55, v228
    v_mul_f32 v56, v56, v228
    v_mul_f32 v57, v57, v228
    v_mul_f32 v58, v58, v228
    v_mul_f32 v59, v59, v228
    v_mul_f32 v60, v60, v228
    v_mul_f32 v61, v61, v228
    v_mul_f32 v62, v62, v228
    v_mul_f32 v63, v63, v228
    v_mul_f32 v64, v64, v228
    v_mul_f32 v65, v65, v228
    v_mul_f32 v66, v66, v228
    v_mul_f32 v67, v67, v228
    v_mul_f32 v68, v68, v228
    v_mul_f32 v69, v69, v228
    v_mul_f32 v70, v70, v228
    v_mul_f32 v71, v71, v228
    v_mul_f32 v72, v72, v228
    v_mul_f32 v73, v73, v228
    v_mul_f32 v74, v74, v228
    v_mul_f32 v75, v75, v228
    v_mul_f32 v76, v76, v228
    v_mul_f32 v77, v77, v228
    v_mul_f32 v78, v78, v228
    v_mul_f32 v79, v79, v228
    v_mul_f32 v80, v80, v228
    v_mul_f32 v81, v81, v228
    v_mul_f32 v82, v82, v228
    v_mul_f32 v83, v83, v228
    v_mul_f32 v84, v84, v228
    v_mul_f32 v85, v85, v228
    v_mul_f32 v86, v86, v228
    v_mul_f32 v87, v87, v228
    v_mul_f32 v88, v88, v228
    v_mul_f32 v89, v89, v228
    v_mul_f32 v90, v90, v228
    v_mul_f32 v91, v91, v228
    v_mul_f32 v92, v92, v228
    v_mul_f32 v93, v93, v228
    v_mul_f32 v94, v94, v228
    v_mul_f32 v95, v95, v228
    v_mul_f32 v96, v96, v228
    v_mul_f32 v97, v97, v228
    v_mul_f32 v98, v98, v228
    v_mul_f32 v99, v99, v228
    v_mul_f32 v100, v100, v228
    v_mul_f32 v101, v101, v228
    v_mul_f32 v102, v102, v228
    v_mul_f32 v103, v103, v228
    v_mul_f32 v104, v104, v228
    v_mul_f32 v105, v105, v228
    v_mul_f32 v106, v106, v228
    v_mul_f32 v107, v107, v228
    v_mul_f32 v108, v108, v228
    v_mul_f32 v109, v109, v228
    v_mul_f32 v110, v110, v228
    v_mul_f32 v111, v111, v228
    v_lshlrev_b32 v226, 16, v176
    v_and_b32 v227, 0xffff0000, v176
    v_mul_f32 v226, v226, v228
    v_mul_f32 v227, v227, v228
    v_cvt_pk_bf16_f32 v176, v226, v227
    v_lshlrev_b32 v226, 16, v177
    v_and_b32 v227, 0xffff0000, v177
    v_mul_f32 v226, v226, v228
    v_mul_f32 v227, v227, v228
    v_cvt_pk_bf16_f32 v177, v226, v227
    v_lshlrev_b32 v226, 16, v178
    v_and_b32 v227, 0xffff0000, v178
    v_mul_f32 v226, v226, v228
    v_mul_f32 v227, v227, v228
    v_cvt_pk_bf16_f32 v178, v226, v227
    v_lshlrev_b32 v226, 16, v179
    v_and_b32 v227, 0xffff0000, v179
    v_mul_f32 v226, v226, v228
    v_mul_f32 v227, v227, v228
    v_cvt_pk_bf16_f32 v179, v226, v227
    v_lshlrev_b32 v226, 16, v180
    v_and_b32 v227, 0xffff0000, v180
    v_mul_f32 v226, v226, v228
    v_mul_f32 v227, v227, v228
    v_cvt_pk_bf16_f32 v180, v226, v227
    v_lshlrev_b32 v226, 16, v181
    v_and_b32 v227, 0xffff0000, v181
    v_mul_f32 v226, v226, v228
    v_mul_f32 v227, v227, v228
    v_cvt_pk_bf16_f32 v181, v226, v227
    v_lshlrev_b32 v226, 16, v182
    v_and_b32 v227, 0xffff0000, v182
    v_mul_f32 v226, v226, v228
    v_mul_f32 v227, v227, v228
    v_cvt_pk_bf16_f32 v182, v226, v227
    v_lshlrev_b32 v226, 16, v183
    v_and_b32 v227, 0xffff0000, v183
    v_mul_f32 v226, v226, v228
    v_mul_f32 v227, v227, v228
    v_cvt_pk_bf16_f32 v183, v226, v227
    s_nop 3
    s_branch BACK_1_15

.section .rodata,"a"
.p2align 6
.amdhsa_kernel concat_heads__gqa_block_cached__gqa_block_cached__near_ridge_kernel
  .amdhsa_next_free_vgpr 256
  .amdhsa_next_free_sgpr 102
  .amdhsa_accum_offset 256
  .amdhsa_group_segment_fixed_size 0
  .amdhsa_kernarg_size 104
  .amdhsa_user_sgpr_count 2
  .amdhsa_user_sgpr_kernarg_segment_ptr 1
  .amdhsa_system_sgpr_workgroup_id_x 1
.end_amdhsa_kernel
.p2align 6
```
